```python
import torch

def _softmax(x, axis=-1):
    return torch.softmax(x, dim=axis)

def _gelu(x):
    return torch.nn.functional.gelu(x, approximate='tanh')

def _silu(x):
    return torch.nn.functional.silu(x)

def _sigmoid(x):
    return torch.sigmoid(x)

def _layernorm(x, axis=-1, eps=1e-05):
    m = x.mean(dim=axis, keepdim=True)
    v = x.var(dim=axis, keepdim=True, unbiased=False)
    return (x - m) / torch.sqrt(v + eps)

def _scatter_add(tgt, idx, src, axis=0):
    return tgt.clone().index_add_(axis, idx, src)

def _segment_sum(src, seg, n):
    out = torch.zeros((n,) + src.shape[1:], dtype=src.dtype)
    return out.index_add_(0, seg, src)

def _pad(x, pw):
    flat = tuple((v for pair in reversed(pw) for v in pair))
    return torch.nn.functional.pad(x, flat)
kernel_name = 'parallel_sum__mha_block__mixer_gmlp__prompt'

def setup_inputs():

    _w = lambda a: (lambda t: t.to(torch.bfloat16) if t.is_floating_point() else t)(torch.as_tensor(a))

    def _A_setup():
        B, S, D, H = (1, 2048, 448, 16)
        return {'x': _w((lambda *s: torch.randn(*s, dtype=torch.bfloat16) * 0.05)(B, S, D)), 'wqkv': _w((lambda *s: torch.randn(*s, dtype=torch.bfloat16) * 0.2)(D, 3 * D)), 'wo': _w((lambda *s: torch.randn(*s, dtype=torch.bfloat16) * 0.1)(D, D))}
    _A_in = _A_setup()

    def _B_setup():
        B, S, D, F = (1, 2048, 448, 1792)
        Fh = F // 2
        return {'x': _w((lambda *s: torch.randn(*s, dtype=torch.bfloat16) * 0.05)(B, S, D)), 'w_in': _w((lambda *s: torch.randn(*s, dtype=torch.bfloat16) * 0.4)(D, 2 * Fh)), 'w_sp': _w(0.01 * (lambda *s: torch.randn(*s, dtype=torch.bfloat16) * 0.4)(S, S)), 'b_sp': _w(1.0 + 0.01 * (lambda *s: torch.randn(*s, dtype=torch.bfloat16) * 0.2)(S)), 'w_out': _w((lambda *s: torch.randn(*s, dtype=torch.bfloat16) * 0.2)(Fh, D))}
    _B_in = _B_setup()
    return {'A_x': _A_in['x'], 'A_wqkv': _A_in['wqkv'], 'A_wo': _A_in['wo'], 'B_x': _B_in['x'], 'B_w_in': _B_in['w_in'], 'B_w_sp': _B_in['w_sp'], 'B_b_sp': _B_in['b_sp'], 'B_w_out': _B_in['w_out']}

def reference(A_x, A_wqkv, A_wo, B_x, B_w_in, B_w_sp, B_b_sp, B_w_out):

    def _A_ref(x, wqkv, wo):
        B, S, D = x.shape
        H = 16
        Dh = D // H
        qkv = (lambda x, *d: x.permute(*d))((x @ wqkv).reshape(B, S, 3, H, Dh), 2, 0, 3, 1, 4)
        q, k, v = (qkv[0], qkv[1], qkv[2])
        scores = torch.einsum('bhqd,bhkd->bhqk', q, k) * Dh ** (-0.5)
        p = _softmax(scores, axis=-1)
        o = torch.einsum('bhqk,bhkd->bhqd', p, v)
        return (lambda x, *d: x.permute(*d))(o, 0, 2, 1, 3).reshape(B, S, D) @ wo

    def _B_ref(x, w_in, w_sp, b_sp, w_out):
        B, S, D = x.shape
        F = w_in.shape[-1]
        Fh = F // 2
        z = _gelu(torch.einsum('bsd,df->bsf', x, w_in))
        z1 = z[..., :Fh].clone()
        z2 = _layernorm(z[..., Fh:], axis=-1)
        g = torch.einsum('ts,bsf->btf', w_sp, z2) + b_sp[None, :, None]
        return torch.einsum('bsf,fd->bsd', z1 * g, w_out)
    x = A_x
    xn = _layernorm(x, axis=-1)
    return x + _A_ref(xn, A_wqkv, A_wo) + _B_ref(xn, B_w_in, B_w_sp, B_b_sp, B_w_out)
```

```asm
; @launch kernel=p1_kernel grid=(256,1,1) block=(512,1,1) lds=162304
; @launch kernel=p2_kernel grid=(256,1,1) block=(512,1,1) lds=149536
; @launch kernel=p3_kernel grid=(224,1,1) block=(512,1,1) lds=98304
.amdgcn_target "amdgcn-amd-amdhsa--gfx950"
.text
.globl p1_kernel
.p2align 8
.type p1_kernel,@function
p1_kernel:
    s_cmp_ge_u32 s2, 256
    s_cbranch_scc1 p1_end
    s_cmp_ge_u32 s2, 224
    s_cbranch_scc1 p1_pf
    s_load_dwordx2 s[4:5], s[0:1], 0
    s_load_dwordx2 s[6:7], s[0:1], 8
    s_load_dwordx2 s[50:51], s[0:1], 32
    s_load_dwordx2 s[52:53], s[0:1], 72
    s_load_dwordx2 s[54:55], s[0:1], 80
    s_getpc_b64 s[98:99]
    v_lshrrev_b32 v255, 6, v0
    v_cmp_eq_u32 vcc, 7, v255
    s_lshr_b32 s96, s2, 3
    s_mul_i32 s97, s96, 10923
    s_lshr_b32 s97, s97, 16
    s_mul_i32 s97, s97, 6
    s_sub_u32 s96, s96, s97
    s_lshl_b32 s96, s96, 6
    v_and_b32 v255, 63, v0
    v_add_u32 v255, s96, v255
    s_mov_b32 s97, 340
    v_cmp_gt_u32 s[96:97], s97, v255
    s_nop 3
    s_and_b64 vcc, vcc, s[96:97]
    v_lshlrev_b32 v255, 7, v255
    s_and_saveexec_b64 s[96:97], vcc
    s_cbranch_execz p1_cpf
    global_load_dword v254, v255, s[98:99]
p1_cpf:
    s_mov_b64 exec, s[96:97]
    v_and_b32 v1, 63, v0
    v_lshrrev_b32 v2, 6, v0
    s_nop 0
    v_readfirstlane_b32 s28, v2
    s_and_b32 s31, s2, 7
    s_mul_i32 s31, s31, 28
    s_lshr_b32 s32, s2, 3
    s_add_u32 s31, s31, s32
    s_lshr_b32 s30, s31, 5
    s_and_b32 s29, s31, 31
    s_and_b32 s35, s28, 3
    s_lshr_b32 s36, s28, 2
    v_lshrrev_b32 v2, 3, v1
    v_and_b32 v3, 7, v1
    v_mul_u32_u24 v4, 896, v2
    v_lshl_add_u32 v8, v3, 4, v4
    s_lshl_b32 s31, s29, 3
    s_add_u32 s31, s31, s28
    s_mul_i32 s48, s31, 7168
    v_lshrrev_b32 v4, 2, v2
    v_and_b32 v5, 3, v2
    v_lshl_add_u32 v4, v4, 3, v5
    v_bfe_u32 v5, v2, 1, 2
    v_lshrrev_b32 v6, 1, v3
    v_xor_b32 v6, v6, v5
    v_and_b32 v3, 1, v3
    v_lshl_add_u32 v6, v6, 1, v3
    v_lshlrev_b32 v6, 4, v6
    v_mul_u32_u24 v10, 3584, v4
    v_add_u32 v10, v10, v6
    v_mul_u32_u24 v9, 2688, v4
    v_add_u32 v9, v9, v6
    s_mul_i32 s41, s36, 114688
    s_bfe_u32 s31, s28, 0x10001
    s_lshl_b32 s31, s31, 7
    s_add_u32 s41, s41, s31
    s_lshl_b32 s31, s30, 8
    s_add_u32 s41, s41, s31
    s_add_u32 s41, s41, 1792
    s_and_b32 s31, s28, 1
    s_mul_i32 s31, s31, 14336
    s_add_u32 s41, s41, s31
    s_add_u32 s42, s41, 57344
    s_lshl_b32 s46, s28, 11
    s_add_u32 s46, s46, 57344
    s_waitcnt lgkmcnt(0)
    s_mov_b32 s8, s4
    s_mov_b32 s9, s5
    s_mov_b32 s10, 0x1c0000
    s_mov_b32 s11, 0x20000
    buffer_load_dwordx4 v[12:15], v8, s[8:11], s48 offen offset:0
    buffer_load_dwordx4 v[16:19], v8, s[8:11], s48 offen offset:128
    buffer_load_dwordx4 v[20:23], v8, s[8:11], s48 offen offset:256
    buffer_load_dwordx4 v[24:27], v8, s[8:11], s48 offen offset:384
    buffer_load_dwordx4 v[28:31], v8, s[8:11], s48 offen offset:512
    buffer_load_dwordx4 v[32:35], v8, s[8:11], s48 offen offset:640
    buffer_load_dwordx4 v[36:39], v8, s[8:11], s48 offen offset:768
    s_mov_b32 s16, s50
    s_mov_b32 s17, s51
    s_mov_b32 s18, 0x188000
    s_mov_b32 s19, 0x20000
    s_mov_b32 s12, s6
    s_mov_b32 s13, s7
    s_mov_b32 s14, 0x126000
    s_mov_b32 s15, 0x20000
    s_mov_b32 s24, s52
    s_mov_b32 s25, s53
    s_mov_b32 s26, 0x100
    s_mov_b32 s27, 0x20000
    s_mov_b32 s20, s54
    s_mov_b32 s21, s55
    s_mov_b32 s22, 0x1400000
    s_mov_b32 s23, 0x20000
    s_add_u32 m0, s46, 0
    s_nop 0
    buffer_load_dwordx4 v10, s[16:19], s41 offen lds
    s_add_u32 s41, s41, 229376
    s_add_u32 m0, s46, 1024
    s_nop 0
    buffer_load_dwordx4 v10, s[16:19], s42 offen lds
    s_add_u32 s42, s42, 229376
    s_add_u32 m0, s46, 20480
    s_nop 0
    buffer_load_dwordx4 v10, s[16:19], s41 offen lds
    s_add_u32 s41, s41, 229376
    s_add_u32 m0, s46, 21504
    s_nop 0
    buffer_load_dwordx4 v10, s[16:19], s42 offen lds
    s_add_u32 s42, s42, 229376
    s_and_b32 s31, s28, 1
    s_lshl_b32 s31, s31, 4
    s_bfe_u32 s32, s28, 0x10001
    s_lshl_b32 s32, s32, 2
    s_add_u32 s31, s31, s32
    s_mul_i32 s32, s31, 2688
    s_lshl_b32 s33, s30, 7
    s_add_u32 s32, s32, s33
    s_mul_i32 s33, s36, 896
    s_add_u32 s43, s32, s33
    s_mul_i32 s31, s31, 3584
    s_lshl_b32 s33, s30, 8
    s_add_u32 s31, s31, s33
    s_add_u32 s45, s31, 128
    s_add_u32 s32, s32, 1792
    s_cmp_eq_u32 s36, 0
    s_cselect_b32 s44, s32, s31
    s_lshl_b32 s47, s28, 10
    s_add_u32 s47, s47, 57344
    v_mov_b32 v124, v9
    v_mov_b32 v125, v10
    v_and_b32 v2, 15, v1
    v_lshrrev_b32 v3, 4, v1
    v_xor_b32 v4, v2, v3
    v_lshl_add_u32 v4, v3, 4, v4
    v_lshlrev_b32 v4, 4, v4
    s_mul_i32 s31, s36, 28672
    v_add_u32 v126, s31, v4
    v_xor_b32 v127, 192, v126
    v_lshrrev_b32 v4, 2, v2
    v_lshl_add_u32 v4, v3, 2, v4
    v_bfe_u32 v5, v4, 1, 2
    v_lshlrev_b32 v4, 7, v4
    v_and_b32 v2, 3, v2
    v_lshl_add_u32 v4, v2, 3, v4
    v_add_u32 v4, 57344, v4
    v_xor_b32 v6, 0, v5
    v_lshl_add_u32 v128, v6, 5, v4
    v_xor_b32 v6, 1, v5
    v_lshl_add_u32 v129, v6, 5, v4
    v_xor_b32 v6, 2, v5
    v_lshl_add_u32 v130, v6, 5, v4
    v_xor_b32 v6, 3, v5
    v_lshl_add_u32 v131, v6, 5, v4
    v_mov_b32 v148, 0xc0135761
    v_mov_b32 v150, 1.0
    s_mov_b32 s6, 0xbdd2d3e8
    v_mov_b32 v149, 0xc0135761
    v_mov_b32 v151, 1.0
    s_mov_b32 s7, 0xbdd2d3e8
    s_and_b32 s31, s35, 1
    s_cmp_eq_u32 s31, 0
    s_cbranch_scc0 p1_A_hi
    v_mov_b32 v228, v128
    v_mov_b32 v229, v129
    s_branch p1_A_sel
p1_A_hi:
    v_mov_b32 v228, v130
    v_mov_b32 v229, v131
p1_A_sel:
    s_lshr_b32 s31, s35, 1
    s_lshl_b32 s31, s31, 12
    v_add_u32 v228, s31, v228
    v_add_u32 v229, s31, v229
    s_cmp_eq_u32 s35, 3
    s_cselect_b32 s31, 4, s35
    s_lshl_b32 s31, s31, 12
    v_add_u32 v152, s31, v128
    v_add_u32 v153, s31, v129
    v_add_u32 v154, s31, v130
    v_add_u32 v155, s31, v131
    s_cmp_lg_u32 s35, 0
    s_cbranch_scc1 p1_sel0
    v_add_u32 v156, 12288, v128
p1_sel0:
    s_cmp_lg_u32 s35, 1
    s_cbranch_scc1 p1_sel1
    v_add_u32 v156, 12288, v129
p1_sel1:
    s_cmp_lg_u32 s35, 2
    s_cbranch_scc1 p1_sel2
    v_add_u32 v156, 12288, v130
p1_sel2:
    s_cmp_lg_u32 s35, 3
    s_cbranch_scc1 p1_sel3
    v_add_u32 v156, 12288, v131
p1_sel3:
    v_add_u32 v230, 61440, v228
    v_add_u32 v231, 61440, v229
    v_add_u32 v157, 61440, v152
    v_add_u32 v158, 61440, v153
    v_add_u32 v159, 61440, v154
    v_add_u32 v160, 61440, v155
    v_add_u32 v161, 61440, v156
    v_and_b32 v2, 15, v1
    v_lshrrev_b32 v3, 4, v1
    s_cmp_eq_u32 s35, 2
    s_cbranch_scc1 p1_ad_v
    s_cmp_eq_u32 s35, 0
    s_cselect_b32 s59, 1, 2
    s_lshl_b32 s59, s59, 17
    v_lshrrev_b32 v4, 3, v2
    v_lshlrev_b32 v4, 4, v4
    v_and_b32 v5, 7, v2
    v_add_u32 v4, v4, v5
    v_lshlrev_b32 v4, 4, v4
    s_mov_b32 s32, 9363
    v_mov_b32 v108, 0x2606
    v_mov_b32 v109, 1
    s_lshl_b32 s31, s30, 4
    s_add_u32 s31, s31, 0
    v_add_u32 v5, s31, v3
    v_mul_u32_u24 v6, s32, v5
    v_lshrrev_b32 v6, 16, v6
    v_mul_u32_u24 v7, 7, v6
    v_sub_u32 v236, v5, v7
    v_mul_lo_u32 v232, v6, s59
    v_add_u32 v232, v232, v4
    v_and_b32 v6, 3, v6
    v_lshlrev_b32 v6, 2, v6
    v_lshrrev_b32 v6, v6, v108
    v_and_b32 v6, 7, v6
    v_cmp_gt_u32 vcc, v236, v6
    v_mov_b32 v7, v236
    v_subrev_u32 v5, 1, v236
    v_cndmask_b32 v5, v7, v5, vcc
    v_cmp_eq_u32 vcc, v236, v6
    v_mov_b32 v7, 6
    s_nop 0
    v_cndmask_b32 v5, v5, v7, vcc
    v_cndmask_b32 v236, 0, v109, vcc
    v_lshrrev_b32 v6, 1, v5
    v_lshl_add_u32 v232, v6, 9, v232
    v_and_b32 v5, 1, v5
    v_lshl_add_u32 v232, v5, 3, v232
    s_lshl_b32 s31, s30, 4
    s_add_u32 s31, s31, 4
    v_add_u32 v5, s31, v3
    v_mul_u32_u24 v6, s32, v5
    v_lshrrev_b32 v6, 16, v6
    v_mul_u32_u24 v7, 7, v6
    v_sub_u32 v237, v5, v7
    v_mul_lo_u32 v233, v6, s59
    v_add_u32 v233, v233, v4
    v_and_b32 v6, 3, v6
    v_lshlrev_b32 v6, 2, v6
    v_lshrrev_b32 v6, v6, v108
    v_and_b32 v6, 7, v6
    v_cmp_gt_u32 vcc, v237, v6
    v_mov_b32 v7, v237
    v_subrev_u32 v5, 1, v237
    v_cndmask_b32 v5, v7, v5, vcc
    v_cmp_eq_u32 vcc, v237, v6
    v_mov_b32 v7, 6
    s_nop 0
    v_cndmask_b32 v5, v5, v7, vcc
    v_cndmask_b32 v237, 0, v109, vcc
    v_lshrrev_b32 v6, 1, v5
    v_lshl_add_u32 v233, v6, 9, v233
    v_and_b32 v5, 1, v5
    v_lshl_add_u32 v233, v5, 3, v233
    s_lshl_b32 s31, s30, 4
    s_add_u32 s31, s31, 8
    v_add_u32 v5, s31, v3
    v_mul_u32_u24 v6, s32, v5
    v_lshrrev_b32 v6, 16, v6
    v_mul_u32_u24 v7, 7, v6
    v_sub_u32 v238, v5, v7
    v_mul_lo_u32 v234, v6, s59
    v_add_u32 v234, v234, v4
    v_and_b32 v6, 3, v6
    v_lshlrev_b32 v6, 2, v6
    v_lshrrev_b32 v6, v6, v108
    v_and_b32 v6, 7, v6
    v_cmp_gt_u32 vcc, v238, v6
    v_mov_b32 v7, v238
    v_subrev_u32 v5, 1, v238
    v_cndmask_b32 v5, v7, v5, vcc
    v_cmp_eq_u32 vcc, v238, v6
    v_mov_b32 v7, 6
    s_nop 0
    v_cndmask_b32 v5, v5, v7, vcc
    v_cndmask_b32 v238, 0, v109, vcc
    v_lshrrev_b32 v6, 1, v5
    v_lshl_add_u32 v234, v6, 9, v234
    v_and_b32 v5, 1, v5
    v_lshl_add_u32 v234, v5, 3, v234
    s_lshl_b32 s31, s30, 4
    s_add_u32 s31, s31, 12
    v_add_u32 v5, s31, v3
    v_mul_u32_u24 v6, s32, v5
    v_lshrrev_b32 v6, 16, v6
    v_mul_u32_u24 v7, 7, v6
    v_sub_u32 v239, v5, v7
    v_mul_lo_u32 v235, v6, s59
    v_add_u32 v235, v235, v4
    v_and_b32 v6, 3, v6
    v_lshlrev_b32 v6, 2, v6
    v_lshrrev_b32 v6, v6, v108
    v_and_b32 v6, 7, v6
    v_cmp_gt_u32 vcc, v239, v6
    v_mov_b32 v7, v239
    v_subrev_u32 v5, 1, v239
    v_cndmask_b32 v5, v7, v5, vcc
    v_cmp_eq_u32 vcc, v239, v6
    v_mov_b32 v7, 6
    s_nop 0
    v_cndmask_b32 v5, v5, v7, vcc
    v_cndmask_b32 v239, 0, v109, vcc
    v_lshrrev_b32 v6, 1, v5
    v_lshl_add_u32 v235, v6, 9, v235
    v_and_b32 v5, 1, v5
    v_lshl_add_u32 v235, v5, 3, v235
    s_branch p1_ad_done
p1_ad_v:
    v_lshrrev_b32 v4, 1, v3
    v_lshlrev_b32 v4, 10, v4
    v_and_b32 v5, 1, v3
    v_lshl_add_u32 v4, v5, 9, v4
    s_mov_b32 s32, 2341
    s_lshl_b32 s31, s30, 6
    s_add_u32 s31, s31, 0
    v_add_u32 v5, s31, v2
    v_mul_u32_u24 v6, s32, v5
    v_lshrrev_b32 v6, 16, v6
    v_mul_u32_u24 v7, 28, v6
    v_sub_u32 v236, v5, v7
    v_lshlrev_b32 v232, 18, v6
    v_add_u32 v232, v232, v4
    v_lshl_add_u32 v232, v236, 4, v232
    s_lshl_b32 s31, s30, 6
    s_add_u32 s31, s31, 16
    v_add_u32 v5, s31, v2
    v_mul_u32_u24 v6, s32, v5
    v_lshrrev_b32 v6, 16, v6
    v_mul_u32_u24 v7, 28, v6
    v_sub_u32 v237, v5, v7
    v_lshlrev_b32 v233, 18, v6
    v_add_u32 v233, v233, v4
    v_lshl_add_u32 v233, v237, 4, v233
    s_lshl_b32 s31, s30, 6
    s_add_u32 s31, s31, 32
    v_add_u32 v5, s31, v2
    v_mul_u32_u24 v6, s32, v5
    v_lshrrev_b32 v6, 16, v6
    v_mul_u32_u24 v7, 28, v6
    v_sub_u32 v238, v5, v7
    v_lshlrev_b32 v234, 18, v6
    v_add_u32 v234, v234, v4
    v_lshl_add_u32 v234, v238, 4, v234
    s_lshl_b32 s31, s30, 6
    s_add_u32 s31, s31, 48
    v_add_u32 v5, s31, v2
    v_mul_u32_u24 v6, s32, v5
    v_lshrrev_b32 v6, 16, v6
    v_mul_u32_u24 v7, 28, v6
    v_sub_u32 v239, v5, v7
    v_lshlrev_b32 v235, 18, v6
    v_add_u32 v235, v235, v4
    v_lshl_add_u32 v235, v239, 4, v235
p1_ad_done:
    v_lshrrev_b32 v2, 3, v1
    v_and_b32 v3, 3, v2
    s_and_b32 s31, s28, 3
    s_lshl_b32 s31, s31, 2
    v_add_u32 v3, s31, v3
    v_and_b32 v4, 3, v1
    v_bfe_u32 v5, v1, 2, 1
    v_xor_b32 v3, v3, v4
    v_mul_u32_u24 v6, 12, v5
    v_xor_b32 v3, v3, v6
    v_lshl_add_u32 v3, v4, 4, v3
    v_lshlrev_b32 v3, 4, v3
    v_lshl_add_u32 v3, v5, 10, v3
    v_lshrrev_b32 v2, 2, v2
    s_lshl_b32 s31, s36, 1
    v_add_u32 v2, s31, v2
    v_mul_u32_u24 v2, 14336, v2
    v_add_u32 v240, v3, v2
    s_waitcnt vmcnt(4)
    v_lshlrev_b32 v52, 16, v12
    v_and_b32 v53, 0xffff0000, v12
    v_lshlrev_b32 v54, 16, v13
    v_and_b32 v55, 0xffff0000, v13
    v_pk_add_f32 v[242:243], v[52:53], v[54:55]
    v_pk_mul_f32 v[244:245], v[52:53], v[52:53]
    v_pk_fma_f32 v[244:245], v[54:55], v[54:55], v[244:245]
    v_lshlrev_b32 v56, 16, v14
    v_and_b32 v57, 0xffff0000, v14
    v_pk_add_f32 v[242:243], v[242:243], v[56:57]
    v_pk_fma_f32 v[244:245], v[56:57], v[56:57], v[244:245]
    v_lshlrev_b32 v58, 16, v15
    v_and_b32 v59, 0xffff0000, v15
    v_pk_add_f32 v[242:243], v[242:243], v[58:59]
    v_pk_fma_f32 v[244:245], v[58:59], v[58:59], v[244:245]
    v_lshlrev_b32 v60, 16, v16
    v_and_b32 v61, 0xffff0000, v16
    v_pk_add_f32 v[242:243], v[242:243], v[60:61]
    v_pk_fma_f32 v[244:245], v[60:61], v[60:61], v[244:245]
    s_add_u32 m0, s46, 40960
    s_nop 0
    buffer_load_dwordx4 v10, s[16:19], s41 offen lds
    s_add_u32 s41, s41, 229376
    v_lshlrev_b32 v62, 16, v17
    v_and_b32 v63, 0xffff0000, v17
    v_pk_add_f32 v[242:243], v[242:243], v[62:63]
    v_pk_fma_f32 v[244:245], v[62:63], v[62:63], v[244:245]
    v_lshlrev_b32 v64, 16, v18
    v_and_b32 v65, 0xffff0000, v18
    v_pk_add_f32 v[242:243], v[242:243], v[64:65]
    v_pk_fma_f32 v[244:245], v[64:65], v[64:65], v[244:245]
    v_lshlrev_b32 v66, 16, v19
    v_and_b32 v67, 0xffff0000, v19
    v_pk_add_f32 v[242:243], v[242:243], v[66:67]
    v_pk_fma_f32 v[244:245], v[66:67], v[66:67], v[244:245]
    v_lshlrev_b32 v68, 16, v20
    v_and_b32 v69, 0xffff0000, v20
    v_pk_add_f32 v[242:243], v[242:243], v[68:69]
    v_pk_fma_f32 v[244:245], v[68:69], v[68:69], v[244:245]
    v_lshlrev_b32 v70, 16, v21
    v_and_b32 v71, 0xffff0000, v21
    v_pk_add_f32 v[242:243], v[242:243], v[70:71]
    v_pk_fma_f32 v[244:245], v[70:71], v[70:71], v[244:245]
    v_lshlrev_b32 v72, 16, v22
    v_and_b32 v73, 0xffff0000, v22
    v_pk_add_f32 v[242:243], v[242:243], v[72:73]
    v_pk_fma_f32 v[244:245], v[72:73], v[72:73], v[244:245]
    v_lshlrev_b32 v74, 16, v23
    v_and_b32 v75, 0xffff0000, v23
    v_pk_add_f32 v[242:243], v[242:243], v[74:75]
    v_pk_fma_f32 v[244:245], v[74:75], v[74:75], v[244:245]
    v_lshlrev_b32 v76, 16, v24
    v_and_b32 v77, 0xffff0000, v24
    v_pk_add_f32 v[242:243], v[242:243], v[76:77]
    v_pk_fma_f32 v[244:245], v[76:77], v[76:77], v[244:245]
    s_add_u32 m0, s46, 41984
    s_nop 0
    buffer_load_dwordx4 v10, s[16:19], s42 offen lds
    s_add_u32 s42, s42, 229376
    v_lshlrev_b32 v78, 16, v25
    v_and_b32 v79, 0xffff0000, v25
    v_pk_add_f32 v[242:243], v[242:243], v[78:79]
    v_pk_fma_f32 v[244:245], v[78:79], v[78:79], v[244:245]
    v_lshlrev_b32 v80, 16, v26
    v_and_b32 v81, 0xffff0000, v26
    v_pk_add_f32 v[242:243], v[242:243], v[80:81]
    v_pk_fma_f32 v[244:245], v[80:81], v[80:81], v[244:245]
    v_lshlrev_b32 v82, 16, v27
    v_and_b32 v83, 0xffff0000, v27
    v_pk_add_f32 v[242:243], v[242:243], v[82:83]
    v_pk_fma_f32 v[244:245], v[82:83], v[82:83], v[244:245]
    v_lshlrev_b32 v84, 16, v28
    v_and_b32 v85, 0xffff0000, v28
    v_pk_add_f32 v[242:243], v[242:243], v[84:85]
    v_pk_fma_f32 v[244:245], v[84:85], v[84:85], v[244:245]
    v_lshlrev_b32 v86, 16, v29
    v_and_b32 v87, 0xffff0000, v29
    v_pk_add_f32 v[242:243], v[242:243], v[86:87]
    v_pk_fma_f32 v[244:245], v[86:87], v[86:87], v[244:245]
    v_lshlrev_b32 v88, 16, v30
    v_and_b32 v89, 0xffff0000, v30
    v_pk_add_f32 v[242:243], v[242:243], v[88:89]
    v_pk_fma_f32 v[244:245], v[88:89], v[88:89], v[244:245]
    v_lshlrev_b32 v90, 16, v31
    v_and_b32 v91, 0xffff0000, v31
    v_pk_add_f32 v[242:243], v[242:243], v[90:91]
    v_pk_fma_f32 v[244:245], v[90:91], v[90:91], v[244:245]
    v_lshlrev_b32 v92, 16, v32
    v_and_b32 v93, 0xffff0000, v32
    v_pk_add_f32 v[242:243], v[242:243], v[92:93]
    v_pk_fma_f32 v[244:245], v[92:93], v[92:93], v[244:245]
    s_add_u32 m0, s46, 61440
    s_nop 0
    buffer_load_dwordx4 v10, s[16:19], s41 offen lds
    s_add_u32 s41, s41, 229376
    v_lshlrev_b32 v94, 16, v33
    v_and_b32 v95, 0xffff0000, v33
    v_pk_add_f32 v[242:243], v[242:243], v[94:95]
    v_pk_fma_f32 v[244:245], v[94:95], v[94:95], v[244:245]
    v_lshlrev_b32 v96, 16, v34
    v_and_b32 v97, 0xffff0000, v34
    v_pk_add_f32 v[242:243], v[242:243], v[96:97]
    v_pk_fma_f32 v[244:245], v[96:97], v[96:97], v[244:245]
    v_lshlrev_b32 v98, 16, v35
    v_and_b32 v99, 0xffff0000, v35
    v_pk_add_f32 v[242:243], v[242:243], v[98:99]
    v_pk_fma_f32 v[244:245], v[98:99], v[98:99], v[244:245]
    v_lshlrev_b32 v100, 16, v36
    v_and_b32 v101, 0xffff0000, v36
    v_pk_add_f32 v[242:243], v[242:243], v[100:101]
    v_pk_fma_f32 v[244:245], v[100:101], v[100:101], v[244:245]
    v_lshlrev_b32 v102, 16, v37
    v_and_b32 v103, 0xffff0000, v37
    v_pk_add_f32 v[242:243], v[242:243], v[102:103]
    v_pk_fma_f32 v[244:245], v[102:103], v[102:103], v[244:245]
    v_lshlrev_b32 v104, 16, v38
    v_and_b32 v105, 0xffff0000, v38
    v_pk_add_f32 v[242:243], v[242:243], v[104:105]
    v_pk_fma_f32 v[244:245], v[104:105], v[104:105], v[244:245]
    v_lshlrev_b32 v106, 16, v39
    v_and_b32 v107, 0xffff0000, v39
    v_pk_add_f32 v[242:243], v[242:243], v[106:107]
    v_pk_fma_f32 v[244:245], v[106:107], v[106:107], v[244:245]
    v_add_f32 v242, v242, v243
    v_add_f32 v244, v244, v245
    s_nop 0
    v_add_f32_dpp v242, v242, v242 quad_perm:[1,0,3,2] row_mask:0xf bank_mask:0xf
    v_add_f32_dpp v244, v244, v244 quad_perm:[1,0,3,2] row_mask:0xf bank_mask:0xf
    s_nop 0
    v_add_f32_dpp v242, v242, v242 quad_perm:[2,3,0,1] row_mask:0xf bank_mask:0xf
    v_add_f32_dpp v244, v244, v244 quad_perm:[2,3,0,1] row_mask:0xf bank_mask:0xf
    s_nop 0
    v_add_f32_dpp v242, v242, v242 row_half_mirror row_mask:0xf bank_mask:0xf
    v_add_f32_dpp v244, v244, v244 row_half_mirror row_mask:0xf bank_mask:0xf
    v_mul_f32 v242, 0x3b124925, v242
    v_mul_f32 v244, 0x3b124925, v244
    v_fma_f32 v244, -v242, v242, v244
    v_max_f32 v244, 0, v244
    v_add_f32 v244, 0x3727c5ac, v244
    v_rsq_f32 v246, v244
    s_add_u32 m0, s46, 62464
    s_nop 0
    buffer_load_dwordx4 v10, s[16:19], s42 offen lds
    s_add_u32 s42, s42, 229376
    v_mov_b32 v247, v246
    v_mul_f32 v248, -v242, v246
    v_mov_b32 v249, v248
    v_pk_fma_f32 v[52:53], v[52:53], v[246:247], v[248:249]
    v_pk_fma_f32 v[54:55], v[54:55], v[246:247], v[248:249]
    v_pk_fma_f32 v[56:57], v[56:57], v[246:247], v[248:249]
    v_pk_fma_f32 v[58:59], v[58:59], v[246:247], v[248:249]
    v_cvt_pk_bf16_f32 v12, v52, v53
    v_cvt_pk_bf16_f32 v13, v54, v55
    v_cvt_pk_bf16_f32 v14, v56, v57
    v_cvt_pk_bf16_f32 v15, v58, v59
    ds_write_b128 v240, v[12:15] offset:0
    v_pk_fma_f32 v[60:61], v[60:61], v[246:247], v[248:249]
    v_pk_fma_f32 v[62:63], v[62:63], v[246:247], v[248:249]
    v_pk_fma_f32 v[64:65], v[64:65], v[246:247], v[248:249]
    v_pk_fma_f32 v[66:67], v[66:67], v[246:247], v[248:249]
    v_cvt_pk_bf16_f32 v16, v60, v61
    v_cvt_pk_bf16_f32 v17, v62, v63
    v_cvt_pk_bf16_f32 v18, v64, v65
    v_cvt_pk_bf16_f32 v19, v66, v67
    ds_write_b128 v240, v[16:19] offset:2048
    s_add_u32 m0, s46, 81920
    s_nop 0
    buffer_load_dwordx4 v10, s[16:19], s41 offen lds
    s_add_u32 s41, s41, 229376
    v_pk_fma_f32 v[68:69], v[68:69], v[246:247], v[248:249]
    v_pk_fma_f32 v[70:71], v[70:71], v[246:247], v[248:249]
    v_pk_fma_f32 v[72:73], v[72:73], v[246:247], v[248:249]
    v_pk_fma_f32 v[74:75], v[74:75], v[246:247], v[248:249]
    v_cvt_pk_bf16_f32 v20, v68, v69
    v_cvt_pk_bf16_f32 v21, v70, v71
    v_cvt_pk_bf16_f32 v22, v72, v73
    v_cvt_pk_bf16_f32 v23, v74, v75
    ds_write_b128 v240, v[20:23] offset:4096
    v_pk_fma_f32 v[76:77], v[76:77], v[246:247], v[248:249]
    v_pk_fma_f32 v[78:79], v[78:79], v[246:247], v[248:249]
    v_pk_fma_f32 v[80:81], v[80:81], v[246:247], v[248:249]
    v_pk_fma_f32 v[82:83], v[82:83], v[246:247], v[248:249]
    v_cvt_pk_bf16_f32 v24, v76, v77
    v_cvt_pk_bf16_f32 v25, v78, v79
    v_cvt_pk_bf16_f32 v26, v80, v81
    v_cvt_pk_bf16_f32 v27, v82, v83
    ds_write_b128 v240, v[24:27] offset:6144
    s_add_u32 m0, s46, 82944
    s_nop 0
    buffer_load_dwordx4 v10, s[16:19], s42 offen lds
    s_add_u32 s42, s42, 229376
    v_pk_fma_f32 v[84:85], v[84:85], v[246:247], v[248:249]
    v_pk_fma_f32 v[86:87], v[86:87], v[246:247], v[248:249]
    v_pk_fma_f32 v[88:89], v[88:89], v[246:247], v[248:249]
    v_pk_fma_f32 v[90:91], v[90:91], v[246:247], v[248:249]
    v_cvt_pk_bf16_f32 v28, v84, v85
    v_cvt_pk_bf16_f32 v29, v86, v87
    v_cvt_pk_bf16_f32 v30, v88, v89
    v_cvt_pk_bf16_f32 v31, v90, v91
    ds_write_b128 v240, v[28:31] offset:8192
    v_pk_fma_f32 v[92:93], v[92:93], v[246:247], v[248:249]
    v_pk_fma_f32 v[94:95], v[94:95], v[246:247], v[248:249]
    v_pk_fma_f32 v[96:97], v[96:97], v[246:247], v[248:249]
    v_pk_fma_f32 v[98:99], v[98:99], v[246:247], v[248:249]
    v_cvt_pk_bf16_f32 v32, v92, v93
    v_cvt_pk_bf16_f32 v33, v94, v95
    v_cvt_pk_bf16_f32 v34, v96, v97
    v_cvt_pk_bf16_f32 v35, v98, v99
    ds_write_b128 v240, v[32:35] offset:10240
    v_pk_fma_f32 v[100:101], v[100:101], v[246:247], v[248:249]
    v_pk_fma_f32 v[102:103], v[102:103], v[246:247], v[248:249]
    v_pk_fma_f32 v[104:105], v[104:105], v[246:247], v[248:249]
    v_pk_fma_f32 v[106:107], v[106:107], v[246:247], v[248:249]
    v_cvt_pk_bf16_f32 v36, v100, v101
    v_cvt_pk_bf16_f32 v37, v102, v103
    v_cvt_pk_bf16_f32 v38, v104, v105
    v_cvt_pk_bf16_f32 v39, v106, v107
    ds_write_b128 v240, v[36:39] offset:12288
    s_waitcnt vmcnt(8) lgkmcnt(0)
    s_barrier
    ds_read_b128 v[164:167], v126 offset:0
    ds_read_b128 v[168:171], v126 offset:14336
    ds_read_b64_tr_b16 v[196:197], v228 offset:0
    ds_read_b64_tr_b16 v[198:199], v228 offset:2048
    ds_read_b64_tr_b16 v[200:201], v229 offset:0
    ds_read_b64_tr_b16 v[202:203], v229 offset:2048
    ds_read_b128 v[172:175], v127 offset:1024
    ds_read_b128 v[176:179], v127 offset:15360
    ds_read_b64_tr_b16 v[204:205], v228 offset:8192
    ds_read_b64_tr_b16 v[206:207], v228 offset:10240
    ds_read_b64_tr_b16 v[208:209], v229 offset:8192
    ds_read_b64_tr_b16 v[210:211], v229 offset:10240
    s_waitcnt lgkmcnt(0)
    s_cmp_lg_u32 s36, 0
    s_cbranch_scc1 p1_A_1
    s_waitcnt vmcnt(6)
    s_barrier
    v_mfma_f32_16x16x32_bf16 v[132:135], v[164:167], v[196:199], 0
    ds_read_b128 v[180:183], v126 offset:2048
    ds_read_b128 v[184:187], v126 offset:16384
    v_mfma_f32_16x16x32_bf16 v[136:139], v[168:171], v[196:199], 0
    s_add_u32 m0, s46, 0
    s_nop 0
    buffer_load_dwordx4 v10, s[16:19], s41 offen lds
    s_add_u32 s41, s41, 229376
    v_mfma_f32_16x16x32_bf16 v[140:143], v[164:167], v[200:203], 0
    ds_read_b64_tr_b16 v[212:213], v228 offset:20480
    ds_read_b64_tr_b16 v[214:215], v228 offset:22528
    v_mfma_f32_16x16x32_bf16 v[144:147], v[168:171], v[200:203], 0
    ds_read_b64_tr_b16 v[216:217], v229 offset:20480
    ds_read_b64_tr_b16 v[218:219], v229 offset:22528
    v_mfma_f32_16x16x32_bf16 v[132:135], v[172:175], v[204:207], v[132:135]
    s_add_u32 m0, s46, 1024
    s_nop 0
    buffer_load_dwordx4 v10, s[16:19], s42 offen lds
    s_add_u32 s42, s42, 229376
    v_mfma_f32_16x16x32_bf16 v[136:139], v[176:179], v[204:207], v[136:139]
    ds_read_b128 v[188:191], v127 offset:3072
    ds_read_b128 v[192:195], v127 offset:17408
    v_mfma_f32_16x16x32_bf16 v[140:143], v[172:175], v[208:211], v[140:143]
    ds_read_b64_tr_b16 v[220:221], v228 offset:28672
    ds_read_b64_tr_b16 v[222:223], v228 offset:30720
    v_mfma_f32_16x16x32_bf16 v[144:147], v[176:179], v[208:211], v[144:147]
    ds_read_b64_tr_b16 v[224:225], v229 offset:28672
    ds_read_b64_tr_b16 v[226:227], v229 offset:30720
    s_waitcnt lgkmcnt(0)
    s_waitcnt vmcnt(6)
    s_barrier
    v_mfma_f32_16x16x32_bf16 v[132:135], v[180:183], v[212:215], v[132:135]
    ds_read_b128 v[164:167], v126 offset:4096
    ds_read_b128 v[168:171], v126 offset:18432
    v_mfma_f32_16x16x32_bf16 v[136:139], v[184:187], v[212:215], v[136:139]
    s_add_u32 m0, s46, 20480
    s_nop 0
    buffer_load_dwordx4 v10, s[16:19], s41 offen lds
    s_add_u32 s41, s41, 229376
    v_mfma_f32_16x16x32_bf16 v[140:143], v[180:183], v[216:219], v[140:143]
    ds_read_b64_tr_b16 v[196:197], v228 offset:40960
    ds_read_b64_tr_b16 v[198:199], v228 offset:43008
    v_mfma_f32_16x16x32_bf16 v[144:147], v[184:187], v[216:219], v[144:147]
    ds_read_b64_tr_b16 v[200:201], v229 offset:40960
    ds_read_b64_tr_b16 v[202:203], v229 offset:43008
    v_mfma_f32_16x16x32_bf16 v[132:135], v[188:191], v[220:223], v[132:135]
    s_add_u32 m0, s46, 21504
    s_nop 0
    buffer_load_dwordx4 v10, s[16:19], s42 offen lds
    s_add_u32 s42, s42, 229376
    v_mfma_f32_16x16x32_bf16 v[136:139], v[192:195], v[220:223], v[136:139]
    ds_read_b128 v[172:175], v127 offset:5120
    ds_read_b128 v[176:179], v127 offset:19456
    v_mfma_f32_16x16x32_bf16 v[140:143], v[188:191], v[224:227], v[140:143]
    ds_read_b64_tr_b16 v[204:205], v228 offset:49152
    ds_read_b64_tr_b16 v[206:207], v228 offset:51200
    v_mfma_f32_16x16x32_bf16 v[144:147], v[192:195], v[224:227], v[144:147]
    ds_read_b64_tr_b16 v[208:209], v229 offset:49152
    ds_read_b64_tr_b16 v[210:211], v229 offset:51200
    s_waitcnt lgkmcnt(0)
    s_waitcnt vmcnt(6)
    s_barrier
    v_mfma_f32_16x16x32_bf16 v[132:135], v[164:167], v[196:199], v[132:135]
    ds_read_b128 v[180:183], v126 offset:6144
    ds_read_b128 v[184:187], v126 offset:20480
    v_mfma_f32_16x16x32_bf16 v[136:139], v[168:171], v[196:199], v[136:139]
    s_add_u32 m0, s47, 40960
    s_nop 0
    buffer_load_dwordx4 v124, s[12:15], s43 offen lds
    v_mfma_f32_16x16x32_bf16 v[140:143], v[164:167], v[200:203], v[140:143]
    ds_read_b64_tr_b16 v[212:213], v230 offset:0
    ds_read_b64_tr_b16 v[214:215], v230 offset:2048
    v_mfma_f32_16x16x32_bf16 v[144:147], v[168:171], v[200:203], v[144:147]
    ds_read_b64_tr_b16 v[216:217], v231 offset:0
    ds_read_b64_tr_b16 v[218:219], v231 offset:2048
    v_mfma_f32_16x16x32_bf16 v[132:135], v[172:175], v[204:207], v[132:135]
    s_add_u32 m0, s47, 49152
    s_nop 0
    buffer_load_dwordx4 v124, s[12:15], s44 offen lds
    v_add_u32 v124, 86016, v124
    v_mfma_f32_16x16x32_bf16 v[136:139], v[176:179], v[204:207], v[136:139]
    ds_read_b128 v[188:191], v127 offset:7168
    ds_read_b128 v[192:195], v127 offset:21504
    v_mfma_f32_16x16x32_bf16 v[140:143], v[172:175], v[208:211], v[140:143]
    s_add_u32 m0, s47, 57344
    s_nop 0
    buffer_load_dwordx4 v125, s[16:19], s45 offen lds
    v_add_u32 v125, 114688, v125
    v_mfma_f32_16x16x32_bf16 v[144:147], v[176:179], v[208:211], v[144:147]
    ds_read_b64_tr_b16 v[220:221], v230 offset:8192
    ds_read_b64_tr_b16 v[222:223], v230 offset:10240
    ds_read_b64_tr_b16 v[224:225], v231 offset:8192
    ds_read_b64_tr_b16 v[226:227], v231 offset:10240
    s_waitcnt lgkmcnt(0)
    s_waitcnt vmcnt(7)
    s_barrier
    v_mfma_f32_16x16x32_bf16 v[132:135], v[180:183], v[212:215], v[132:135]
    ds_read_b128 v[164:167], v126 offset:8192
    ds_read_b128 v[168:171], v126 offset:22528
    v_mfma_f32_16x16x32_bf16 v[136:139], v[184:187], v[212:215], v[136:139]
    s_add_u32 m0, s47, 61440
    s_nop 0
    buffer_load_dwordx4 v124, s[12:15], s43 offen lds
    v_mfma_f32_16x16x32_bf16 v[140:143], v[180:183], v[216:219], v[140:143]
    ds_read_b64_tr_b16 v[196:197], v230 offset:20480
    ds_read_b64_tr_b16 v[198:199], v230 offset:22528
    v_mfma_f32_16x16x32_bf16 v[144:147], v[184:187], v[216:219], v[144:147]
    ds_read_b64_tr_b16 v[200:201], v231 offset:20480
    ds_read_b64_tr_b16 v[202:203], v231 offset:22528
    v_mfma_f32_16x16x32_bf16 v[132:135], v[188:191], v[220:223], v[132:135]
    s_add_u32 m0, s47, 69632
    s_nop 0
    buffer_load_dwordx4 v124, s[12:15], s44 offen lds
    v_add_u32 v124, 86016, v124
    v_mfma_f32_16x16x32_bf16 v[136:139], v[192:195], v[220:223], v[136:139]
    ds_read_b128 v[172:175], v127 offset:9216
    ds_read_b128 v[176:179], v127 offset:23552
    v_mfma_f32_16x16x32_bf16 v[140:143], v[188:191], v[224:227], v[140:143]
    s_add_u32 m0, s47, 77824
    s_nop 0
    buffer_load_dwordx4 v125, s[16:19], s45 offen lds
    v_add_u32 v125, 114688, v125
    v_mfma_f32_16x16x32_bf16 v[144:147], v[192:195], v[224:227], v[144:147]
    ds_read_b64_tr_b16 v[204:205], v230 offset:28672
    ds_read_b64_tr_b16 v[206:207], v230 offset:30720
    ds_read_b64_tr_b16 v[208:209], v231 offset:28672
    ds_read_b64_tr_b16 v[210:211], v231 offset:30720
    s_waitcnt lgkmcnt(0)
    s_waitcnt vmcnt(8)
    s_barrier
    v_mfma_f32_16x16x32_bf16 v[132:135], v[164:167], v[196:199], v[132:135]
    ds_read_b128 v[180:183], v126 offset:10240
    ds_read_b128 v[184:187], v126 offset:24576
    v_mfma_f32_16x16x32_bf16 v[136:139], v[168:171], v[196:199], v[136:139]
    s_add_u32 m0, s47, 81920
    s_nop 0
    buffer_load_dwordx4 v124, s[12:15], s43 offen lds
    v_mfma_f32_16x16x32_bf16 v[140:143], v[164:167], v[200:203], v[140:143]
    ds_read_b64_tr_b16 v[212:213], v228 offset:0
    ds_read_b64_tr_b16 v[214:215], v228 offset:2048
    v_mfma_f32_16x16x32_bf16 v[144:147], v[168:171], v[200:203], v[144:147]
    ds_read_b64_tr_b16 v[216:217], v229 offset:0
    ds_read_b64_tr_b16 v[218:219], v229 offset:2048
    v_mfma_f32_16x16x32_bf16 v[132:135], v[172:175], v[204:207], v[132:135]
    s_add_u32 m0, s47, 90112
    s_nop 0
    buffer_load_dwordx4 v124, s[12:15], s44 offen lds
    v_add_u32 v124, 86016, v124
    v_mfma_f32_16x16x32_bf16 v[136:139], v[176:179], v[204:207], v[136:139]
    ds_read_b128 v[188:191], v127 offset:11264
    ds_read_b128 v[192:195], v127 offset:25600
    v_mfma_f32_16x16x32_bf16 v[140:143], v[172:175], v[208:211], v[140:143]
    s_add_u32 m0, s47, 98304
    s_nop 0
    buffer_load_dwordx4 v125, s[16:19], s45 offen lds
    v_add_u32 v125, 114688, v125
    v_mfma_f32_16x16x32_bf16 v[144:147], v[176:179], v[208:211], v[144:147]
    ds_read_b64_tr_b16 v[220:221], v228 offset:8192
    ds_read_b64_tr_b16 v[222:223], v228 offset:10240
    ds_read_b64_tr_b16 v[224:225], v229 offset:8192
    ds_read_b64_tr_b16 v[226:227], v229 offset:10240
    s_waitcnt lgkmcnt(0)
    s_waitcnt vmcnt(9)
    s_barrier
    v_mfma_f32_16x16x32_bf16 v[132:135], v[180:183], v[212:215], v[132:135]
    ds_read_b128 v[164:167], v126 offset:12288
    ds_read_b128 v[168:171], v126 offset:26624
    v_mfma_f32_16x16x32_bf16 v[136:139], v[184:187], v[212:215], v[136:139]
    s_add_u32 m0, s47, 0
    s_nop 0
    buffer_load_dwordx4 v124, s[12:15], s43 offen lds
    v_mfma_f32_16x16x32_bf16 v[140:143], v[180:183], v[216:219], v[140:143]
    ds_read_b64_tr_b16 v[196:197], v228 offset:20480
    ds_read_b64_tr_b16 v[198:199], v228 offset:22528
    v_mfma_f32_16x16x32_bf16 v[144:147], v[184:187], v[216:219], v[144:147]
    ds_read_b64_tr_b16 v[200:201], v229 offset:20480
    ds_read_b64_tr_b16 v[202:203], v229 offset:22528
    v_mfma_f32_16x16x32_bf16 v[132:135], v[188:191], v[220:223], v[132:135]
    s_add_u32 m0, s47, 8192
    s_nop 0
    buffer_load_dwordx4 v124, s[12:15], s44 offen lds
    v_add_u32 v124, 86016, v124
    v_mfma_f32_16x16x32_bf16 v[136:139], v[192:195], v[220:223], v[136:139]
    ds_read_b128 v[172:175], v127 offset:13312
    ds_read_b128 v[176:179], v127 offset:27648
    v_mfma_f32_16x16x32_bf16 v[140:143], v[188:191], v[224:227], v[140:143]
    s_add_u32 m0, s47, 16384
    s_nop 0
    buffer_load_dwordx4 v125, s[16:19], s45 offen lds
    v_add_u32 v125, 114688, v125
    v_mfma_f32_16x16x32_bf16 v[144:147], v[192:195], v[224:227], v[144:147]
    ds_read_b64_tr_b16 v[204:205], v228 offset:28672
    ds_read_b64_tr_b16 v[206:207], v228 offset:30720
    ds_read_b64_tr_b16 v[208:209], v229 offset:28672
    ds_read_b64_tr_b16 v[210:211], v229 offset:30720
    s_waitcnt lgkmcnt(0)
    s_waitcnt vmcnt(9)
    s_barrier
    v_mfma_f32_16x16x32_bf16 v[132:135], v[164:167], v[196:199], v[132:135]
    ds_read_b128 v[52:55], v126 offset:0
    ds_read_b128 v[56:59], v126 offset:14336
    v_mfma_f32_16x16x32_bf16 v[136:139], v[168:171], v[196:199], v[136:139]
    s_add_u32 m0, s47, 20480
    s_nop 0
    buffer_load_dwordx4 v124, s[12:15], s43 offen lds
    v_mfma_f32_16x16x32_bf16 v[140:143], v[164:167], v[200:203], v[140:143]
    ds_read_b64_tr_b16 v[68:69], v152 offset:40960
    ds_read_b64_tr_b16 v[70:71], v152 offset:43008
    v_mfma_f32_16x16x32_bf16 v[144:147], v[168:171], v[200:203], v[144:147]
    ds_read_b64_tr_b16 v[72:73], v153 offset:40960
    ds_read_b64_tr_b16 v[74:75], v153 offset:43008
    v_mfma_f32_16x16x32_bf16 v[132:135], v[172:175], v[204:207], v[132:135]
    s_add_u32 m0, s47, 28672
    s_nop 0
    buffer_load_dwordx4 v124, s[12:15], s44 offen lds
    v_add_u32 v124, 86016, v124
    v_mfma_f32_16x16x32_bf16 v[136:139], v[176:179], v[204:207], v[136:139]
    ds_read_b64_tr_b16 v[76:77], v154 offset:40960
    ds_read_b64_tr_b16 v[78:79], v154 offset:43008
    v_mfma_f32_16x16x32_bf16 v[140:143], v[172:175], v[208:211], v[140:143]
    s_add_u32 m0, s47, 36864
    s_nop 0
    buffer_load_dwordx4 v125, s[16:19], s45 offen lds
    v_add_u32 v125, 114688, v125
    v_mfma_f32_16x16x32_bf16 v[144:147], v[176:179], v[208:211], v[144:147]
    ds_read_b64_tr_b16 v[80:81], v155 offset:40960
    ds_read_b64_tr_b16 v[82:83], v155 offset:43008
    ds_read_b64_tr_b16 v[84:85], v156 offset:40960
    ds_read_b64_tr_b16 v[86:87], v156 offset:43008
    s_waitcnt lgkmcnt(0)
    s_branch p1_A_done
p1_A_1:
    s_waitcnt vmcnt(6)
    s_barrier
    v_mfma_f32_16x16x32_bf16 v[132:135], v[164:167], v[196:199], 0
    ds_read_b128 v[180:183], v126 offset:2048
    ds_read_b128 v[184:187], v126 offset:16384
    v_mfma_f32_16x16x32_bf16 v[136:139], v[168:171], v[196:199], 0
    ds_read_b64_tr_b16 v[212:213], v228 offset:20480
    ds_read_b64_tr_b16 v[214:215], v228 offset:22528
    v_mfma_f32_16x16x32_bf16 v[140:143], v[164:167], v[200:203], 0
    s_add_u32 m0, s46, 0
    s_nop 0
    buffer_load_dwordx4 v10, s[16:19], s41 offen lds
    s_add_u32 s41, s41, 229376
    v_mfma_f32_16x16x32_bf16 v[144:147], v[168:171], v[200:203], 0
    ds_read_b64_tr_b16 v[216:217], v229 offset:20480
    ds_read_b64_tr_b16 v[218:219], v229 offset:22528
    v_mfma_f32_16x16x32_bf16 v[132:135], v[172:175], v[204:207], v[132:135]
    ds_read_b128 v[188:191], v127 offset:3072
    ds_read_b128 v[192:195], v127 offset:17408
    v_mfma_f32_16x16x32_bf16 v[136:139], v[176:179], v[204:207], v[136:139]
    s_add_u32 m0, s46, 1024
    s_nop 0
    buffer_load_dwordx4 v10, s[16:19], s42 offen lds
    s_add_u32 s42, s42, 229376
    v_mfma_f32_16x16x32_bf16 v[140:143], v[172:175], v[208:211], v[140:143]
    ds_read_b64_tr_b16 v[220:221], v228 offset:28672
    ds_read_b64_tr_b16 v[222:223], v228 offset:30720
    v_mfma_f32_16x16x32_bf16 v[144:147], v[176:179], v[208:211], v[144:147]
    ds_read_b64_tr_b16 v[224:225], v229 offset:28672
    ds_read_b64_tr_b16 v[226:227], v229 offset:30720
    s_waitcnt lgkmcnt(0)
    s_waitcnt vmcnt(6)
    s_barrier
    v_mfma_f32_16x16x32_bf16 v[132:135], v[180:183], v[212:215], v[132:135]
    ds_read_b128 v[164:167], v126 offset:4096
    ds_read_b128 v[168:171], v126 offset:18432
    v_mfma_f32_16x16x32_bf16 v[136:139], v[184:187], v[212:215], v[136:139]
    ds_read_b64_tr_b16 v[196:197], v228 offset:40960
    ds_read_b64_tr_b16 v[198:199], v228 offset:43008
    v_mfma_f32_16x16x32_bf16 v[140:143], v[180:183], v[216:219], v[140:143]
    s_add_u32 m0, s46, 20480
    s_nop 0
    buffer_load_dwordx4 v10, s[16:19], s41 offen lds
    s_add_u32 s41, s41, 229376
    v_mfma_f32_16x16x32_bf16 v[144:147], v[184:187], v[216:219], v[144:147]
    ds_read_b64_tr_b16 v[200:201], v229 offset:40960
    ds_read_b64_tr_b16 v[202:203], v229 offset:43008
    v_mfma_f32_16x16x32_bf16 v[132:135], v[188:191], v[220:223], v[132:135]
    ds_read_b128 v[172:175], v127 offset:5120
    ds_read_b128 v[176:179], v127 offset:19456
    v_mfma_f32_16x16x32_bf16 v[136:139], v[192:195], v[220:223], v[136:139]
    s_add_u32 m0, s46, 21504
    s_nop 0
    buffer_load_dwordx4 v10, s[16:19], s42 offen lds
    s_add_u32 s42, s42, 229376
    v_mfma_f32_16x16x32_bf16 v[140:143], v[188:191], v[224:227], v[140:143]
    ds_read_b64_tr_b16 v[204:205], v228 offset:49152
    ds_read_b64_tr_b16 v[206:207], v228 offset:51200
    v_mfma_f32_16x16x32_bf16 v[144:147], v[192:195], v[224:227], v[144:147]
    ds_read_b64_tr_b16 v[208:209], v229 offset:49152
    ds_read_b64_tr_b16 v[210:211], v229 offset:51200
    s_waitcnt lgkmcnt(0)
    s_waitcnt vmcnt(6)
    s_barrier
    v_mfma_f32_16x16x32_bf16 v[132:135], v[164:167], v[196:199], v[132:135]
    ds_read_b128 v[180:183], v126 offset:6144
    ds_read_b128 v[184:187], v126 offset:20480
    v_mfma_f32_16x16x32_bf16 v[136:139], v[168:171], v[196:199], v[136:139]
    ds_read_b64_tr_b16 v[212:213], v230 offset:0
    ds_read_b64_tr_b16 v[214:215], v230 offset:2048
    v_mfma_f32_16x16x32_bf16 v[140:143], v[164:167], v[200:203], v[140:143]
    s_add_u32 m0, s47, 40960
    s_nop 0
    buffer_load_dwordx4 v124, s[12:15], s43 offen lds
    v_add_u32 v124, 86016, v124
    v_mfma_f32_16x16x32_bf16 v[144:147], v[168:171], v[200:203], v[144:147]
    ds_read_b64_tr_b16 v[216:217], v231 offset:0
    ds_read_b64_tr_b16 v[218:219], v231 offset:2048
    v_mfma_f32_16x16x32_bf16 v[132:135], v[172:175], v[204:207], v[132:135]
    ds_read_b128 v[188:191], v127 offset:7168
    ds_read_b128 v[192:195], v127 offset:21504
    v_mfma_f32_16x16x32_bf16 v[136:139], v[176:179], v[204:207], v[136:139]
    s_add_u32 m0, s47, 49152
    s_nop 0
    buffer_load_dwordx4 v125, s[16:19], s44 offen lds
    v_add_u32 v125, 114688, v125
    v_mfma_f32_16x16x32_bf16 v[140:143], v[172:175], v[208:211], v[140:143]
    ds_read_b64_tr_b16 v[220:221], v230 offset:8192
    ds_read_b64_tr_b16 v[222:223], v230 offset:10240
    v_mfma_f32_16x16x32_bf16 v[144:147], v[176:179], v[208:211], v[144:147]
    ds_read_b64_tr_b16 v[224:225], v231 offset:8192
    ds_read_b64_tr_b16 v[226:227], v231 offset:10240
    s_waitcnt lgkmcnt(0)
    s_waitcnt vmcnt(6)
    s_barrier
    v_mfma_f32_16x16x32_bf16 v[132:135], v[180:183], v[212:215], v[132:135]
    ds_read_b128 v[164:167], v126 offset:8192
    ds_read_b128 v[168:171], v126 offset:22528
    v_mfma_f32_16x16x32_bf16 v[136:139], v[184:187], v[212:215], v[136:139]
    ds_read_b64_tr_b16 v[196:197], v230 offset:20480
    ds_read_b64_tr_b16 v[198:199], v230 offset:22528
    v_mfma_f32_16x16x32_bf16 v[140:143], v[180:183], v[216:219], v[140:143]
    s_add_u32 m0, s47, 61440
    s_nop 0
    buffer_load_dwordx4 v124, s[12:15], s43 offen lds
    v_add_u32 v124, 86016, v124
    v_mfma_f32_16x16x32_bf16 v[144:147], v[184:187], v[216:219], v[144:147]
    ds_read_b64_tr_b16 v[200:201], v231 offset:20480
    ds_read_b64_tr_b16 v[202:203], v231 offset:22528
    v_mfma_f32_16x16x32_bf16 v[132:135], v[188:191], v[220:223], v[132:135]
    ds_read_b128 v[172:175], v127 offset:9216
    ds_read_b128 v[176:179], v127 offset:23552
    v_mfma_f32_16x16x32_bf16 v[136:139], v[192:195], v[220:223], v[136:139]
    s_add_u32 m0, s47, 69632
    s_nop 0
    buffer_load_dwordx4 v125, s[16:19], s44 offen lds
    v_add_u32 v125, 114688, v125
    v_mfma_f32_16x16x32_bf16 v[140:143], v[188:191], v[224:227], v[140:143]
    ds_read_b64_tr_b16 v[204:205], v230 offset:28672
    ds_read_b64_tr_b16 v[206:207], v230 offset:30720
    v_mfma_f32_16x16x32_bf16 v[144:147], v[192:195], v[224:227], v[144:147]
    ds_read_b64_tr_b16 v[208:209], v231 offset:28672
    ds_read_b64_tr_b16 v[210:211], v231 offset:30720
    s_waitcnt lgkmcnt(0)
    s_waitcnt vmcnt(6)
    s_barrier
    v_mfma_f32_16x16x32_bf16 v[132:135], v[164:167], v[196:199], v[132:135]
    ds_read_b128 v[180:183], v126 offset:10240
    ds_read_b128 v[184:187], v126 offset:24576
    v_mfma_f32_16x16x32_bf16 v[136:139], v[168:171], v[196:199], v[136:139]
    ds_read_b64_tr_b16 v[212:213], v228 offset:0
    ds_read_b64_tr_b16 v[214:215], v228 offset:2048
    v_mfma_f32_16x16x32_bf16 v[140:143], v[164:167], v[200:203], v[140:143]
    s_add_u32 m0, s47, 81920
    s_nop 0
    buffer_load_dwordx4 v124, s[12:15], s43 offen lds
    v_add_u32 v124, 86016, v124
    v_mfma_f32_16x16x32_bf16 v[144:147], v[168:171], v[200:203], v[144:147]
    ds_read_b64_tr_b16 v[216:217], v229 offset:0
    ds_read_b64_tr_b16 v[218:219], v229 offset:2048
    v_mfma_f32_16x16x32_bf16 v[132:135], v[172:175], v[204:207], v[132:135]
    ds_read_b128 v[188:191], v127 offset:11264
    ds_read_b128 v[192:195], v127 offset:25600
    v_mfma_f32_16x16x32_bf16 v[136:139], v[176:179], v[204:207], v[136:139]
    s_add_u32 m0, s47, 90112
    s_nop 0
    buffer_load_dwordx4 v125, s[16:19], s44 offen lds
    v_add_u32 v125, 114688, v125
    v_mfma_f32_16x16x32_bf16 v[140:143], v[172:175], v[208:211], v[140:143]
    ds_read_b64_tr_b16 v[220:221], v228 offset:8192
    ds_read_b64_tr_b16 v[222:223], v228 offset:10240
    v_mfma_f32_16x16x32_bf16 v[144:147], v[176:179], v[208:211], v[144:147]
    ds_read_b64_tr_b16 v[224:225], v229 offset:8192
    ds_read_b64_tr_b16 v[226:227], v229 offset:10240
    s_waitcnt lgkmcnt(0)
    s_waitcnt vmcnt(6)
    s_barrier
    v_mfma_f32_16x16x32_bf16 v[132:135], v[180:183], v[212:215], v[132:135]
    ds_read_b128 v[164:167], v126 offset:12288
    ds_read_b128 v[168:171], v126 offset:26624
    v_mfma_f32_16x16x32_bf16 v[136:139], v[184:187], v[212:215], v[136:139]
    ds_read_b64_tr_b16 v[196:197], v228 offset:20480
    ds_read_b64_tr_b16 v[198:199], v228 offset:22528
    v_mfma_f32_16x16x32_bf16 v[140:143], v[180:183], v[216:219], v[140:143]
    s_add_u32 m0, s47, 0
    s_nop 0
    buffer_load_dwordx4 v124, s[12:15], s43 offen lds
    v_add_u32 v124, 86016, v124
    v_mfma_f32_16x16x32_bf16 v[144:147], v[184:187], v[216:219], v[144:147]
    ds_read_b64_tr_b16 v[200:201], v229 offset:20480
    ds_read_b64_tr_b16 v[202:203], v229 offset:22528
    v_mfma_f32_16x16x32_bf16 v[132:135], v[188:191], v[220:223], v[132:135]
    ds_read_b128 v[172:175], v127 offset:13312
    ds_read_b128 v[176:179], v127 offset:27648
    v_mfma_f32_16x16x32_bf16 v[136:139], v[192:195], v[220:223], v[136:139]
    s_add_u32 m0, s47, 8192
    s_nop 0
    buffer_load_dwordx4 v125, s[16:19], s44 offen lds
    v_add_u32 v125, 114688, v125
    v_mfma_f32_16x16x32_bf16 v[140:143], v[188:191], v[224:227], v[140:143]
    ds_read_b64_tr_b16 v[204:205], v228 offset:28672
    ds_read_b64_tr_b16 v[206:207], v228 offset:30720
    v_mfma_f32_16x16x32_bf16 v[144:147], v[192:195], v[224:227], v[144:147]
    ds_read_b64_tr_b16 v[208:209], v229 offset:28672
    ds_read_b64_tr_b16 v[210:211], v229 offset:30720
    s_waitcnt lgkmcnt(0)
    s_waitcnt vmcnt(6)
    s_barrier
    v_mfma_f32_16x16x32_bf16 v[132:135], v[164:167], v[196:199], v[132:135]
    ds_read_b128 v[52:55], v126 offset:0
    ds_read_b128 v[56:59], v126 offset:14336
    v_mfma_f32_16x16x32_bf16 v[136:139], v[168:171], v[196:199], v[136:139]
    ds_read_b64_tr_b16 v[68:69], v152 offset:40960
    ds_read_b64_tr_b16 v[70:71], v152 offset:43008
    v_mfma_f32_16x16x32_bf16 v[140:143], v[164:167], v[200:203], v[140:143]
    s_add_u32 m0, s47, 20480
    s_nop 0
    buffer_load_dwordx4 v124, s[12:15], s43 offen lds
    v_add_u32 v124, 86016, v124
    v_mfma_f32_16x16x32_bf16 v[144:147], v[168:171], v[200:203], v[144:147]
    ds_read_b64_tr_b16 v[72:73], v153 offset:40960
    ds_read_b64_tr_b16 v[74:75], v153 offset:43008
    v_mfma_f32_16x16x32_bf16 v[132:135], v[172:175], v[204:207], v[132:135]
    ds_read_b64_tr_b16 v[76:77], v154 offset:40960
    ds_read_b64_tr_b16 v[78:79], v154 offset:43008
    v_mfma_f32_16x16x32_bf16 v[136:139], v[176:179], v[204:207], v[136:139]
    s_add_u32 m0, s47, 28672
    s_nop 0
    buffer_load_dwordx4 v125, s[16:19], s44 offen lds
    v_add_u32 v125, 114688, v125
    v_mfma_f32_16x16x32_bf16 v[140:143], v[172:175], v[208:211], v[140:143]
    ds_read_b64_tr_b16 v[80:81], v155 offset:40960
    ds_read_b64_tr_b16 v[82:83], v155 offset:43008
    v_mfma_f32_16x16x32_bf16 v[144:147], v[176:179], v[208:211], v[144:147]
    ds_read_b64_tr_b16 v[84:85], v156 offset:40960
    ds_read_b64_tr_b16 v[86:87], v156 offset:43008
    s_waitcnt lgkmcnt(0)
p1_A_done:
    v_pk_mul_f32 v[164:165], v[132:133], v[132:133]
    v_pk_mul_f32 v[166:167], v[134:135], v[134:135]
    v_pk_mul_f32 v[168:169], v[136:137], v[136:137]
    v_pk_mul_f32 v[170:171], v[138:139], v[138:139]
    v_pk_mul_f32 v[172:173], v[140:141], v[140:141]
    v_pk_mul_f32 v[174:175], v[142:143], v[142:143]
    v_pk_mul_f32 v[176:177], v[144:145], v[144:145]
    v_pk_mul_f32 v[178:179], v[146:147], v[146:147]
    v_pk_fma_f32 v[164:165], v[164:165], s[6:7], v[148:149]
    v_pk_fma_f32 v[166:167], v[166:167], s[6:7], v[148:149]
    v_pk_fma_f32 v[168:169], v[168:169], s[6:7], v[148:149]
    v_pk_fma_f32 v[170:171], v[170:171], s[6:7], v[148:149]
    v_pk_fma_f32 v[172:173], v[172:173], s[6:7], v[148:149]
    v_pk_fma_f32 v[174:175], v[174:175], s[6:7], v[148:149]
    v_pk_fma_f32 v[176:177], v[176:177], s[6:7], v[148:149]
    v_pk_fma_f32 v[178:179], v[178:179], s[6:7], v[148:149]
    v_pk_mul_f32 v[164:165], v[164:165], v[132:133]
    v_pk_mul_f32 v[166:167], v[166:167], v[134:135]
    v_pk_mul_f32 v[168:169], v[168:169], v[136:137]
    v_pk_mul_f32 v[170:171], v[170:171], v[138:139]
    v_pk_mul_f32 v[172:173], v[172:173], v[140:141]
    v_pk_mul_f32 v[174:175], v[174:175], v[142:143]
    v_pk_mul_f32 v[176:177], v[176:177], v[144:145]
    v_pk_mul_f32 v[178:179], v[178:179], v[146:147]
    v_exp_f32 v164, v164
    v_exp_f32 v165, v165
    v_exp_f32 v166, v166
    v_exp_f32 v167, v167
    v_exp_f32 v168, v168
    v_exp_f32 v169, v169
    v_exp_f32 v170, v170
    v_exp_f32 v171, v171
    v_exp_f32 v172, v172
    v_exp_f32 v173, v173
    v_exp_f32 v174, v174
    v_exp_f32 v175, v175
    v_exp_f32 v176, v176
    v_exp_f32 v177, v177
    v_exp_f32 v178, v178
    v_exp_f32 v179, v179
    v_pk_add_f32 v[164:165], v[164:165], v[150:151]
    v_pk_add_f32 v[166:167], v[166:167], v[150:151]
    v_pk_add_f32 v[168:169], v[168:169], v[150:151]
    v_pk_add_f32 v[170:171], v[170:171], v[150:151]
    v_pk_add_f32 v[172:173], v[172:173], v[150:151]
    v_pk_add_f32 v[174:175], v[174:175], v[150:151]
    v_pk_add_f32 v[176:177], v[176:177], v[150:151]
    v_pk_add_f32 v[178:179], v[178:179], v[150:151]
    v_rcp_f32 v164, v164
    v_rcp_f32 v165, v165
    v_rcp_f32 v166, v166
    v_rcp_f32 v167, v167
    v_rcp_f32 v168, v168
    v_rcp_f32 v169, v169
    v_rcp_f32 v170, v170
    v_rcp_f32 v171, v171
    v_rcp_f32 v172, v172
    v_rcp_f32 v173, v173
    v_rcp_f32 v174, v174
    v_rcp_f32 v175, v175
    v_rcp_f32 v176, v176
    v_rcp_f32 v177, v177
    v_rcp_f32 v178, v178
    v_rcp_f32 v179, v179
    v_pk_mul_f32 v[132:133], v[132:133], v[164:165]
    v_pk_mul_f32 v[134:135], v[134:135], v[166:167]
    v_pk_mul_f32 v[136:137], v[136:137], v[168:169]
    v_pk_mul_f32 v[138:139], v[138:139], v[170:171]
    v_pk_mul_f32 v[140:141], v[140:141], v[172:173]
    v_pk_mul_f32 v[142:143], v[142:143], v[174:175]
    v_pk_mul_f32 v[144:145], v[144:145], v[176:177]
    v_pk_mul_f32 v[146:147], v[146:147], v[178:179]
    v_add_f32 v164, v132, v140
    v_mul_f32 v165, v132, v132
    v_add_f32 v166, v133, v141
    v_mul_f32 v167, v133, v133
    v_add_f32 v168, v134, v142
    v_mul_f32 v169, v134, v134
    v_add_f32 v170, v135, v143
    v_mul_f32 v171, v135, v135
    v_add_f32 v172, v136, v144
    v_mul_f32 v173, v136, v136
    v_add_f32 v174, v137, v145
    v_mul_f32 v175, v137, v137
    v_add_f32 v176, v138, v146
    v_mul_f32 v177, v138, v138
    v_add_f32 v178, v139, v147
    v_mul_f32 v179, v139, v139
    v_fmac_f32 v165, v140, v140
    v_fmac_f32 v167, v141, v141
    v_fmac_f32 v169, v142, v142
    v_fmac_f32 v171, v143, v143
    v_fmac_f32 v173, v144, v144
    v_fmac_f32 v175, v145, v145
    v_fmac_f32 v177, v146, v146
    v_fmac_f32 v179, v147, v147
    v_add_f32_dpp v164, v164, v164 row_ror:8 row_mask:0xf bank_mask:0xf
    v_add_f32_dpp v165, v165, v165 row_ror:8 row_mask:0xf bank_mask:0xf
    v_add_f32_dpp v166, v166, v166 row_ror:8 row_mask:0xf bank_mask:0xf
    v_add_f32_dpp v167, v167, v167 row_ror:8 row_mask:0xf bank_mask:0xf
    v_add_f32_dpp v168, v168, v168 row_ror:8 row_mask:0xf bank_mask:0xf
    v_add_f32_dpp v169, v169, v169 row_ror:8 row_mask:0xf bank_mask:0xf
    v_add_f32_dpp v170, v170, v170 row_ror:8 row_mask:0xf bank_mask:0xf
    v_add_f32_dpp v171, v171, v171 row_ror:8 row_mask:0xf bank_mask:0xf
    v_add_f32_dpp v172, v172, v172 row_ror:8 row_mask:0xf bank_mask:0xf
    v_add_f32_dpp v173, v173, v173 row_ror:8 row_mask:0xf bank_mask:0xf
    v_add_f32_dpp v174, v174, v174 row_ror:8 row_mask:0xf bank_mask:0xf
    v_add_f32_dpp v175, v175, v175 row_ror:8 row_mask:0xf bank_mask:0xf
    v_add_f32_dpp v176, v176, v176 row_ror:8 row_mask:0xf bank_mask:0xf
    v_add_f32_dpp v177, v177, v177 row_ror:8 row_mask:0xf bank_mask:0xf
    v_add_f32_dpp v178, v178, v178 row_ror:8 row_mask:0xf bank_mask:0xf
    v_add_f32_dpp v179, v179, v179 row_ror:8 row_mask:0xf bank_mask:0xf
    v_add_f32_dpp v164, v164, v164 row_ror:4 row_mask:0xf bank_mask:0xf
    v_add_f32_dpp v165, v165, v165 row_ror:4 row_mask:0xf bank_mask:0xf
    v_add_f32_dpp v166, v166, v166 row_ror:4 row_mask:0xf bank_mask:0xf
    v_add_f32_dpp v167, v167, v167 row_ror:4 row_mask:0xf bank_mask:0xf
    v_add_f32_dpp v168, v168, v168 row_ror:4 row_mask:0xf bank_mask:0xf
    v_add_f32_dpp v169, v169, v169 row_ror:4 row_mask:0xf bank_mask:0xf
    v_add_f32_dpp v170, v170, v170 row_ror:4 row_mask:0xf bank_mask:0xf
    v_add_f32_dpp v171, v171, v171 row_ror:4 row_mask:0xf bank_mask:0xf
    v_add_f32_dpp v172, v172, v172 row_ror:4 row_mask:0xf bank_mask:0xf
    v_add_f32_dpp v173, v173, v173 row_ror:4 row_mask:0xf bank_mask:0xf
    v_add_f32_dpp v174, v174, v174 row_ror:4 row_mask:0xf bank_mask:0xf
    v_add_f32_dpp v175, v175, v175 row_ror:4 row_mask:0xf bank_mask:0xf
    v_add_f32_dpp v176, v176, v176 row_ror:4 row_mask:0xf bank_mask:0xf
    v_add_f32_dpp v177, v177, v177 row_ror:4 row_mask:0xf bank_mask:0xf
    v_add_f32_dpp v178, v178, v178 row_ror:4 row_mask:0xf bank_mask:0xf
    v_add_f32_dpp v179, v179, v179 row_ror:4 row_mask:0xf bank_mask:0xf
    v_add_f32_dpp v164, v164, v164 row_ror:2 row_mask:0xf bank_mask:0xf
    v_add_f32_dpp v165, v165, v165 row_ror:2 row_mask:0xf bank_mask:0xf
    v_add_f32_dpp v166, v166, v166 row_ror:2 row_mask:0xf bank_mask:0xf
    v_add_f32_dpp v167, v167, v167 row_ror:2 row_mask:0xf bank_mask:0xf
    v_add_f32_dpp v168, v168, v168 row_ror:2 row_mask:0xf bank_mask:0xf
    v_add_f32_dpp v169, v169, v169 row_ror:2 row_mask:0xf bank_mask:0xf
    v_add_f32_dpp v170, v170, v170 row_ror:2 row_mask:0xf bank_mask:0xf
    v_add_f32_dpp v171, v171, v171 row_ror:2 row_mask:0xf bank_mask:0xf
    v_add_f32_dpp v172, v172, v172 row_ror:2 row_mask:0xf bank_mask:0xf
    v_add_f32_dpp v173, v173, v173 row_ror:2 row_mask:0xf bank_mask:0xf
    v_add_f32_dpp v174, v174, v174 row_ror:2 row_mask:0xf bank_mask:0xf
    v_add_f32_dpp v175, v175, v175 row_ror:2 row_mask:0xf bank_mask:0xf
    v_add_f32_dpp v176, v176, v176 row_ror:2 row_mask:0xf bank_mask:0xf
    v_add_f32_dpp v177, v177, v177 row_ror:2 row_mask:0xf bank_mask:0xf
    v_add_f32_dpp v178, v178, v178 row_ror:2 row_mask:0xf bank_mask:0xf
    v_add_f32_dpp v179, v179, v179 row_ror:2 row_mask:0xf bank_mask:0xf
    v_add_f32_dpp v164, v164, v164 row_ror:1 row_mask:0xf bank_mask:0xf
    v_add_f32_dpp v165, v165, v165 row_ror:1 row_mask:0xf bank_mask:0xf
    v_add_f32_dpp v166, v166, v166 row_ror:1 row_mask:0xf bank_mask:0xf
    v_add_f32_dpp v167, v167, v167 row_ror:1 row_mask:0xf bank_mask:0xf
    v_add_f32_dpp v168, v168, v168 row_ror:1 row_mask:0xf bank_mask:0xf
    v_add_f32_dpp v169, v169, v169 row_ror:1 row_mask:0xf bank_mask:0xf
    v_add_f32_dpp v170, v170, v170 row_ror:1 row_mask:0xf bank_mask:0xf
    v_add_f32_dpp v171, v171, v171 row_ror:1 row_mask:0xf bank_mask:0xf
    v_add_f32_dpp v172, v172, v172 row_ror:1 row_mask:0xf bank_mask:0xf
    v_add_f32_dpp v173, v173, v173 row_ror:1 row_mask:0xf bank_mask:0xf
    v_add_f32_dpp v174, v174, v174 row_ror:1 row_mask:0xf bank_mask:0xf
    v_add_f32_dpp v175, v175, v175 row_ror:1 row_mask:0xf bank_mask:0xf
    v_add_f32_dpp v176, v176, v176 row_ror:1 row_mask:0xf bank_mask:0xf
    v_add_f32_dpp v177, v177, v177 row_ror:1 row_mask:0xf bank_mask:0xf
    v_add_f32_dpp v178, v178, v178 row_ror:1 row_mask:0xf bank_mask:0xf
    v_add_f32_dpp v179, v179, v179 row_ror:1 row_mask:0xf bank_mask:0xf
    v_lshrrev_b32 v2, 4, v1
    v_lshlrev_b32 v2, 6, v2
    s_lshl_b32 s31, s35, 9
    s_lshl_b32 s32, s36, 8
    s_add_u32 s31, s31, s32
    s_add_u32 s31, s31, 159744
    v_add_u32 v2, s31, v2
    s_mov_b32 exec_lo, 0x10001
    s_mov_b32 exec_hi, 0x10001
    ds_write_b128 v2, v[164:167] offset:0
    ds_write_b128 v2, v[168:171] offset:16
    ds_write_b128 v2, v[172:175] offset:32
    ds_write_b128 v2, v[176:179] offset:48
    s_mov_b64 exec, -1
    s_waitcnt lgkmcnt(0)
    s_mov_b32 s55, 0
    s_cmp_eq_u32 s35, 2
    s_cbranch_scc1 p1_B_T
    s_cmp_lg_u32 s36, 0
    s_cbranch_scc1 p1_B_F1
p1_B_F0:
    s_waitcnt vmcnt(9)
    s_barrier
    v_mfma_f32_16x16x32_bf16 v[12:15], v[68:71], v[52:55], 0
    ds_read_b128 v[60:63], v127 offset:1024
    ds_read_b128 v[64:67], v127 offset:15360
    v_mfma_f32_16x16x32_bf16 v[16:19], v[68:71], v[56:59], 0
    s_add_u32 m0, s47, 40960
    s_nop 0
    buffer_load_dwordx4 v124, s[12:15], s43 offen lds
    v_mfma_f32_16x16x32_bf16 v[20:23], v[72:75], v[52:55], 0
    ds_read_b64_tr_b16 v[88:89], v157 offset:0
    ds_read_b64_tr_b16 v[90:91], v157 offset:2048
    v_mfma_f32_16x16x32_bf16 v[24:27], v[72:75], v[56:59], 0
    ds_read_b64_tr_b16 v[92:93], v158 offset:0
    ds_read_b64_tr_b16 v[94:95], v158 offset:2048
    v_mfma_f32_16x16x32_bf16 v[28:31], v[76:79], v[52:55], 0
    ds_read_b64_tr_b16 v[96:97], v159 offset:0
    ds_read_b64_tr_b16 v[98:99], v159 offset:2048
    v_mfma_f32_16x16x32_bf16 v[32:35], v[76:79], v[56:59], 0
    s_add_u32 m0, s47, 49152
    s_nop 0
    buffer_load_dwordx4 v124, s[12:15], s44 offen lds
    v_add_u32 v124, 86016, v124
    v_mfma_f32_16x16x32_bf16 v[36:39], v[80:83], v[52:55], 0
    ds_read_b64_tr_b16 v[100:101], v160 offset:0
    ds_read_b64_tr_b16 v[102:103], v160 offset:2048
    v_mfma_f32_16x16x32_bf16 v[40:43], v[80:83], v[56:59], 0
    ds_read_b64_tr_b16 v[104:105], v161 offset:0
    ds_read_b64_tr_b16 v[106:107], v161 offset:2048
    v_mfma_f32_16x16x32_bf16 v[44:47], v[84:87], v[52:55], 0
    s_add_u32 m0, s47, 57344
    s_nop 0
    buffer_load_dwordx4 v125, s[16:19], s45 offen lds
    v_add_u32 v125, 114688, v125
    v_mfma_f32_16x16x32_bf16 v[48:51], v[84:87], v[56:59], 0
    s_cmp_eq_u32 s28, 0
    s_cbranch_scc1 p1_B_F0_k0_x
p1_B_F0_k0_r:
    s_waitcnt lgkmcnt(0)
    s_waitcnt vmcnt(9)
    s_barrier
    v_mfma_f32_16x16x32_bf16 v[12:15], v[88:91], v[60:63], v[12:15]
    ds_read_b128 v[52:55], v126 offset:2048
    ds_read_b128 v[56:59], v126 offset:16384
    v_mfma_f32_16x16x32_bf16 v[16:19], v[88:91], v[64:67], v[16:19]
    s_add_u32 m0, s47, 61440
    s_nop 0
    buffer_load_dwordx4 v124, s[12:15], s43 offen lds
    v_mfma_f32_16x16x32_bf16 v[20:23], v[92:95], v[60:63], v[20:23]
    ds_read_b64_tr_b16 v[68:69], v157 offset:20480
    ds_read_b64_tr_b16 v[70:71], v157 offset:22528
    v_mfma_f32_16x16x32_bf16 v[24:27], v[92:95], v[64:67], v[24:27]
    ds_read_b64_tr_b16 v[72:73], v158 offset:20480
    ds_read_b64_tr_b16 v[74:75], v158 offset:22528
    v_mfma_f32_16x16x32_bf16 v[28:31], v[96:99], v[60:63], v[28:31]
    ds_read_b64_tr_b16 v[76:77], v159 offset:20480
    ds_read_b64_tr_b16 v[78:79], v159 offset:22528
    v_mfma_f32_16x16x32_bf16 v[32:35], v[96:99], v[64:67], v[32:35]
    s_add_u32 m0, s47, 69632
    s_nop 0
    buffer_load_dwordx4 v124, s[12:15], s44 offen lds
    v_add_u32 v124, 86016, v124
    v_mfma_f32_16x16x32_bf16 v[36:39], v[100:103], v[60:63], v[36:39]
    ds_read_b64_tr_b16 v[80:81], v160 offset:20480
    ds_read_b64_tr_b16 v[82:83], v160 offset:22528
    v_mfma_f32_16x16x32_bf16 v[40:43], v[100:103], v[64:67], v[40:43]
    ds_read_b64_tr_b16 v[84:85], v161 offset:20480
    ds_read_b64_tr_b16 v[86:87], v161 offset:22528
    v_mfma_f32_16x16x32_bf16 v[44:47], v[104:107], v[60:63], v[44:47]
    s_add_u32 m0, s47, 77824
    s_nop 0
    buffer_load_dwordx4 v125, s[16:19], s45 offen lds
    v_add_u32 v125, 114688, v125
    v_mfma_f32_16x16x32_bf16 v[48:51], v[104:107], v[64:67], v[48:51]
    s_waitcnt lgkmcnt(0)
    s_waitcnt vmcnt(9)
    s_barrier
    v_mfma_f32_16x16x32_bf16 v[12:15], v[68:71], v[52:55], v[12:15]
    ds_read_b128 v[60:63], v127 offset:3072
    ds_read_b128 v[64:67], v127 offset:17408
    v_mfma_f32_16x16x32_bf16 v[16:19], v[68:71], v[56:59], v[16:19]
    s_add_u32 m0, s47, 81920
    s_nop 0
    buffer_load_dwordx4 v124, s[12:15], s43 offen lds
    v_mfma_f32_16x16x32_bf16 v[20:23], v[72:75], v[52:55], v[20:23]
    ds_read_b64_tr_b16 v[88:89], v152 offset:0
    ds_read_b64_tr_b16 v[90:91], v152 offset:2048
    v_mfma_f32_16x16x32_bf16 v[24:27], v[72:75], v[56:59], v[24:27]
    ds_read_b64_tr_b16 v[92:93], v153 offset:0
    ds_read_b64_tr_b16 v[94:95], v153 offset:2048
    v_mfma_f32_16x16x32_bf16 v[28:31], v[76:79], v[52:55], v[28:31]
    ds_read_b64_tr_b16 v[96:97], v154 offset:0
    ds_read_b64_tr_b16 v[98:99], v154 offset:2048
    v_mfma_f32_16x16x32_bf16 v[32:35], v[76:79], v[56:59], v[32:35]
    s_add_u32 m0, s47, 90112
    s_nop 0
    buffer_load_dwordx4 v124, s[12:15], s44 offen lds
    v_add_u32 v124, 86016, v124
    v_mfma_f32_16x16x32_bf16 v[36:39], v[80:83], v[52:55], v[36:39]
    ds_read_b64_tr_b16 v[100:101], v155 offset:0
    ds_read_b64_tr_b16 v[102:103], v155 offset:2048
    v_mfma_f32_16x16x32_bf16 v[40:43], v[80:83], v[56:59], v[40:43]
    ds_read_b64_tr_b16 v[104:105], v156 offset:0
    ds_read_b64_tr_b16 v[106:107], v156 offset:2048
    v_mfma_f32_16x16x32_bf16 v[44:47], v[84:87], v[52:55], v[44:47]
    s_add_u32 m0, s47, 98304
    s_nop 0
    buffer_load_dwordx4 v125, s[16:19], s45 offen lds
    v_add_u32 v125, 114688, v125
    v_mfma_f32_16x16x32_bf16 v[48:51], v[84:87], v[56:59], v[48:51]
    s_waitcnt lgkmcnt(0)
    s_waitcnt vmcnt(9)
    s_barrier
    v_mfma_f32_16x16x32_bf16 v[12:15], v[88:91], v[60:63], v[12:15]
    ds_read_b128 v[52:55], v126 offset:4096
    ds_read_b128 v[56:59], v126 offset:18432
    v_mfma_f32_16x16x32_bf16 v[16:19], v[88:91], v[64:67], v[16:19]
    s_add_u32 m0, s47, 0
    s_nop 0
    buffer_load_dwordx4 v124, s[12:15], s43 offen lds
    v_mfma_f32_16x16x32_bf16 v[20:23], v[92:95], v[60:63], v[20:23]
    ds_read_b64_tr_b16 v[68:69], v152 offset:20480
    ds_read_b64_tr_b16 v[70:71], v152 offset:22528
    v_mfma_f32_16x16x32_bf16 v[24:27], v[92:95], v[64:67], v[24:27]
    ds_read_b64_tr_b16 v[72:73], v153 offset:20480
    ds_read_b64_tr_b16 v[74:75], v153 offset:22528
    v_mfma_f32_16x16x32_bf16 v[28:31], v[96:99], v[60:63], v[28:31]
    ds_read_b64_tr_b16 v[76:77], v154 offset:20480
    ds_read_b64_tr_b16 v[78:79], v154 offset:22528
    v_mfma_f32_16x16x32_bf16 v[32:35], v[96:99], v[64:67], v[32:35]
    s_add_u32 m0, s47, 8192
    s_nop 0
    buffer_load_dwordx4 v124, s[12:15], s44 offen lds
    v_add_u32 v124, 86016, v124
    v_mfma_f32_16x16x32_bf16 v[36:39], v[100:103], v[60:63], v[36:39]
    ds_read_b64_tr_b16 v[80:81], v155 offset:20480
    ds_read_b64_tr_b16 v[82:83], v155 offset:22528
    v_mfma_f32_16x16x32_bf16 v[40:43], v[100:103], v[64:67], v[40:43]
    ds_read_b64_tr_b16 v[84:85], v156 offset:20480
    ds_read_b64_tr_b16 v[86:87], v156 offset:22528
    v_mfma_f32_16x16x32_bf16 v[44:47], v[104:107], v[60:63], v[44:47]
    s_add_u32 m0, s47, 16384
    s_nop 0
    buffer_load_dwordx4 v125, s[16:19], s45 offen lds
    v_add_u32 v125, 114688, v125
    v_mfma_f32_16x16x32_bf16 v[48:51], v[104:107], v[64:67], v[48:51]
    s_waitcnt lgkmcnt(0)
    s_waitcnt vmcnt(9)
    s_barrier
    v_mfma_f32_16x16x32_bf16 v[12:15], v[68:71], v[52:55], v[12:15]
    ds_read_b128 v[60:63], v127 offset:5120
    ds_read_b128 v[64:67], v127 offset:19456
    v_mfma_f32_16x16x32_bf16 v[16:19], v[68:71], v[56:59], v[16:19]
    s_add_u32 m0, s47, 20480
    s_nop 0
    buffer_load_dwordx4 v124, s[12:15], s43 offen lds
    v_mfma_f32_16x16x32_bf16 v[20:23], v[72:75], v[52:55], v[20:23]
    ds_read_b64_tr_b16 v[88:89], v152 offset:40960
    ds_read_b64_tr_b16 v[90:91], v152 offset:43008
    v_mfma_f32_16x16x32_bf16 v[24:27], v[72:75], v[56:59], v[24:27]
    ds_read_b64_tr_b16 v[92:93], v153 offset:40960
    ds_read_b64_tr_b16 v[94:95], v153 offset:43008
    v_mfma_f32_16x16x32_bf16 v[28:31], v[76:79], v[52:55], v[28:31]
    ds_read_b64_tr_b16 v[96:97], v154 offset:40960
    ds_read_b64_tr_b16 v[98:99], v154 offset:43008
    v_mfma_f32_16x16x32_bf16 v[32:35], v[76:79], v[56:59], v[32:35]
    s_add_u32 m0, s47, 28672
    s_nop 0
    buffer_load_dwordx4 v124, s[12:15], s44 offen lds
    v_add_u32 v124, 86016, v124
    v_mfma_f32_16x16x32_bf16 v[36:39], v[80:83], v[52:55], v[36:39]
    ds_read_b64_tr_b16 v[100:101], v155 offset:40960
    ds_read_b64_tr_b16 v[102:103], v155 offset:43008
    v_mfma_f32_16x16x32_bf16 v[40:43], v[80:83], v[56:59], v[40:43]
    ds_read_b64_tr_b16 v[104:105], v156 offset:40960
    ds_read_b64_tr_b16 v[106:107], v156 offset:43008
    v_mfma_f32_16x16x32_bf16 v[44:47], v[84:87], v[52:55], v[44:47]
    s_add_u32 m0, s47, 36864
    s_nop 0
    buffer_load_dwordx4 v125, s[16:19], s45 offen lds
    v_add_u32 v125, 114688, v125
    v_mfma_f32_16x16x32_bf16 v[48:51], v[84:87], v[56:59], v[48:51]
    s_cmp_eq_u32 s28, 0
    s_cbranch_scc1 p1_B_F0_k4_x
p1_B_F0_k4_r:
    s_waitcnt lgkmcnt(0)
    s_waitcnt vmcnt(9)
    s_barrier
    v_mfma_f32_16x16x32_bf16 v[12:15], v[88:91], v[60:63], v[12:15]
    ds_read_b128 v[52:55], v126 offset:6144
    ds_read_b128 v[56:59], v126 offset:20480
    v_mfma_f32_16x16x32_bf16 v[16:19], v[88:91], v[64:67], v[16:19]
    s_add_u32 m0, s47, 40960
    s_nop 0
    buffer_load_dwordx4 v124, s[12:15], s43 offen lds
    v_mfma_f32_16x16x32_bf16 v[20:23], v[92:95], v[60:63], v[20:23]
    ds_read_b64_tr_b16 v[68:69], v157 offset:0
    ds_read_b64_tr_b16 v[70:71], v157 offset:2048
    v_mfma_f32_16x16x32_bf16 v[24:27], v[92:95], v[64:67], v[24:27]
    ds_read_b64_tr_b16 v[72:73], v158 offset:0
    ds_read_b64_tr_b16 v[74:75], v158 offset:2048
    v_mfma_f32_16x16x32_bf16 v[28:31], v[96:99], v[60:63], v[28:31]
    ds_read_b64_tr_b16 v[76:77], v159 offset:0
    ds_read_b64_tr_b16 v[78:79], v159 offset:2048
    v_mfma_f32_16x16x32_bf16 v[32:35], v[96:99], v[64:67], v[32:35]
    s_add_u32 m0, s47, 49152
    s_nop 0
    buffer_load_dwordx4 v124, s[12:15], s44 offen lds
    v_add_u32 v124, 86016, v124
    v_mfma_f32_16x16x32_bf16 v[36:39], v[100:103], v[60:63], v[36:39]
    ds_read_b64_tr_b16 v[80:81], v160 offset:0
    ds_read_b64_tr_b16 v[82:83], v160 offset:2048
    v_mfma_f32_16x16x32_bf16 v[40:43], v[100:103], v[64:67], v[40:43]
    ds_read_b64_tr_b16 v[84:85], v161 offset:0
    ds_read_b64_tr_b16 v[86:87], v161 offset:2048
    v_mfma_f32_16x16x32_bf16 v[44:47], v[104:107], v[60:63], v[44:47]
    s_add_u32 m0, s47, 57344
    s_nop 0
    buffer_load_dwordx4 v125, s[16:19], s45 offen lds
    v_add_u32 v125, 114688, v125
    v_mfma_f32_16x16x32_bf16 v[48:51], v[104:107], v[64:67], v[48:51]
    s_waitcnt lgkmcnt(0)
    s_waitcnt vmcnt(9)
    s_barrier
    v_mfma_f32_16x16x32_bf16 v[12:15], v[68:71], v[52:55], v[12:15]
    ds_read_b128 v[60:63], v127 offset:7168
    ds_read_b128 v[64:67], v127 offset:21504
    v_mfma_f32_16x16x32_bf16 v[16:19], v[68:71], v[56:59], v[16:19]
    s_add_u32 m0, s47, 61440
    s_nop 0
    buffer_load_dwordx4 v124, s[12:15], s43 offen lds
    v_mfma_f32_16x16x32_bf16 v[20:23], v[72:75], v[52:55], v[20:23]
    ds_read_b64_tr_b16 v[88:89], v157 offset:20480
    ds_read_b64_tr_b16 v[90:91], v157 offset:22528
    v_mfma_f32_16x16x32_bf16 v[24:27], v[72:75], v[56:59], v[24:27]
    ds_read_b64_tr_b16 v[92:93], v158 offset:20480
    ds_read_b64_tr_b16 v[94:95], v158 offset:22528
    v_mfma_f32_16x16x32_bf16 v[28:31], v[76:79], v[52:55], v[28:31]
    ds_read_b64_tr_b16 v[96:97], v159 offset:20480
    ds_read_b64_tr_b16 v[98:99], v159 offset:22528
    v_mfma_f32_16x16x32_bf16 v[32:35], v[76:79], v[56:59], v[32:35]
    s_add_u32 m0, s47, 69632
    s_nop 0
    buffer_load_dwordx4 v124, s[12:15], s44 offen lds
    v_add_u32 v124, 86016, v124
    v_mfma_f32_16x16x32_bf16 v[36:39], v[80:83], v[52:55], v[36:39]
    ds_read_b64_tr_b16 v[100:101], v160 offset:20480
    ds_read_b64_tr_b16 v[102:103], v160 offset:22528
    v_mfma_f32_16x16x32_bf16 v[40:43], v[80:83], v[56:59], v[40:43]
    ds_read_b64_tr_b16 v[104:105], v161 offset:20480
    ds_read_b64_tr_b16 v[106:107], v161 offset:22528
    v_mfma_f32_16x16x32_bf16 v[44:47], v[84:87], v[52:55], v[44:47]
    s_add_u32 m0, s47, 77824
    s_nop 0
    buffer_load_dwordx4 v125, s[16:19], s45 offen lds
    v_add_u32 v125, 114688, v125
    v_mfma_f32_16x16x32_bf16 v[48:51], v[84:87], v[56:59], v[48:51]
    s_waitcnt lgkmcnt(0)
    s_waitcnt vmcnt(9)
    s_barrier
    v_mfma_f32_16x16x32_bf16 v[12:15], v[88:91], v[60:63], v[12:15]
    ds_read_b128 v[52:55], v126 offset:8192
    ds_read_b128 v[56:59], v126 offset:22528
    v_mfma_f32_16x16x32_bf16 v[16:19], v[88:91], v[64:67], v[16:19]
    s_add_u32 m0, s47, 81920
    s_nop 0
    buffer_load_dwordx4 v124, s[12:15], s43 offen lds
    v_mfma_f32_16x16x32_bf16 v[20:23], v[92:95], v[60:63], v[20:23]
    ds_read_b64_tr_b16 v[68:69], v152 offset:0
    ds_read_b64_tr_b16 v[70:71], v152 offset:2048
    v_mfma_f32_16x16x32_bf16 v[24:27], v[92:95], v[64:67], v[24:27]
    ds_read_b64_tr_b16 v[72:73], v153 offset:0
    ds_read_b64_tr_b16 v[74:75], v153 offset:2048
    v_mfma_f32_16x16x32_bf16 v[28:31], v[96:99], v[60:63], v[28:31]
    ds_read_b64_tr_b16 v[76:77], v154 offset:0
    ds_read_b64_tr_b16 v[78:79], v154 offset:2048
    v_mfma_f32_16x16x32_bf16 v[32:35], v[96:99], v[64:67], v[32:35]
    s_add_u32 m0, s47, 90112
    s_nop 0
    buffer_load_dwordx4 v124, s[12:15], s44 offen lds
    v_add_u32 v124, 86016, v124
    v_mfma_f32_16x16x32_bf16 v[36:39], v[100:103], v[60:63], v[36:39]
    ds_read_b64_tr_b16 v[80:81], v155 offset:0
    ds_read_b64_tr_b16 v[82:83], v155 offset:2048
    v_mfma_f32_16x16x32_bf16 v[40:43], v[100:103], v[64:67], v[40:43]
    ds_read_b64_tr_b16 v[84:85], v156 offset:0
    ds_read_b64_tr_b16 v[86:87], v156 offset:2048
    v_mfma_f32_16x16x32_bf16 v[44:47], v[104:107], v[60:63], v[44:47]
    s_add_u32 m0, s47, 98304
    s_nop 0
    buffer_load_dwordx4 v125, s[16:19], s45 offen lds
    v_add_u32 v125, 114688, v125
    v_mfma_f32_16x16x32_bf16 v[48:51], v[104:107], v[64:67], v[48:51]
    s_waitcnt lgkmcnt(0)
    s_waitcnt vmcnt(9)
    s_barrier
    v_mfma_f32_16x16x32_bf16 v[12:15], v[68:71], v[52:55], v[12:15]
    ds_read_b128 v[60:63], v127 offset:9216
    ds_read_b128 v[64:67], v127 offset:23552
    v_mfma_f32_16x16x32_bf16 v[16:19], v[68:71], v[56:59], v[16:19]
    s_add_u32 m0, s47, 0
    s_nop 0
    buffer_load_dwordx4 v124, s[12:15], s43 offen lds
    v_mfma_f32_16x16x32_bf16 v[20:23], v[72:75], v[52:55], v[20:23]
    ds_read_b64_tr_b16 v[88:89], v152 offset:20480
    ds_read_b64_tr_b16 v[90:91], v152 offset:22528
    v_mfma_f32_16x16x32_bf16 v[24:27], v[72:75], v[56:59], v[24:27]
    ds_read_b64_tr_b16 v[92:93], v153 offset:20480
    ds_read_b64_tr_b16 v[94:95], v153 offset:22528
    v_mfma_f32_16x16x32_bf16 v[28:31], v[76:79], v[52:55], v[28:31]
    ds_read_b64_tr_b16 v[96:97], v154 offset:20480
    ds_read_b64_tr_b16 v[98:99], v154 offset:22528
    v_mfma_f32_16x16x32_bf16 v[32:35], v[76:79], v[56:59], v[32:35]
    s_add_u32 m0, s47, 8192
    s_nop 0
    buffer_load_dwordx4 v124, s[12:15], s44 offen lds
    v_add_u32 v124, 86016, v124
    v_mfma_f32_16x16x32_bf16 v[36:39], v[80:83], v[52:55], v[36:39]
    ds_read_b64_tr_b16 v[100:101], v155 offset:20480
    ds_read_b64_tr_b16 v[102:103], v155 offset:22528
    v_mfma_f32_16x16x32_bf16 v[40:43], v[80:83], v[56:59], v[40:43]
    ds_read_b64_tr_b16 v[104:105], v156 offset:20480
    ds_read_b64_tr_b16 v[106:107], v156 offset:22528
    v_mfma_f32_16x16x32_bf16 v[44:47], v[84:87], v[52:55], v[44:47]
    s_add_u32 m0, s47, 16384
    s_nop 0
    buffer_load_dwordx4 v125, s[16:19], s45 offen lds
    v_add_u32 v125, 114688, v125
    v_mfma_f32_16x16x32_bf16 v[48:51], v[84:87], v[56:59], v[48:51]
    s_waitcnt lgkmcnt(0)
    s_waitcnt vmcnt(9)
    s_barrier
    v_mfma_f32_16x16x32_bf16 v[12:15], v[88:91], v[60:63], v[12:15]
    ds_read_b128 v[52:55], v126 offset:10240
    ds_read_b128 v[56:59], v126 offset:24576
    v_mfma_f32_16x16x32_bf16 v[16:19], v[88:91], v[64:67], v[16:19]
    ds_read_b64_tr_b16 v[68:69], v152 offset:40960
    ds_read_b64_tr_b16 v[70:71], v152 offset:43008
    v_mfma_f32_16x16x32_bf16 v[20:23], v[92:95], v[60:63], v[20:23]
    ds_read_b64_tr_b16 v[72:73], v153 offset:40960
    ds_read_b64_tr_b16 v[74:75], v153 offset:43008
    v_mfma_f32_16x16x32_bf16 v[24:27], v[92:95], v[64:67], v[24:27]
    ds_read_b64_tr_b16 v[76:77], v154 offset:40960
    ds_read_b64_tr_b16 v[78:79], v154 offset:43008
    v_mfma_f32_16x16x32_bf16 v[28:31], v[96:99], v[60:63], v[28:31]
    ds_read_b64_tr_b16 v[80:81], v155 offset:40960
    ds_read_b64_tr_b16 v[82:83], v155 offset:43008
    v_mfma_f32_16x16x32_bf16 v[32:35], v[96:99], v[64:67], v[32:35]
    ds_read_b64_tr_b16 v[84:85], v156 offset:40960
    ds_read_b64_tr_b16 v[86:87], v156 offset:43008
    v_mfma_f32_16x16x32_bf16 v[36:39], v[100:103], v[60:63], v[36:39]
    v_mfma_f32_16x16x32_bf16 v[40:43], v[100:103], v[64:67], v[40:43]
    v_mfma_f32_16x16x32_bf16 v[44:47], v[104:107], v[60:63], v[44:47]
    v_mfma_f32_16x16x32_bf16 v[48:51], v[104:107], v[64:67], v[48:51]
    s_waitcnt lgkmcnt(0)
    s_waitcnt vmcnt(6)
    s_barrier
    v_mfma_f32_16x16x32_bf16 v[12:15], v[68:71], v[52:55], v[12:15]
    ds_read_b128 v[60:63], v127 offset:11264
    ds_read_b128 v[64:67], v127 offset:25600
    v_mfma_f32_16x16x32_bf16 v[16:19], v[68:71], v[56:59], v[16:19]
    ds_read_b64_tr_b16 v[88:89], v157 offset:0
    ds_read_b64_tr_b16 v[90:91], v157 offset:2048
    v_mfma_f32_16x16x32_bf16 v[20:23], v[72:75], v[52:55], v[20:23]
    ds_read_b64_tr_b16 v[92:93], v158 offset:0
    ds_read_b64_tr_b16 v[94:95], v158 offset:2048
    v_mfma_f32_16x16x32_bf16 v[24:27], v[72:75], v[56:59], v[24:27]
    ds_read_b64_tr_b16 v[96:97], v159 offset:0
    ds_read_b64_tr_b16 v[98:99], v159 offset:2048
    v_mfma_f32_16x16x32_bf16 v[28:31], v[76:79], v[52:55], v[28:31]
    ds_read_b64_tr_b16 v[100:101], v160 offset:0
    ds_read_b64_tr_b16 v[102:103], v160 offset:2048
    v_mfma_f32_16x16x32_bf16 v[32:35], v[76:79], v[56:59], v[32:35]
    ds_read_b64_tr_b16 v[104:105], v161 offset:0
    ds_read_b64_tr_b16 v[106:107], v161 offset:2048
    v_mfma_f32_16x16x32_bf16 v[36:39], v[80:83], v[52:55], v[36:39]
    v_mfma_f32_16x16x32_bf16 v[40:43], v[80:83], v[56:59], v[40:43]
    v_mfma_f32_16x16x32_bf16 v[44:47], v[84:87], v[52:55], v[44:47]
    v_mfma_f32_16x16x32_bf16 v[48:51], v[84:87], v[56:59], v[48:51]
    s_waitcnt lgkmcnt(0)
    s_waitcnt vmcnt(3)
    s_barrier
    v_mfma_f32_16x16x32_bf16 v[12:15], v[88:91], v[60:63], v[12:15]
    ds_read_b128 v[52:55], v126 offset:12288
    ds_read_b128 v[56:59], v126 offset:26624
    v_mfma_f32_16x16x32_bf16 v[16:19], v[88:91], v[64:67], v[16:19]
    ds_read_b64_tr_b16 v[68:69], v157 offset:20480
    ds_read_b64_tr_b16 v[70:71], v157 offset:22528
    v_mfma_f32_16x16x32_bf16 v[20:23], v[92:95], v[60:63], v[20:23]
    ds_read_b64_tr_b16 v[72:73], v158 offset:20480
    ds_read_b64_tr_b16 v[74:75], v158 offset:22528
    v_mfma_f32_16x16x32_bf16 v[24:27], v[92:95], v[64:67], v[24:27]
    ds_read_b64_tr_b16 v[76:77], v159 offset:20480
    ds_read_b64_tr_b16 v[78:79], v159 offset:22528
    v_mfma_f32_16x16x32_bf16 v[28:31], v[96:99], v[60:63], v[28:31]
    ds_read_b64_tr_b16 v[80:81], v160 offset:20480
    ds_read_b64_tr_b16 v[82:83], v160 offset:22528
    v_mfma_f32_16x16x32_bf16 v[32:35], v[96:99], v[64:67], v[32:35]
    ds_read_b64_tr_b16 v[84:85], v161 offset:20480
    ds_read_b64_tr_b16 v[86:87], v161 offset:22528
    v_mfma_f32_16x16x32_bf16 v[36:39], v[100:103], v[60:63], v[36:39]
    v_mfma_f32_16x16x32_bf16 v[40:43], v[100:103], v[64:67], v[40:43]
    v_mfma_f32_16x16x32_bf16 v[44:47], v[104:107], v[60:63], v[44:47]
    v_mfma_f32_16x16x32_bf16 v[48:51], v[104:107], v[64:67], v[48:51]
    s_waitcnt lgkmcnt(0)
    s_waitcnt vmcnt(0)
    s_barrier
    v_mfma_f32_16x16x32_bf16 v[12:15], v[68:71], v[52:55], v[12:15]
    ds_read_b128 v[60:63], v127 offset:13312
    ds_read_b128 v[64:67], v127 offset:27648
    v_mfma_f32_16x16x32_bf16 v[16:19], v[68:71], v[56:59], v[16:19]
    ds_read_b64_tr_b16 v[88:89], v152 offset:0
    ds_read_b64_tr_b16 v[90:91], v152 offset:2048
    v_mfma_f32_16x16x32_bf16 v[20:23], v[72:75], v[52:55], v[20:23]
    ds_read_b64_tr_b16 v[92:93], v153 offset:0
    ds_read_b64_tr_b16 v[94:95], v153 offset:2048
    v_mfma_f32_16x16x32_bf16 v[24:27], v[72:75], v[56:59], v[24:27]
    ds_read_b64_tr_b16 v[96:97], v154 offset:0
    ds_read_b64_tr_b16 v[98:99], v154 offset:2048
    v_mfma_f32_16x16x32_bf16 v[28:31], v[76:79], v[52:55], v[28:31]
    ds_read_b64_tr_b16 v[100:101], v155 offset:0
    ds_read_b64_tr_b16 v[102:103], v155 offset:2048
    v_mfma_f32_16x16x32_bf16 v[32:35], v[76:79], v[56:59], v[32:35]
    ds_read_b64_tr_b16 v[104:105], v156 offset:0
    ds_read_b64_tr_b16 v[106:107], v156 offset:2048
    v_mfma_f32_16x16x32_bf16 v[36:39], v[80:83], v[52:55], v[36:39]
    v_mfma_f32_16x16x32_bf16 v[40:43], v[80:83], v[56:59], v[40:43]
    v_mfma_f32_16x16x32_bf16 v[44:47], v[84:87], v[52:55], v[44:47]
    v_mfma_f32_16x16x32_bf16 v[48:51], v[84:87], v[56:59], v[48:51]
    s_waitcnt lgkmcnt(0)
    s_barrier
    v_mfma_f32_16x16x32_bf16 v[12:15], v[88:91], v[60:63], v[12:15]
    v_mfma_f32_16x16x32_bf16 v[16:19], v[88:91], v[64:67], v[16:19]
    v_mfma_f32_16x16x32_bf16 v[20:23], v[92:95], v[60:63], v[20:23]
    v_mfma_f32_16x16x32_bf16 v[24:27], v[92:95], v[64:67], v[24:27]
    v_mfma_f32_16x16x32_bf16 v[28:31], v[96:99], v[60:63], v[28:31]
    v_mfma_f32_16x16x32_bf16 v[32:35], v[96:99], v[64:67], v[32:35]
    v_mfma_f32_16x16x32_bf16 v[36:39], v[100:103], v[60:63], v[36:39]
    v_mfma_f32_16x16x32_bf16 v[40:43], v[100:103], v[64:67], v[40:43]
    v_mfma_f32_16x16x32_bf16 v[44:47], v[104:107], v[60:63], v[44:47]
    v_mfma_f32_16x16x32_bf16 v[48:51], v[104:107], v[64:67], v[48:51]
    s_branch p1_B_epi
p1_B_F1:
    s_waitcnt vmcnt(6)
    s_barrier
    v_mfma_f32_16x16x32_bf16 v[12:15], v[68:71], v[52:55], 0
    ds_read_b128 v[60:63], v127 offset:1024
    ds_read_b128 v[64:67], v127 offset:15360
    v_mfma_f32_16x16x32_bf16 v[16:19], v[68:71], v[56:59], 0
    ds_read_b64_tr_b16 v[88:89], v157 offset:0
    ds_read_b64_tr_b16 v[90:91], v157 offset:2048
    v_mfma_f32_16x16x32_bf16 v[20:23], v[72:75], v[52:55], 0
    ds_read_b64_tr_b16 v[92:93], v158 offset:0
    ds_read_b64_tr_b16 v[94:95], v158 offset:2048
    v_mfma_f32_16x16x32_bf16 v[24:27], v[72:75], v[56:59], 0
    s_add_u32 m0, s47, 40960
    s_nop 0
    buffer_load_dwordx4 v124, s[12:15], s43 offen lds
    v_add_u32 v124, 86016, v124
    v_mfma_f32_16x16x32_bf16 v[28:31], v[76:79], v[52:55], 0
    ds_read_b64_tr_b16 v[96:97], v159 offset:0
    ds_read_b64_tr_b16 v[98:99], v159 offset:2048
    v_mfma_f32_16x16x32_bf16 v[32:35], v[76:79], v[56:59], 0
    ds_read_b64_tr_b16 v[100:101], v160 offset:0
    ds_read_b64_tr_b16 v[102:103], v160 offset:2048
    v_mfma_f32_16x16x32_bf16 v[36:39], v[80:83], v[52:55], 0
    ds_read_b64_tr_b16 v[104:105], v161 offset:0
    ds_read_b64_tr_b16 v[106:107], v161 offset:2048
    v_mfma_f32_16x16x32_bf16 v[40:43], v[80:83], v[56:59], 0
    s_add_u32 m0, s47, 49152
    s_nop 0
    buffer_load_dwordx4 v125, s[16:19], s44 offen lds
    v_add_u32 v125, 114688, v125
    v_mfma_f32_16x16x32_bf16 v[44:47], v[84:87], v[52:55], 0
    v_mfma_f32_16x16x32_bf16 v[48:51], v[84:87], v[56:59], 0
    s_waitcnt lgkmcnt(0)
    s_waitcnt vmcnt(6)
    s_barrier
    v_mfma_f32_16x16x32_bf16 v[12:15], v[88:91], v[60:63], v[12:15]
    ds_read_b128 v[52:55], v126 offset:2048
    ds_read_b128 v[56:59], v126 offset:16384
    v_mfma_f32_16x16x32_bf16 v[16:19], v[88:91], v[64:67], v[16:19]
    ds_read_b64_tr_b16 v[68:69], v157 offset:20480
    ds_read_b64_tr_b16 v[70:71], v157 offset:22528
    v_mfma_f32_16x16x32_bf16 v[20:23], v[92:95], v[60:63], v[20:23]
    ds_read_b64_tr_b16 v[72:73], v158 offset:20480
    ds_read_b64_tr_b16 v[74:75], v158 offset:22528
    v_mfma_f32_16x16x32_bf16 v[24:27], v[92:95], v[64:67], v[24:27]
    s_add_u32 m0, s47, 61440
    s_nop 0
    buffer_load_dwordx4 v124, s[12:15], s43 offen lds
    v_add_u32 v124, 86016, v124
    v_mfma_f32_16x16x32_bf16 v[28:31], v[96:99], v[60:63], v[28:31]
    ds_read_b64_tr_b16 v[76:77], v159 offset:20480
    ds_read_b64_tr_b16 v[78:79], v159 offset:22528
    v_mfma_f32_16x16x32_bf16 v[32:35], v[96:99], v[64:67], v[32:35]
    ds_read_b64_tr_b16 v[80:81], v160 offset:20480
    ds_read_b64_tr_b16 v[82:83], v160 offset:22528
    v_mfma_f32_16x16x32_bf16 v[36:39], v[100:103], v[60:63], v[36:39]
    ds_read_b64_tr_b16 v[84:85], v161 offset:20480
    ds_read_b64_tr_b16 v[86:87], v161 offset:22528
    v_mfma_f32_16x16x32_bf16 v[40:43], v[100:103], v[64:67], v[40:43]
    s_add_u32 m0, s47, 69632
    s_nop 0
    buffer_load_dwordx4 v125, s[16:19], s44 offen lds
    v_add_u32 v125, 114688, v125
    v_mfma_f32_16x16x32_bf16 v[44:47], v[104:107], v[60:63], v[44:47]
    v_mfma_f32_16x16x32_bf16 v[48:51], v[104:107], v[64:67], v[48:51]
    s_waitcnt lgkmcnt(0)
    s_waitcnt vmcnt(6)
    s_barrier
    v_mfma_f32_16x16x32_bf16 v[12:15], v[68:71], v[52:55], v[12:15]
    ds_read_b128 v[60:63], v127 offset:3072
    ds_read_b128 v[64:67], v127 offset:17408
    v_mfma_f32_16x16x32_bf16 v[16:19], v[68:71], v[56:59], v[16:19]
    ds_read_b64_tr_b16 v[88:89], v152 offset:0
    ds_read_b64_tr_b16 v[90:91], v152 offset:2048
    v_mfma_f32_16x16x32_bf16 v[20:23], v[72:75], v[52:55], v[20:23]
    ds_read_b64_tr_b16 v[92:93], v153 offset:0
    ds_read_b64_tr_b16 v[94:95], v153 offset:2048
    v_mfma_f32_16x16x32_bf16 v[24:27], v[72:75], v[56:59], v[24:27]
    s_add_u32 m0, s47, 81920
    s_nop 0
    buffer_load_dwordx4 v124, s[12:15], s43 offen lds
    v_add_u32 v124, 86016, v124
    v_mfma_f32_16x16x32_bf16 v[28:31], v[76:79], v[52:55], v[28:31]
    ds_read_b64_tr_b16 v[96:97], v154 offset:0
    ds_read_b64_tr_b16 v[98:99], v154 offset:2048
    v_mfma_f32_16x16x32_bf16 v[32:35], v[76:79], v[56:59], v[32:35]
    ds_read_b64_tr_b16 v[100:101], v155 offset:0
    ds_read_b64_tr_b16 v[102:103], v155 offset:2048
    v_mfma_f32_16x16x32_bf16 v[36:39], v[80:83], v[52:55], v[36:39]
    ds_read_b64_tr_b16 v[104:105], v156 offset:0
    ds_read_b64_tr_b16 v[106:107], v156 offset:2048
    v_mfma_f32_16x16x32_bf16 v[40:43], v[80:83], v[56:59], v[40:43]
    s_add_u32 m0, s47, 90112
    s_nop 0
    buffer_load_dwordx4 v125, s[16:19], s44 offen lds
    v_add_u32 v125, 114688, v125
    v_mfma_f32_16x16x32_bf16 v[44:47], v[84:87], v[52:55], v[44:47]
    v_mfma_f32_16x16x32_bf16 v[48:51], v[84:87], v[56:59], v[48:51]
    s_waitcnt lgkmcnt(0)
    s_waitcnt vmcnt(6)
    s_barrier
    v_mfma_f32_16x16x32_bf16 v[12:15], v[88:91], v[60:63], v[12:15]
    ds_read_b128 v[52:55], v126 offset:4096
    ds_read_b128 v[56:59], v126 offset:18432
    v_mfma_f32_16x16x32_bf16 v[16:19], v[88:91], v[64:67], v[16:19]
    ds_read_b64_tr_b16 v[68:69], v152 offset:20480
    ds_read_b64_tr_b16 v[70:71], v152 offset:22528
    v_mfma_f32_16x16x32_bf16 v[20:23], v[92:95], v[60:63], v[20:23]
    ds_read_b64_tr_b16 v[72:73], v153 offset:20480
    ds_read_b64_tr_b16 v[74:75], v153 offset:22528
    v_mfma_f32_16x16x32_bf16 v[24:27], v[92:95], v[64:67], v[24:27]
    s_add_u32 m0, s47, 0
    s_nop 0
    buffer_load_dwordx4 v124, s[12:15], s43 offen lds
    v_add_u32 v124, 86016, v124
    v_mfma_f32_16x16x32_bf16 v[28:31], v[96:99], v[60:63], v[28:31]
    ds_read_b64_tr_b16 v[76:77], v154 offset:20480
    ds_read_b64_tr_b16 v[78:79], v154 offset:22528
    v_mfma_f32_16x16x32_bf16 v[32:35], v[96:99], v[64:67], v[32:35]
    ds_read_b64_tr_b16 v[80:81], v155 offset:20480
    ds_read_b64_tr_b16 v[82:83], v155 offset:22528
    v_mfma_f32_16x16x32_bf16 v[36:39], v[100:103], v[60:63], v[36:39]
    ds_read_b64_tr_b16 v[84:85], v156 offset:20480
    ds_read_b64_tr_b16 v[86:87], v156 offset:22528
    v_mfma_f32_16x16x32_bf16 v[40:43], v[100:103], v[64:67], v[40:43]
    s_add_u32 m0, s47, 8192
    s_nop 0
    buffer_load_dwordx4 v125, s[16:19], s44 offen lds
    v_add_u32 v125, 114688, v125
    v_mfma_f32_16x16x32_bf16 v[44:47], v[104:107], v[60:63], v[44:47]
    v_mfma_f32_16x16x32_bf16 v[48:51], v[104:107], v[64:67], v[48:51]
    s_waitcnt lgkmcnt(0)
    s_waitcnt vmcnt(6)
    s_barrier
    v_mfma_f32_16x16x32_bf16 v[12:15], v[68:71], v[52:55], v[12:15]
    ds_read_b128 v[60:63], v127 offset:5120
    ds_read_b128 v[64:67], v127 offset:19456
    v_mfma_f32_16x16x32_bf16 v[16:19], v[68:71], v[56:59], v[16:19]
    ds_read_b64_tr_b16 v[88:89], v152 offset:40960
    ds_read_b64_tr_b16 v[90:91], v152 offset:43008
    v_mfma_f32_16x16x32_bf16 v[20:23], v[72:75], v[52:55], v[20:23]
    ds_read_b64_tr_b16 v[92:93], v153 offset:40960
    ds_read_b64_tr_b16 v[94:95], v153 offset:43008
    v_mfma_f32_16x16x32_bf16 v[24:27], v[72:75], v[56:59], v[24:27]
    s_add_u32 m0, s47, 20480
    s_nop 0
    buffer_load_dwordx4 v124, s[12:15], s43 offen lds
    v_add_u32 v124, 86016, v124
    v_mfma_f32_16x16x32_bf16 v[28:31], v[76:79], v[52:55], v[28:31]
    ds_read_b64_tr_b16 v[96:97], v154 offset:40960
    ds_read_b64_tr_b16 v[98:99], v154 offset:43008
    v_mfma_f32_16x16x32_bf16 v[32:35], v[76:79], v[56:59], v[32:35]
    ds_read_b64_tr_b16 v[100:101], v155 offset:40960
    ds_read_b64_tr_b16 v[102:103], v155 offset:43008
    v_mfma_f32_16x16x32_bf16 v[36:39], v[80:83], v[52:55], v[36:39]
    ds_read_b64_tr_b16 v[104:105], v156 offset:40960
    ds_read_b64_tr_b16 v[106:107], v156 offset:43008
    v_mfma_f32_16x16x32_bf16 v[40:43], v[80:83], v[56:59], v[40:43]
    s_add_u32 m0, s47, 28672
    s_nop 0
    buffer_load_dwordx4 v125, s[16:19], s44 offen lds
    v_add_u32 v125, 114688, v125
    v_mfma_f32_16x16x32_bf16 v[44:47], v[84:87], v[52:55], v[44:47]
    v_mfma_f32_16x16x32_bf16 v[48:51], v[84:87], v[56:59], v[48:51]
    s_waitcnt lgkmcnt(0)
    s_waitcnt vmcnt(6)
    s_barrier
    v_mfma_f32_16x16x32_bf16 v[12:15], v[88:91], v[60:63], v[12:15]
    ds_read_b128 v[52:55], v126 offset:6144
    ds_read_b128 v[56:59], v126 offset:20480
    v_mfma_f32_16x16x32_bf16 v[16:19], v[88:91], v[64:67], v[16:19]
    ds_read_b64_tr_b16 v[68:69], v157 offset:0
    ds_read_b64_tr_b16 v[70:71], v157 offset:2048
    v_mfma_f32_16x16x32_bf16 v[20:23], v[92:95], v[60:63], v[20:23]
    ds_read_b64_tr_b16 v[72:73], v158 offset:0
    ds_read_b64_tr_b16 v[74:75], v158 offset:2048
    v_mfma_f32_16x16x32_bf16 v[24:27], v[92:95], v[64:67], v[24:27]
    s_add_u32 m0, s47, 40960
    s_nop 0
    buffer_load_dwordx4 v124, s[12:15], s43 offen lds
    v_add_u32 v124, 86016, v124
    v_mfma_f32_16x16x32_bf16 v[28:31], v[96:99], v[60:63], v[28:31]
    ds_read_b64_tr_b16 v[76:77], v159 offset:0
    ds_read_b64_tr_b16 v[78:79], v159 offset:2048
    v_mfma_f32_16x16x32_bf16 v[32:35], v[96:99], v[64:67], v[32:35]
    ds_read_b64_tr_b16 v[80:81], v160 offset:0
    ds_read_b64_tr_b16 v[82:83], v160 offset:2048
    v_mfma_f32_16x16x32_bf16 v[36:39], v[100:103], v[60:63], v[36:39]
    ds_read_b64_tr_b16 v[84:85], v161 offset:0
    ds_read_b64_tr_b16 v[86:87], v161 offset:2048
    v_mfma_f32_16x16x32_bf16 v[40:43], v[100:103], v[64:67], v[40:43]
    s_add_u32 m0, s47, 49152
    s_nop 0
    buffer_load_dwordx4 v125, s[16:19], s44 offen lds
    v_add_u32 v125, 114688, v125
    v_mfma_f32_16x16x32_bf16 v[44:47], v[104:107], v[60:63], v[44:47]
    v_mfma_f32_16x16x32_bf16 v[48:51], v[104:107], v[64:67], v[48:51]
    s_waitcnt lgkmcnt(0)
    s_waitcnt vmcnt(6)
    s_barrier
    v_mfma_f32_16x16x32_bf16 v[12:15], v[68:71], v[52:55], v[12:15]
    ds_read_b128 v[60:63], v127 offset:7168
    ds_read_b128 v[64:67], v127 offset:21504
    v_mfma_f32_16x16x32_bf16 v[16:19], v[68:71], v[56:59], v[16:19]
    ds_read_b64_tr_b16 v[88:89], v157 offset:20480
    ds_read_b64_tr_b16 v[90:91], v157 offset:22528
    v_mfma_f32_16x16x32_bf16 v[20:23], v[72:75], v[52:55], v[20:23]
    ds_read_b64_tr_b16 v[92:93], v158 offset:20480
    ds_read_b64_tr_b16 v[94:95], v158 offset:22528
    v_mfma_f32_16x16x32_bf16 v[24:27], v[72:75], v[56:59], v[24:27]
    s_add_u32 m0, s47, 61440
    s_nop 0
    buffer_load_dwordx4 v124, s[12:15], s43 offen lds
    v_add_u32 v124, 86016, v124
    v_mfma_f32_16x16x32_bf16 v[28:31], v[76:79], v[52:55], v[28:31]
    ds_read_b64_tr_b16 v[96:97], v159 offset:20480
    ds_read_b64_tr_b16 v[98:99], v159 offset:22528
    v_mfma_f32_16x16x32_bf16 v[32:35], v[76:79], v[56:59], v[32:35]
    ds_read_b64_tr_b16 v[100:101], v160 offset:20480
    ds_read_b64_tr_b16 v[102:103], v160 offset:22528
    v_mfma_f32_16x16x32_bf16 v[36:39], v[80:83], v[52:55], v[36:39]
    ds_read_b64_tr_b16 v[104:105], v161 offset:20480
    ds_read_b64_tr_b16 v[106:107], v161 offset:22528
    v_mfma_f32_16x16x32_bf16 v[40:43], v[80:83], v[56:59], v[40:43]
    s_add_u32 m0, s47, 69632
    s_nop 0
    buffer_load_dwordx4 v125, s[16:19], s44 offen lds
    v_add_u32 v125, 114688, v125
    v_mfma_f32_16x16x32_bf16 v[44:47], v[84:87], v[52:55], v[44:47]
    v_mfma_f32_16x16x32_bf16 v[48:51], v[84:87], v[56:59], v[48:51]
    s_waitcnt lgkmcnt(0)
    s_waitcnt vmcnt(6)
    s_barrier
    v_mfma_f32_16x16x32_bf16 v[12:15], v[88:91], v[60:63], v[12:15]
    ds_read_b128 v[52:55], v126 offset:8192
    ds_read_b128 v[56:59], v126 offset:22528
    v_mfma_f32_16x16x32_bf16 v[16:19], v[88:91], v[64:67], v[16:19]
    ds_read_b64_tr_b16 v[68:69], v152 offset:0
    ds_read_b64_tr_b16 v[70:71], v152 offset:2048
    v_mfma_f32_16x16x32_bf16 v[20:23], v[92:95], v[60:63], v[20:23]
    ds_read_b64_tr_b16 v[72:73], v153 offset:0
    ds_read_b64_tr_b16 v[74:75], v153 offset:2048
    v_mfma_f32_16x16x32_bf16 v[24:27], v[92:95], v[64:67], v[24:27]
    s_add_u32 m0, s47, 81920
    s_nop 0
    buffer_load_dwordx4 v124, s[12:15], s43 offen lds
    v_add_u32 v124, 86016, v124
    v_mfma_f32_16x16x32_bf16 v[28:31], v[96:99], v[60:63], v[28:31]
    ds_read_b64_tr_b16 v[76:77], v154 offset:0
    ds_read_b64_tr_b16 v[78:79], v154 offset:2048
    v_mfma_f32_16x16x32_bf16 v[32:35], v[96:99], v[64:67], v[32:35]
    ds_read_b64_tr_b16 v[80:81], v155 offset:0
    ds_read_b64_tr_b16 v[82:83], v155 offset:2048
    v_mfma_f32_16x16x32_bf16 v[36:39], v[100:103], v[60:63], v[36:39]
    ds_read_b64_tr_b16 v[84:85], v156 offset:0
    ds_read_b64_tr_b16 v[86:87], v156 offset:2048
    v_mfma_f32_16x16x32_bf16 v[40:43], v[100:103], v[64:67], v[40:43]
    s_add_u32 m0, s47, 90112
    s_nop 0
    buffer_load_dwordx4 v125, s[16:19], s44 offen lds
    v_add_u32 v125, 114688, v125
    v_mfma_f32_16x16x32_bf16 v[44:47], v[104:107], v[60:63], v[44:47]
    v_mfma_f32_16x16x32_bf16 v[48:51], v[104:107], v[64:67], v[48:51]
    s_waitcnt lgkmcnt(0)
    s_waitcnt vmcnt(6)
    s_barrier
    v_mfma_f32_16x16x32_bf16 v[12:15], v[68:71], v[52:55], v[12:15]
    ds_read_b128 v[60:63], v127 offset:9216
    ds_read_b128 v[64:67], v127 offset:23552
    v_mfma_f32_16x16x32_bf16 v[16:19], v[68:71], v[56:59], v[16:19]
    ds_read_b64_tr_b16 v[88:89], v152 offset:20480
    ds_read_b64_tr_b16 v[90:91], v152 offset:22528
    v_mfma_f32_16x16x32_bf16 v[20:23], v[72:75], v[52:55], v[20:23]
    ds_read_b64_tr_b16 v[92:93], v153 offset:20480
    ds_read_b64_tr_b16 v[94:95], v153 offset:22528
    v_mfma_f32_16x16x32_bf16 v[24:27], v[72:75], v[56:59], v[24:27]
    s_add_u32 m0, s47, 0
    s_nop 0
    buffer_load_dwordx4 v124, s[12:15], s43 offen lds
    v_add_u32 v124, 86016, v124
    v_mfma_f32_16x16x32_bf16 v[28:31], v[76:79], v[52:55], v[28:31]
    ds_read_b64_tr_b16 v[96:97], v154 offset:20480
    ds_read_b64_tr_b16 v[98:99], v154 offset:22528
    v_mfma_f32_16x16x32_bf16 v[32:35], v[76:79], v[56:59], v[32:35]
    ds_read_b64_tr_b16 v[100:101], v155 offset:20480
    ds_read_b64_tr_b16 v[102:103], v155 offset:22528
    v_mfma_f32_16x16x32_bf16 v[36:39], v[80:83], v[52:55], v[36:39]
    ds_read_b64_tr_b16 v[104:105], v156 offset:20480
    ds_read_b64_tr_b16 v[106:107], v156 offset:22528
    v_mfma_f32_16x16x32_bf16 v[40:43], v[80:83], v[56:59], v[40:43]
    s_add_u32 m0, s47, 8192
    s_nop 0
    buffer_load_dwordx4 v125, s[16:19], s44 offen lds
    v_add_u32 v125, 114688, v125
    v_mfma_f32_16x16x32_bf16 v[44:47], v[84:87], v[52:55], v[44:47]
    v_mfma_f32_16x16x32_bf16 v[48:51], v[84:87], v[56:59], v[48:51]
    s_waitcnt lgkmcnt(0)
    s_waitcnt vmcnt(6)
    s_barrier
    v_mfma_f32_16x16x32_bf16 v[12:15], v[88:91], v[60:63], v[12:15]
    ds_read_b128 v[52:55], v126 offset:10240
    ds_read_b128 v[56:59], v126 offset:24576
    v_mfma_f32_16x16x32_bf16 v[16:19], v[88:91], v[64:67], v[16:19]
    ds_read_b64_tr_b16 v[68:69], v152 offset:40960
    ds_read_b64_tr_b16 v[70:71], v152 offset:43008
    v_mfma_f32_16x16x32_bf16 v[20:23], v[92:95], v[60:63], v[20:23]
    ds_read_b64_tr_b16 v[72:73], v153 offset:40960
    ds_read_b64_tr_b16 v[74:75], v153 offset:43008
    v_mfma_f32_16x16x32_bf16 v[24:27], v[92:95], v[64:67], v[24:27]
    ds_read_b64_tr_b16 v[76:77], v154 offset:40960
    ds_read_b64_tr_b16 v[78:79], v154 offset:43008
    v_mfma_f32_16x16x32_bf16 v[28:31], v[96:99], v[60:63], v[28:31]
    ds_read_b64_tr_b16 v[80:81], v155 offset:40960
    ds_read_b64_tr_b16 v[82:83], v155 offset:43008
    v_mfma_f32_16x16x32_bf16 v[32:35], v[96:99], v[64:67], v[32:35]
    ds_read_b64_tr_b16 v[84:85], v156 offset:40960
    ds_read_b64_tr_b16 v[86:87], v156 offset:43008
    v_mfma_f32_16x16x32_bf16 v[36:39], v[100:103], v[60:63], v[36:39]
    v_mfma_f32_16x16x32_bf16 v[40:43], v[100:103], v[64:67], v[40:43]
    v_mfma_f32_16x16x32_bf16 v[44:47], v[104:107], v[60:63], v[44:47]
    v_mfma_f32_16x16x32_bf16 v[48:51], v[104:107], v[64:67], v[48:51]
    s_waitcnt lgkmcnt(0)
    s_waitcnt vmcnt(4)
    s_barrier
    v_mfma_f32_16x16x32_bf16 v[12:15], v[68:71], v[52:55], v[12:15]
    ds_read_b128 v[60:63], v127 offset:11264
    ds_read_b128 v[64:67], v127 offset:25600
    v_mfma_f32_16x16x32_bf16 v[16:19], v[68:71], v[56:59], v[16:19]
    ds_read_b64_tr_b16 v[88:89], v157 offset:0
    ds_read_b64_tr_b16 v[90:91], v157 offset:2048
    v_mfma_f32_16x16x32_bf16 v[20:23], v[72:75], v[52:55], v[20:23]
    ds_read_b64_tr_b16 v[92:93], v158 offset:0
    ds_read_b64_tr_b16 v[94:95], v158 offset:2048
    v_mfma_f32_16x16x32_bf16 v[24:27], v[72:75], v[56:59], v[24:27]
    ds_read_b64_tr_b16 v[96:97], v159 offset:0
    ds_read_b64_tr_b16 v[98:99], v159 offset:2048
    v_mfma_f32_16x16x32_bf16 v[28:31], v[76:79], v[52:55], v[28:31]
    ds_read_b64_tr_b16 v[100:101], v160 offset:0
    ds_read_b64_tr_b16 v[102:103], v160 offset:2048
    v_mfma_f32_16x16x32_bf16 v[32:35], v[76:79], v[56:59], v[32:35]
    ds_read_b64_tr_b16 v[104:105], v161 offset:0
    ds_read_b64_tr_b16 v[106:107], v161 offset:2048
    v_mfma_f32_16x16x32_bf16 v[36:39], v[80:83], v[52:55], v[36:39]
    v_mfma_f32_16x16x32_bf16 v[40:43], v[80:83], v[56:59], v[40:43]
    v_mfma_f32_16x16x32_bf16 v[44:47], v[84:87], v[52:55], v[44:47]
    v_mfma_f32_16x16x32_bf16 v[48:51], v[84:87], v[56:59], v[48:51]
    s_waitcnt lgkmcnt(0)
    s_waitcnt vmcnt(2)
    s_barrier
    v_mfma_f32_16x16x32_bf16 v[12:15], v[88:91], v[60:63], v[12:15]
    ds_read_b128 v[52:55], v126 offset:12288
    ds_read_b128 v[56:59], v126 offset:26624
    v_mfma_f32_16x16x32_bf16 v[16:19], v[88:91], v[64:67], v[16:19]
    ds_read_b64_tr_b16 v[68:69], v157 offset:20480
    ds_read_b64_tr_b16 v[70:71], v157 offset:22528
    v_mfma_f32_16x16x32_bf16 v[20:23], v[92:95], v[60:63], v[20:23]
    ds_read_b64_tr_b16 v[72:73], v158 offset:20480
    ds_read_b64_tr_b16 v[74:75], v158 offset:22528
    v_mfma_f32_16x16x32_bf16 v[24:27], v[92:95], v[64:67], v[24:27]
    ds_read_b64_tr_b16 v[76:77], v159 offset:20480
    ds_read_b64_tr_b16 v[78:79], v159 offset:22528
    v_mfma_f32_16x16x32_bf16 v[28:31], v[96:99], v[60:63], v[28:31]
    ds_read_b64_tr_b16 v[80:81], v160 offset:20480
    ds_read_b64_tr_b16 v[82:83], v160 offset:22528
    v_mfma_f32_16x16x32_bf16 v[32:35], v[96:99], v[64:67], v[32:35]
    ds_read_b64_tr_b16 v[84:85], v161 offset:20480
    ds_read_b64_tr_b16 v[86:87], v161 offset:22528
    v_mfma_f32_16x16x32_bf16 v[36:39], v[100:103], v[60:63], v[36:39]
    v_mfma_f32_16x16x32_bf16 v[40:43], v[100:103], v[64:67], v[40:43]
    v_mfma_f32_16x16x32_bf16 v[44:47], v[104:107], v[60:63], v[44:47]
    v_mfma_f32_16x16x32_bf16 v[48:51], v[104:107], v[64:67], v[48:51]
    s_waitcnt lgkmcnt(0)
    s_waitcnt vmcnt(0)
    s_barrier
    v_mfma_f32_16x16x32_bf16 v[12:15], v[68:71], v[52:55], v[12:15]
    ds_read_b128 v[60:63], v127 offset:13312
    ds_read_b128 v[64:67], v127 offset:27648
    v_mfma_f32_16x16x32_bf16 v[16:19], v[68:71], v[56:59], v[16:19]
    ds_read_b64_tr_b16 v[88:89], v152 offset:0
    ds_read_b64_tr_b16 v[90:91], v152 offset:2048
    v_mfma_f32_16x16x32_bf16 v[20:23], v[72:75], v[52:55], v[20:23]
    ds_read_b64_tr_b16 v[92:93], v153 offset:0
    ds_read_b64_tr_b16 v[94:95], v153 offset:2048
    v_mfma_f32_16x16x32_bf16 v[24:27], v[72:75], v[56:59], v[24:27]
    ds_read_b64_tr_b16 v[96:97], v154 offset:0
    ds_read_b64_tr_b16 v[98:99], v154 offset:2048
    v_mfma_f32_16x16x32_bf16 v[28:31], v[76:79], v[52:55], v[28:31]
    ds_read_b64_tr_b16 v[100:101], v155 offset:0
    ds_read_b64_tr_b16 v[102:103], v155 offset:2048
    v_mfma_f32_16x16x32_bf16 v[32:35], v[76:79], v[56:59], v[32:35]
    ds_read_b64_tr_b16 v[104:105], v156 offset:0
    ds_read_b64_tr_b16 v[106:107], v156 offset:2048
    v_mfma_f32_16x16x32_bf16 v[36:39], v[80:83], v[52:55], v[36:39]
    v_mfma_f32_16x16x32_bf16 v[40:43], v[80:83], v[56:59], v[40:43]
    v_mfma_f32_16x16x32_bf16 v[44:47], v[84:87], v[52:55], v[44:47]
    v_mfma_f32_16x16x32_bf16 v[48:51], v[84:87], v[56:59], v[48:51]
    s_cmp_eq_u32 s28, 5
    s_cbranch_scc1 p1_B_F1_k12_x
p1_B_F1_k12_r:
    s_waitcnt lgkmcnt(0)
    s_barrier
    v_mfma_f32_16x16x32_bf16 v[12:15], v[88:91], v[60:63], v[12:15]
    v_mfma_f32_16x16x32_bf16 v[16:19], v[88:91], v[64:67], v[16:19]
    v_mfma_f32_16x16x32_bf16 v[20:23], v[92:95], v[60:63], v[20:23]
    v_mfma_f32_16x16x32_bf16 v[24:27], v[92:95], v[64:67], v[24:27]
    v_mfma_f32_16x16x32_bf16 v[28:31], v[96:99], v[60:63], v[28:31]
    v_mfma_f32_16x16x32_bf16 v[32:35], v[96:99], v[64:67], v[32:35]
    v_mfma_f32_16x16x32_bf16 v[36:39], v[100:103], v[60:63], v[36:39]
    v_mfma_f32_16x16x32_bf16 v[40:43], v[100:103], v[64:67], v[40:43]
    v_mfma_f32_16x16x32_bf16 v[44:47], v[104:107], v[60:63], v[44:47]
    v_mfma_f32_16x16x32_bf16 v[48:51], v[104:107], v[64:67], v[48:51]
    s_branch p1_B_epi
p1_B_T:
    s_cmp_lg_u32 s36, 0
    s_cbranch_scc1 p1_B_T1
p1_B_T0:
    s_waitcnt vmcnt(9)
    s_barrier
    v_mfma_f32_16x16x32_bf16 v[12:15], v[52:55], v[68:71], 0
    ds_read_b128 v[60:63], v127 offset:1024
    ds_read_b128 v[64:67], v127 offset:15360
    v_mfma_f32_16x16x32_bf16 v[16:19], v[56:59], v[68:71], 0
    s_add_u32 m0, s47, 40960
    s_nop 0
    buffer_load_dwordx4 v124, s[12:15], s43 offen lds
    v_mfma_f32_16x16x32_bf16 v[20:23], v[52:55], v[72:75], 0
    ds_read_b64_tr_b16 v[88:89], v157 offset:0
    ds_read_b64_tr_b16 v[90:91], v157 offset:2048
    v_mfma_f32_16x16x32_bf16 v[24:27], v[56:59], v[72:75], 0
    ds_read_b64_tr_b16 v[92:93], v158 offset:0
    ds_read_b64_tr_b16 v[94:95], v158 offset:2048
    v_mfma_f32_16x16x32_bf16 v[28:31], v[52:55], v[76:79], 0
    ds_read_b64_tr_b16 v[96:97], v159 offset:0
    ds_read_b64_tr_b16 v[98:99], v159 offset:2048
    v_mfma_f32_16x16x32_bf16 v[32:35], v[56:59], v[76:79], 0
    s_add_u32 m0, s47, 49152
    s_nop 0
    buffer_load_dwordx4 v124, s[12:15], s44 offen lds
    v_add_u32 v124, 86016, v124
    v_mfma_f32_16x16x32_bf16 v[36:39], v[52:55], v[80:83], 0
    ds_read_b64_tr_b16 v[100:101], v160 offset:0
    ds_read_b64_tr_b16 v[102:103], v160 offset:2048
    v_mfma_f32_16x16x32_bf16 v[40:43], v[56:59], v[80:83], 0
    ds_read_b64_tr_b16 v[104:105], v161 offset:0
    ds_read_b64_tr_b16 v[106:107], v161 offset:2048
    v_mfma_f32_16x16x32_bf16 v[44:47], v[84:87], v[52:55], 0
    s_add_u32 m0, s47, 57344
    s_nop 0
    buffer_load_dwordx4 v125, s[16:19], s45 offen lds
    v_add_u32 v125, 114688, v125
    v_mfma_f32_16x16x32_bf16 v[48:51], v[84:87], v[56:59], 0
    s_waitcnt lgkmcnt(0)
    s_waitcnt vmcnt(9)
    s_barrier
    v_mfma_f32_16x16x32_bf16 v[12:15], v[60:63], v[88:91], v[12:15]
    ds_read_b128 v[52:55], v126 offset:2048
    ds_read_b128 v[56:59], v126 offset:16384
    v_mfma_f32_16x16x32_bf16 v[16:19], v[64:67], v[88:91], v[16:19]
    s_add_u32 m0, s47, 61440
    s_nop 0
    buffer_load_dwordx4 v124, s[12:15], s43 offen lds
    v_mfma_f32_16x16x32_bf16 v[20:23], v[60:63], v[92:95], v[20:23]
    ds_read_b64_tr_b16 v[68:69], v157 offset:20480
    ds_read_b64_tr_b16 v[70:71], v157 offset:22528
    v_mfma_f32_16x16x32_bf16 v[24:27], v[64:67], v[92:95], v[24:27]
    ds_read_b64_tr_b16 v[72:73], v158 offset:20480
    ds_read_b64_tr_b16 v[74:75], v158 offset:22528
    v_mfma_f32_16x16x32_bf16 v[28:31], v[60:63], v[96:99], v[28:31]
    ds_read_b64_tr_b16 v[76:77], v159 offset:20480
    ds_read_b64_tr_b16 v[78:79], v159 offset:22528
    v_mfma_f32_16x16x32_bf16 v[32:35], v[64:67], v[96:99], v[32:35]
    s_add_u32 m0, s47, 69632
    s_nop 0
    buffer_load_dwordx4 v124, s[12:15], s44 offen lds
    v_add_u32 v124, 86016, v124
    v_mfma_f32_16x16x32_bf16 v[36:39], v[60:63], v[100:103], v[36:39]
    ds_read_b64_tr_b16 v[80:81], v160 offset:20480
    ds_read_b64_tr_b16 v[82:83], v160 offset:22528
    v_mfma_f32_16x16x32_bf16 v[40:43], v[64:67], v[100:103], v[40:43]
    ds_read_b64_tr_b16 v[84:85], v161 offset:20480
    ds_read_b64_tr_b16 v[86:87], v161 offset:22528
    v_mfma_f32_16x16x32_bf16 v[44:47], v[104:107], v[60:63], v[44:47]
    s_add_u32 m0, s47, 77824
    s_nop 0
    buffer_load_dwordx4 v125, s[16:19], s45 offen lds
    v_add_u32 v125, 114688, v125
    v_mfma_f32_16x16x32_bf16 v[48:51], v[104:107], v[64:67], v[48:51]
    s_waitcnt lgkmcnt(0)
    s_waitcnt vmcnt(9)
    s_barrier
    v_mfma_f32_16x16x32_bf16 v[12:15], v[52:55], v[68:71], v[12:15]
    ds_read_b128 v[60:63], v127 offset:3072
    ds_read_b128 v[64:67], v127 offset:17408
    v_mfma_f32_16x16x32_bf16 v[16:19], v[56:59], v[68:71], v[16:19]
    s_add_u32 m0, s47, 81920
    s_nop 0
    buffer_load_dwordx4 v124, s[12:15], s43 offen lds
    v_mfma_f32_16x16x32_bf16 v[20:23], v[52:55], v[72:75], v[20:23]
    ds_read_b64_tr_b16 v[88:89], v152 offset:0
    ds_read_b64_tr_b16 v[90:91], v152 offset:2048
    v_mfma_f32_16x16x32_bf16 v[24:27], v[56:59], v[72:75], v[24:27]
    ds_read_b64_tr_b16 v[92:93], v153 offset:0
    ds_read_b64_tr_b16 v[94:95], v153 offset:2048
    v_mfma_f32_16x16x32_bf16 v[28:31], v[52:55], v[76:79], v[28:31]
    ds_read_b64_tr_b16 v[96:97], v154 offset:0
    ds_read_b64_tr_b16 v[98:99], v154 offset:2048
    v_mfma_f32_16x16x32_bf16 v[32:35], v[56:59], v[76:79], v[32:35]
    s_add_u32 m0, s47, 90112
    s_nop 0
    buffer_load_dwordx4 v124, s[12:15], s44 offen lds
    v_add_u32 v124, 86016, v124
    v_mfma_f32_16x16x32_bf16 v[36:39], v[52:55], v[80:83], v[36:39]
    ds_read_b64_tr_b16 v[100:101], v155 offset:0
    ds_read_b64_tr_b16 v[102:103], v155 offset:2048
    v_mfma_f32_16x16x32_bf16 v[40:43], v[56:59], v[80:83], v[40:43]
    ds_read_b64_tr_b16 v[104:105], v156 offset:0
    ds_read_b64_tr_b16 v[106:107], v156 offset:2048
    v_mfma_f32_16x16x32_bf16 v[44:47], v[84:87], v[52:55], v[44:47]
    s_add_u32 m0, s47, 98304
    s_nop 0
    buffer_load_dwordx4 v125, s[16:19], s45 offen lds
    v_add_u32 v125, 114688, v125
    v_mfma_f32_16x16x32_bf16 v[48:51], v[84:87], v[56:59], v[48:51]
    s_waitcnt lgkmcnt(0)
    s_waitcnt vmcnt(9)
    s_barrier
    v_mfma_f32_16x16x32_bf16 v[12:15], v[60:63], v[88:91], v[12:15]
    ds_read_b128 v[52:55], v126 offset:4096
    ds_read_b128 v[56:59], v126 offset:18432
    v_mfma_f32_16x16x32_bf16 v[16:19], v[64:67], v[88:91], v[16:19]
    s_add_u32 m0, s47, 0
    s_nop 0
    buffer_load_dwordx4 v124, s[12:15], s43 offen lds
    v_mfma_f32_16x16x32_bf16 v[20:23], v[60:63], v[92:95], v[20:23]
    ds_read_b64_tr_b16 v[68:69], v152 offset:20480
    ds_read_b64_tr_b16 v[70:71], v152 offset:22528
    v_mfma_f32_16x16x32_bf16 v[24:27], v[64:67], v[92:95], v[24:27]
    ds_read_b64_tr_b16 v[72:73], v153 offset:20480
    ds_read_b64_tr_b16 v[74:75], v153 offset:22528
    v_mfma_f32_16x16x32_bf16 v[28:31], v[60:63], v[96:99], v[28:31]
    ds_read_b64_tr_b16 v[76:77], v154 offset:20480
    ds_read_b64_tr_b16 v[78:79], v154 offset:22528
    v_mfma_f32_16x16x32_bf16 v[32:35], v[64:67], v[96:99], v[32:35]
    s_add_u32 m0, s47, 8192
    s_nop 0
    buffer_load_dwordx4 v124, s[12:15], s44 offen lds
    v_add_u32 v124, 86016, v124
    v_mfma_f32_16x16x32_bf16 v[36:39], v[60:63], v[100:103], v[36:39]
    ds_read_b64_tr_b16 v[80:81], v155 offset:20480
    ds_read_b64_tr_b16 v[82:83], v155 offset:22528
    v_mfma_f32_16x16x32_bf16 v[40:43], v[64:67], v[100:103], v[40:43]
    ds_read_b64_tr_b16 v[84:85], v156 offset:20480
    ds_read_b64_tr_b16 v[86:87], v156 offset:22528
    v_mfma_f32_16x16x32_bf16 v[44:47], v[104:107], v[60:63], v[44:47]
    s_add_u32 m0, s47, 16384
    s_nop 0
    buffer_load_dwordx4 v125, s[16:19], s45 offen lds
    v_add_u32 v125, 114688, v125
    v_mfma_f32_16x16x32_bf16 v[48:51], v[104:107], v[64:67], v[48:51]
    s_waitcnt lgkmcnt(0)
    s_waitcnt vmcnt(9)
    s_barrier
    v_mfma_f32_16x16x32_bf16 v[12:15], v[52:55], v[68:71], v[12:15]
    ds_read_b128 v[60:63], v127 offset:5120
    ds_read_b128 v[64:67], v127 offset:19456
    v_mfma_f32_16x16x32_bf16 v[16:19], v[56:59], v[68:71], v[16:19]
    s_add_u32 m0, s47, 20480
    s_nop 0
    buffer_load_dwordx4 v124, s[12:15], s43 offen lds
    v_mfma_f32_16x16x32_bf16 v[20:23], v[52:55], v[72:75], v[20:23]
    ds_read_b64_tr_b16 v[88:89], v152 offset:40960
    ds_read_b64_tr_b16 v[90:91], v152 offset:43008
    v_mfma_f32_16x16x32_bf16 v[24:27], v[56:59], v[72:75], v[24:27]
    ds_read_b64_tr_b16 v[92:93], v153 offset:40960
    ds_read_b64_tr_b16 v[94:95], v153 offset:43008
    v_mfma_f32_16x16x32_bf16 v[28:31], v[52:55], v[76:79], v[28:31]
    ds_read_b64_tr_b16 v[96:97], v154 offset:40960
    ds_read_b64_tr_b16 v[98:99], v154 offset:43008
    v_mfma_f32_16x16x32_bf16 v[32:35], v[56:59], v[76:79], v[32:35]
    s_add_u32 m0, s47, 28672
    s_nop 0
    buffer_load_dwordx4 v124, s[12:15], s44 offen lds
    v_add_u32 v124, 86016, v124
    v_mfma_f32_16x16x32_bf16 v[36:39], v[52:55], v[80:83], v[36:39]
    ds_read_b64_tr_b16 v[100:101], v155 offset:40960
    ds_read_b64_tr_b16 v[102:103], v155 offset:43008
    v_mfma_f32_16x16x32_bf16 v[40:43], v[56:59], v[80:83], v[40:43]
    ds_read_b64_tr_b16 v[104:105], v156 offset:40960
    ds_read_b64_tr_b16 v[106:107], v156 offset:43008
    v_mfma_f32_16x16x32_bf16 v[44:47], v[84:87], v[52:55], v[44:47]
    s_add_u32 m0, s47, 36864
    s_nop 0
    buffer_load_dwordx4 v125, s[16:19], s45 offen lds
    v_add_u32 v125, 114688, v125
    v_mfma_f32_16x16x32_bf16 v[48:51], v[84:87], v[56:59], v[48:51]
    s_waitcnt lgkmcnt(0)
    s_waitcnt vmcnt(9)
    s_barrier
    v_mfma_f32_16x16x32_bf16 v[12:15], v[60:63], v[88:91], v[12:15]
    ds_read_b128 v[52:55], v126 offset:6144
    ds_read_b128 v[56:59], v126 offset:20480
    v_mfma_f32_16x16x32_bf16 v[16:19], v[64:67], v[88:91], v[16:19]
    s_add_u32 m0, s47, 40960
    s_nop 0
    buffer_load_dwordx4 v124, s[12:15], s43 offen lds
    v_mfma_f32_16x16x32_bf16 v[20:23], v[60:63], v[92:95], v[20:23]
    ds_read_b64_tr_b16 v[68:69], v157 offset:0
    ds_read_b64_tr_b16 v[70:71], v157 offset:2048
    v_mfma_f32_16x16x32_bf16 v[24:27], v[64:67], v[92:95], v[24:27]
    ds_read_b64_tr_b16 v[72:73], v158 offset:0
    ds_read_b64_tr_b16 v[74:75], v158 offset:2048
    v_mfma_f32_16x16x32_bf16 v[28:31], v[60:63], v[96:99], v[28:31]
    ds_read_b64_tr_b16 v[76:77], v159 offset:0
    ds_read_b64_tr_b16 v[78:79], v159 offset:2048
    v_mfma_f32_16x16x32_bf16 v[32:35], v[64:67], v[96:99], v[32:35]
    s_add_u32 m0, s47, 49152
    s_nop 0
    buffer_load_dwordx4 v124, s[12:15], s44 offen lds
    v_add_u32 v124, 86016, v124
    v_mfma_f32_16x16x32_bf16 v[36:39], v[60:63], v[100:103], v[36:39]
    ds_read_b64_tr_b16 v[80:81], v160 offset:0
    ds_read_b64_tr_b16 v[82:83], v160 offset:2048
    v_mfma_f32_16x16x32_bf16 v[40:43], v[64:67], v[100:103], v[40:43]
    ds_read_b64_tr_b16 v[84:85], v161 offset:0
    ds_read_b64_tr_b16 v[86:87], v161 offset:2048
    v_mfma_f32_16x16x32_bf16 v[44:47], v[104:107], v[60:63], v[44:47]
    s_add_u32 m0, s47, 57344
    s_nop 0
    buffer_load_dwordx4 v125, s[16:19], s45 offen lds
    v_add_u32 v125, 114688, v125
    v_mfma_f32_16x16x32_bf16 v[48:51], v[104:107], v[64:67], v[48:51]
    s_waitcnt lgkmcnt(0)
    s_waitcnt vmcnt(9)
    s_barrier
    v_mfma_f32_16x16x32_bf16 v[12:15], v[52:55], v[68:71], v[12:15]
    ds_read_b128 v[60:63], v127 offset:7168
    ds_read_b128 v[64:67], v127 offset:21504
    v_mfma_f32_16x16x32_bf16 v[16:19], v[56:59], v[68:71], v[16:19]
    s_add_u32 m0, s47, 61440
    s_nop 0
    buffer_load_dwordx4 v124, s[12:15], s43 offen lds
    v_mfma_f32_16x16x32_bf16 v[20:23], v[52:55], v[72:75], v[20:23]
    ds_read_b64_tr_b16 v[88:89], v157 offset:20480
    ds_read_b64_tr_b16 v[90:91], v157 offset:22528
    v_mfma_f32_16x16x32_bf16 v[24:27], v[56:59], v[72:75], v[24:27]
    ds_read_b64_tr_b16 v[92:93], v158 offset:20480
    ds_read_b64_tr_b16 v[94:95], v158 offset:22528
    v_mfma_f32_16x16x32_bf16 v[28:31], v[52:55], v[76:79], v[28:31]
    ds_read_b64_tr_b16 v[96:97], v159 offset:20480
    ds_read_b64_tr_b16 v[98:99], v159 offset:22528
    v_mfma_f32_16x16x32_bf16 v[32:35], v[56:59], v[76:79], v[32:35]
    s_add_u32 m0, s47, 69632
    s_nop 0
    buffer_load_dwordx4 v124, s[12:15], s44 offen lds
    v_add_u32 v124, 86016, v124
    v_mfma_f32_16x16x32_bf16 v[36:39], v[52:55], v[80:83], v[36:39]
    ds_read_b64_tr_b16 v[100:101], v160 offset:20480
    ds_read_b64_tr_b16 v[102:103], v160 offset:22528
    v_mfma_f32_16x16x32_bf16 v[40:43], v[56:59], v[80:83], v[40:43]
    ds_read_b64_tr_b16 v[104:105], v161 offset:20480
    ds_read_b64_tr_b16 v[106:107], v161 offset:22528
    v_mfma_f32_16x16x32_bf16 v[44:47], v[84:87], v[52:55], v[44:47]
    s_add_u32 m0, s47, 77824
    s_nop 0
    buffer_load_dwordx4 v125, s[16:19], s45 offen lds
    v_add_u32 v125, 114688, v125
    v_mfma_f32_16x16x32_bf16 v[48:51], v[84:87], v[56:59], v[48:51]
    s_waitcnt lgkmcnt(0)
    s_waitcnt vmcnt(9)
    s_barrier
    v_mfma_f32_16x16x32_bf16 v[12:15], v[60:63], v[88:91], v[12:15]
    ds_read_b128 v[52:55], v126 offset:8192
    ds_read_b128 v[56:59], v126 offset:22528
    v_mfma_f32_16x16x32_bf16 v[16:19], v[64:67], v[88:91], v[16:19]
    s_add_u32 m0, s47, 81920
    s_nop 0
    buffer_load_dwordx4 v124, s[12:15], s43 offen lds
    v_mfma_f32_16x16x32_bf16 v[20:23], v[60:63], v[92:95], v[20:23]
    ds_read_b64_tr_b16 v[68:69], v152 offset:0
    ds_read_b64_tr_b16 v[70:71], v152 offset:2048
    v_mfma_f32_16x16x32_bf16 v[24:27], v[64:67], v[92:95], v[24:27]
    ds_read_b64_tr_b16 v[72:73], v153 offset:0
    ds_read_b64_tr_b16 v[74:75], v153 offset:2048
    v_mfma_f32_16x16x32_bf16 v[28:31], v[60:63], v[96:99], v[28:31]
    ds_read_b64_tr_b16 v[76:77], v154 offset:0
    ds_read_b64_tr_b16 v[78:79], v154 offset:2048
    v_mfma_f32_16x16x32_bf16 v[32:35], v[64:67], v[96:99], v[32:35]
    s_add_u32 m0, s47, 90112
    s_nop 0
    buffer_load_dwordx4 v124, s[12:15], s44 offen lds
    v_add_u32 v124, 86016, v124
    v_mfma_f32_16x16x32_bf16 v[36:39], v[60:63], v[100:103], v[36:39]
    ds_read_b64_tr_b16 v[80:81], v155 offset:0
    ds_read_b64_tr_b16 v[82:83], v155 offset:2048
    v_mfma_f32_16x16x32_bf16 v[40:43], v[64:67], v[100:103], v[40:43]
    ds_read_b64_tr_b16 v[84:85], v156 offset:0
    ds_read_b64_tr_b16 v[86:87], v156 offset:2048
    v_mfma_f32_16x16x32_bf16 v[44:47], v[104:107], v[60:63], v[44:47]
    s_add_u32 m0, s47, 98304
    s_nop 0
    buffer_load_dwordx4 v125, s[16:19], s45 offen lds
    v_add_u32 v125, 114688, v125
    v_mfma_f32_16x16x32_bf16 v[48:51], v[104:107], v[64:67], v[48:51]
    s_waitcnt lgkmcnt(0)
    s_waitcnt vmcnt(9)
    s_barrier
    v_mfma_f32_16x16x32_bf16 v[12:15], v[52:55], v[68:71], v[12:15]
    ds_read_b128 v[60:63], v127 offset:9216
    ds_read_b128 v[64:67], v127 offset:23552
    v_mfma_f32_16x16x32_bf16 v[16:19], v[56:59], v[68:71], v[16:19]
    s_add_u32 m0, s47, 0
    s_nop 0
    buffer_load_dwordx4 v124, s[12:15], s43 offen lds
    v_mfma_f32_16x16x32_bf16 v[20:23], v[52:55], v[72:75], v[20:23]
    ds_read_b64_tr_b16 v[88:89], v152 offset:20480
    ds_read_b64_tr_b16 v[90:91], v152 offset:22528
    v_mfma_f32_16x16x32_bf16 v[24:27], v[56:59], v[72:75], v[24:27]
    ds_read_b64_tr_b16 v[92:93], v153 offset:20480
    ds_read_b64_tr_b16 v[94:95], v153 offset:22528
    v_mfma_f32_16x16x32_bf16 v[28:31], v[52:55], v[76:79], v[28:31]
    ds_read_b64_tr_b16 v[96:97], v154 offset:20480
    ds_read_b64_tr_b16 v[98:99], v154 offset:22528
    v_mfma_f32_16x16x32_bf16 v[32:35], v[56:59], v[76:79], v[32:35]
    s_add_u32 m0, s47, 8192
    s_nop 0
    buffer_load_dwordx4 v124, s[12:15], s44 offen lds
    v_add_u32 v124, 86016, v124
    v_mfma_f32_16x16x32_bf16 v[36:39], v[52:55], v[80:83], v[36:39]
    ds_read_b64_tr_b16 v[100:101], v155 offset:20480
    ds_read_b64_tr_b16 v[102:103], v155 offset:22528
    v_mfma_f32_16x16x32_bf16 v[40:43], v[56:59], v[80:83], v[40:43]
    ds_read_b64_tr_b16 v[104:105], v156 offset:20480
    ds_read_b64_tr_b16 v[106:107], v156 offset:22528
    v_mfma_f32_16x16x32_bf16 v[44:47], v[84:87], v[52:55], v[44:47]
    s_add_u32 m0, s47, 16384
    s_nop 0
    buffer_load_dwordx4 v125, s[16:19], s45 offen lds
    v_add_u32 v125, 114688, v125
    v_mfma_f32_16x16x32_bf16 v[48:51], v[84:87], v[56:59], v[48:51]
    s_waitcnt lgkmcnt(0)
    s_waitcnt vmcnt(9)
    s_barrier
    v_mfma_f32_16x16x32_bf16 v[12:15], v[60:63], v[88:91], v[12:15]
    ds_read_b128 v[52:55], v126 offset:10240
    ds_read_b128 v[56:59], v126 offset:24576
    v_mfma_f32_16x16x32_bf16 v[16:19], v[64:67], v[88:91], v[16:19]
    ds_read_b64_tr_b16 v[68:69], v152 offset:40960
    ds_read_b64_tr_b16 v[70:71], v152 offset:43008
    v_mfma_f32_16x16x32_bf16 v[20:23], v[60:63], v[92:95], v[20:23]
    ds_read_b64_tr_b16 v[72:73], v153 offset:40960
    ds_read_b64_tr_b16 v[74:75], v153 offset:43008
    v_mfma_f32_16x16x32_bf16 v[24:27], v[64:67], v[92:95], v[24:27]
    ds_read_b64_tr_b16 v[76:77], v154 offset:40960
    ds_read_b64_tr_b16 v[78:79], v154 offset:43008
    v_mfma_f32_16x16x32_bf16 v[28:31], v[60:63], v[96:99], v[28:31]
    ds_read_b64_tr_b16 v[80:81], v155 offset:40960
    ds_read_b64_tr_b16 v[82:83], v155 offset:43008
    v_mfma_f32_16x16x32_bf16 v[32:35], v[64:67], v[96:99], v[32:35]
    ds_read_b64_tr_b16 v[84:85], v156 offset:40960
    ds_read_b64_tr_b16 v[86:87], v156 offset:43008
    v_mfma_f32_16x16x32_bf16 v[36:39], v[60:63], v[100:103], v[36:39]
    v_mfma_f32_16x16x32_bf16 v[40:43], v[64:67], v[100:103], v[40:43]
    v_mfma_f32_16x16x32_bf16 v[44:47], v[104:107], v[60:63], v[44:47]
    v_mfma_f32_16x16x32_bf16 v[48:51], v[104:107], v[64:67], v[48:51]
    s_waitcnt lgkmcnt(0)
    s_waitcnt vmcnt(6)
    s_barrier
    v_mfma_f32_16x16x32_bf16 v[12:15], v[52:55], v[68:71], v[12:15]
    ds_read_b128 v[60:63], v127 offset:11264
    ds_read_b128 v[64:67], v127 offset:25600
    v_mfma_f32_16x16x32_bf16 v[16:19], v[56:59], v[68:71], v[16:19]
    ds_read_b64_tr_b16 v[88:89], v157 offset:0
    ds_read_b64_tr_b16 v[90:91], v157 offset:2048
    v_mfma_f32_16x16x32_bf16 v[20:23], v[52:55], v[72:75], v[20:23]
    ds_read_b64_tr_b16 v[92:93], v158 offset:0
    ds_read_b64_tr_b16 v[94:95], v158 offset:2048
    v_mfma_f32_16x16x32_bf16 v[24:27], v[56:59], v[72:75], v[24:27]
    ds_read_b64_tr_b16 v[96:97], v159 offset:0
    ds_read_b64_tr_b16 v[98:99], v159 offset:2048
    v_mfma_f32_16x16x32_bf16 v[28:31], v[52:55], v[76:79], v[28:31]
    ds_read_b64_tr_b16 v[100:101], v160 offset:0
    ds_read_b64_tr_b16 v[102:103], v160 offset:2048
    v_mfma_f32_16x16x32_bf16 v[32:35], v[56:59], v[76:79], v[32:35]
    ds_read_b64_tr_b16 v[104:105], v161 offset:0
    ds_read_b64_tr_b16 v[106:107], v161 offset:2048
    v_mfma_f32_16x16x32_bf16 v[36:39], v[52:55], v[80:83], v[36:39]
    v_mfma_f32_16x16x32_bf16 v[40:43], v[56:59], v[80:83], v[40:43]
    v_mfma_f32_16x16x32_bf16 v[44:47], v[84:87], v[52:55], v[44:47]
    v_mfma_f32_16x16x32_bf16 v[48:51], v[84:87], v[56:59], v[48:51]
    s_waitcnt lgkmcnt(0)
    s_waitcnt vmcnt(3)
    s_barrier
    v_mfma_f32_16x16x32_bf16 v[12:15], v[60:63], v[88:91], v[12:15]
    ds_read_b128 v[52:55], v126 offset:12288
    ds_read_b128 v[56:59], v126 offset:26624
    v_mfma_f32_16x16x32_bf16 v[16:19], v[64:67], v[88:91], v[16:19]
    ds_read_b64_tr_b16 v[68:69], v157 offset:20480
    ds_read_b64_tr_b16 v[70:71], v157 offset:22528
    v_mfma_f32_16x16x32_bf16 v[20:23], v[60:63], v[92:95], v[20:23]
    ds_read_b64_tr_b16 v[72:73], v158 offset:20480
    ds_read_b64_tr_b16 v[74:75], v158 offset:22528
    v_mfma_f32_16x16x32_bf16 v[24:27], v[64:67], v[92:95], v[24:27]
    ds_read_b64_tr_b16 v[76:77], v159 offset:20480
    ds_read_b64_tr_b16 v[78:79], v159 offset:22528
    v_mfma_f32_16x16x32_bf16 v[28:31], v[60:63], v[96:99], v[28:31]
    ds_read_b64_tr_b16 v[80:81], v160 offset:20480
    ds_read_b64_tr_b16 v[82:83], v160 offset:22528
    v_mfma_f32_16x16x32_bf16 v[32:35], v[64:67], v[96:99], v[32:35]
    ds_read_b64_tr_b16 v[84:85], v161 offset:20480
    ds_read_b64_tr_b16 v[86:87], v161 offset:22528
    v_mfma_f32_16x16x32_bf16 v[36:39], v[60:63], v[100:103], v[36:39]
    v_mfma_f32_16x16x32_bf16 v[40:43], v[64:67], v[100:103], v[40:43]
    v_mfma_f32_16x16x32_bf16 v[44:47], v[104:107], v[60:63], v[44:47]
    v_mfma_f32_16x16x32_bf16 v[48:51], v[104:107], v[64:67], v[48:51]
    s_waitcnt lgkmcnt(0)
    s_waitcnt vmcnt(0)
    s_barrier
    v_mfma_f32_16x16x32_bf16 v[12:15], v[52:55], v[68:71], v[12:15]
    ds_read_b128 v[60:63], v127 offset:13312
    ds_read_b128 v[64:67], v127 offset:27648
    v_mfma_f32_16x16x32_bf16 v[16:19], v[56:59], v[68:71], v[16:19]
    ds_read_b64_tr_b16 v[88:89], v152 offset:0
    ds_read_b64_tr_b16 v[90:91], v152 offset:2048
    v_mfma_f32_16x16x32_bf16 v[20:23], v[52:55], v[72:75], v[20:23]
    ds_read_b64_tr_b16 v[92:93], v153 offset:0
    ds_read_b64_tr_b16 v[94:95], v153 offset:2048
    v_mfma_f32_16x16x32_bf16 v[24:27], v[56:59], v[72:75], v[24:27]
    ds_read_b64_tr_b16 v[96:97], v154 offset:0
    ds_read_b64_tr_b16 v[98:99], v154 offset:2048
    v_mfma_f32_16x16x32_bf16 v[28:31], v[52:55], v[76:79], v[28:31]
    ds_read_b64_tr_b16 v[100:101], v155 offset:0
    ds_read_b64_tr_b16 v[102:103], v155 offset:2048
    v_mfma_f32_16x16x32_bf16 v[32:35], v[56:59], v[76:79], v[32:35]
    ds_read_b64_tr_b16 v[104:105], v156 offset:0
    ds_read_b64_tr_b16 v[106:107], v156 offset:2048
    v_mfma_f32_16x16x32_bf16 v[36:39], v[52:55], v[80:83], v[36:39]
    v_mfma_f32_16x16x32_bf16 v[40:43], v[56:59], v[80:83], v[40:43]
    v_mfma_f32_16x16x32_bf16 v[44:47], v[84:87], v[52:55], v[44:47]
    v_mfma_f32_16x16x32_bf16 v[48:51], v[84:87], v[56:59], v[48:51]
    s_waitcnt lgkmcnt(0)
    s_barrier
    v_mfma_f32_16x16x32_bf16 v[12:15], v[60:63], v[88:91], v[12:15]
    v_mfma_f32_16x16x32_bf16 v[16:19], v[64:67], v[88:91], v[16:19]
    v_mfma_f32_16x16x32_bf16 v[20:23], v[60:63], v[92:95], v[20:23]
    v_mfma_f32_16x16x32_bf16 v[24:27], v[64:67], v[92:95], v[24:27]
    v_mfma_f32_16x16x32_bf16 v[28:31], v[60:63], v[96:99], v[28:31]
    v_mfma_f32_16x16x32_bf16 v[32:35], v[64:67], v[96:99], v[32:35]
    v_mfma_f32_16x16x32_bf16 v[36:39], v[60:63], v[100:103], v[36:39]
    v_mfma_f32_16x16x32_bf16 v[40:43], v[64:67], v[100:103], v[40:43]
    v_mfma_f32_16x16x32_bf16 v[44:47], v[104:107], v[60:63], v[44:47]
    v_mfma_f32_16x16x32_bf16 v[48:51], v[104:107], v[64:67], v[48:51]
    s_branch p1_B_epi
p1_B_T1:
    s_waitcnt vmcnt(6)
    s_barrier
    v_mfma_f32_16x16x32_bf16 v[12:15], v[52:55], v[68:71], 0
    ds_read_b128 v[60:63], v127 offset:1024
    ds_read_b128 v[64:67], v127 offset:15360
    v_mfma_f32_16x16x32_bf16 v[16:19], v[56:59], v[68:71], 0
    ds_read_b64_tr_b16 v[88:89], v157 offset:0
    ds_read_b64_tr_b16 v[90:91], v157 offset:2048
    v_mfma_f32_16x16x32_bf16 v[20:23], v[52:55], v[72:75], 0
    ds_read_b64_tr_b16 v[92:93], v158 offset:0
    ds_read_b64_tr_b16 v[94:95], v158 offset:2048
    v_mfma_f32_16x16x32_bf16 v[24:27], v[56:59], v[72:75], 0
    s_add_u32 m0, s47, 40960
    s_nop 0
    buffer_load_dwordx4 v124, s[12:15], s43 offen lds
    v_add_u32 v124, 86016, v124
    v_mfma_f32_16x16x32_bf16 v[28:31], v[52:55], v[76:79], 0
    ds_read_b64_tr_b16 v[96:97], v159 offset:0
    ds_read_b64_tr_b16 v[98:99], v159 offset:2048
    v_mfma_f32_16x16x32_bf16 v[32:35], v[56:59], v[76:79], 0
    ds_read_b64_tr_b16 v[100:101], v160 offset:0
    ds_read_b64_tr_b16 v[102:103], v160 offset:2048
    v_mfma_f32_16x16x32_bf16 v[36:39], v[52:55], v[80:83], 0
    ds_read_b64_tr_b16 v[104:105], v161 offset:0
    ds_read_b64_tr_b16 v[106:107], v161 offset:2048
    v_mfma_f32_16x16x32_bf16 v[40:43], v[56:59], v[80:83], 0
    s_add_u32 m0, s47, 49152
    s_nop 0
    buffer_load_dwordx4 v125, s[16:19], s44 offen lds
    v_add_u32 v125, 114688, v125
    v_mfma_f32_16x16x32_bf16 v[44:47], v[84:87], v[52:55], 0
    v_mfma_f32_16x16x32_bf16 v[48:51], v[84:87], v[56:59], 0
    s_waitcnt lgkmcnt(0)
    s_waitcnt vmcnt(6)
    s_barrier
    v_mfma_f32_16x16x32_bf16 v[12:15], v[60:63], v[88:91], v[12:15]
    ds_read_b128 v[52:55], v126 offset:2048
    ds_read_b128 v[56:59], v126 offset:16384
    v_mfma_f32_16x16x32_bf16 v[16:19], v[64:67], v[88:91], v[16:19]
    ds_read_b64_tr_b16 v[68:69], v157 offset:20480
    ds_read_b64_tr_b16 v[70:71], v157 offset:22528
    v_mfma_f32_16x16x32_bf16 v[20:23], v[60:63], v[92:95], v[20:23]
    ds_read_b64_tr_b16 v[72:73], v158 offset:20480
    ds_read_b64_tr_b16 v[74:75], v158 offset:22528
    v_mfma_f32_16x16x32_bf16 v[24:27], v[64:67], v[92:95], v[24:27]
    s_add_u32 m0, s47, 61440
    s_nop 0
    buffer_load_dwordx4 v124, s[12:15], s43 offen lds
    v_add_u32 v124, 86016, v124
    v_mfma_f32_16x16x32_bf16 v[28:31], v[60:63], v[96:99], v[28:31]
    ds_read_b64_tr_b16 v[76:77], v159 offset:20480
    ds_read_b64_tr_b16 v[78:79], v159 offset:22528
    v_mfma_f32_16x16x32_bf16 v[32:35], v[64:67], v[96:99], v[32:35]
    ds_read_b64_tr_b16 v[80:81], v160 offset:20480
    ds_read_b64_tr_b16 v[82:83], v160 offset:22528
    v_mfma_f32_16x16x32_bf16 v[36:39], v[60:63], v[100:103], v[36:39]
    ds_read_b64_tr_b16 v[84:85], v161 offset:20480
    ds_read_b64_tr_b16 v[86:87], v161 offset:22528
    v_mfma_f32_16x16x32_bf16 v[40:43], v[64:67], v[100:103], v[40:43]
    s_add_u32 m0, s47, 69632
    s_nop 0
    buffer_load_dwordx4 v125, s[16:19], s44 offen lds
    v_add_u32 v125, 114688, v125
    v_mfma_f32_16x16x32_bf16 v[44:47], v[104:107], v[60:63], v[44:47]
    v_mfma_f32_16x16x32_bf16 v[48:51], v[104:107], v[64:67], v[48:51]
    s_waitcnt lgkmcnt(0)
    s_waitcnt vmcnt(6)
    s_barrier
    v_mfma_f32_16x16x32_bf16 v[12:15], v[52:55], v[68:71], v[12:15]
    ds_read_b128 v[60:63], v127 offset:3072
    ds_read_b128 v[64:67], v127 offset:17408
    v_mfma_f32_16x16x32_bf16 v[16:19], v[56:59], v[68:71], v[16:19]
    ds_read_b64_tr_b16 v[88:89], v152 offset:0
    ds_read_b64_tr_b16 v[90:91], v152 offset:2048
    v_mfma_f32_16x16x32_bf16 v[20:23], v[52:55], v[72:75], v[20:23]
    ds_read_b64_tr_b16 v[92:93], v153 offset:0
    ds_read_b64_tr_b16 v[94:95], v153 offset:2048
    v_mfma_f32_16x16x32_bf16 v[24:27], v[56:59], v[72:75], v[24:27]
    s_add_u32 m0, s47, 81920
    s_nop 0
    buffer_load_dwordx4 v124, s[12:15], s43 offen lds
    v_add_u32 v124, 86016, v124
    v_mfma_f32_16x16x32_bf16 v[28:31], v[52:55], v[76:79], v[28:31]
    ds_read_b64_tr_b16 v[96:97], v154 offset:0
    ds_read_b64_tr_b16 v[98:99], v154 offset:2048
    v_mfma_f32_16x16x32_bf16 v[32:35], v[56:59], v[76:79], v[32:35]
    ds_read_b64_tr_b16 v[100:101], v155 offset:0
    ds_read_b64_tr_b16 v[102:103], v155 offset:2048
    v_mfma_f32_16x16x32_bf16 v[36:39], v[52:55], v[80:83], v[36:39]
    ds_read_b64_tr_b16 v[104:105], v156 offset:0
    ds_read_b64_tr_b16 v[106:107], v156 offset:2048
    v_mfma_f32_16x16x32_bf16 v[40:43], v[56:59], v[80:83], v[40:43]
    s_add_u32 m0, s47, 90112
    s_nop 0
    buffer_load_dwordx4 v125, s[16:19], s44 offen lds
    v_add_u32 v125, 114688, v125
    v_mfma_f32_16x16x32_bf16 v[44:47], v[84:87], v[52:55], v[44:47]
    v_mfma_f32_16x16x32_bf16 v[48:51], v[84:87], v[56:59], v[48:51]
    s_waitcnt lgkmcnt(0)
    s_waitcnt vmcnt(6)
    s_barrier
    v_mfma_f32_16x16x32_bf16 v[12:15], v[60:63], v[88:91], v[12:15]
    ds_read_b128 v[52:55], v126 offset:4096
    ds_read_b128 v[56:59], v126 offset:18432
    v_mfma_f32_16x16x32_bf16 v[16:19], v[64:67], v[88:91], v[16:19]
    ds_read_b64_tr_b16 v[68:69], v152 offset:20480
    ds_read_b64_tr_b16 v[70:71], v152 offset:22528
    v_mfma_f32_16x16x32_bf16 v[20:23], v[60:63], v[92:95], v[20:23]
    ds_read_b64_tr_b16 v[72:73], v153 offset:20480
    ds_read_b64_tr_b16 v[74:75], v153 offset:22528
    v_mfma_f32_16x16x32_bf16 v[24:27], v[64:67], v[92:95], v[24:27]
    s_add_u32 m0, s47, 0
    s_nop 0
    buffer_load_dwordx4 v124, s[12:15], s43 offen lds
    v_add_u32 v124, 86016, v124
    v_mfma_f32_16x16x32_bf16 v[28:31], v[60:63], v[96:99], v[28:31]
    ds_read_b64_tr_b16 v[76:77], v154 offset:20480
    ds_read_b64_tr_b16 v[78:79], v154 offset:22528
    v_mfma_f32_16x16x32_bf16 v[32:35], v[64:67], v[96:99], v[32:35]
    ds_read_b64_tr_b16 v[80:81], v155 offset:20480
    ds_read_b64_tr_b16 v[82:83], v155 offset:22528
    v_mfma_f32_16x16x32_bf16 v[36:39], v[60:63], v[100:103], v[36:39]
    ds_read_b64_tr_b16 v[84:85], v156 offset:20480
    ds_read_b64_tr_b16 v[86:87], v156 offset:22528
    v_mfma_f32_16x16x32_bf16 v[40:43], v[64:67], v[100:103], v[40:43]
    s_add_u32 m0, s47, 8192
    s_nop 0
    buffer_load_dwordx4 v125, s[16:19], s44 offen lds
    v_add_u32 v125, 114688, v125
    v_mfma_f32_16x16x32_bf16 v[44:47], v[104:107], v[60:63], v[44:47]
    v_mfma_f32_16x16x32_bf16 v[48:51], v[104:107], v[64:67], v[48:51]
    s_waitcnt lgkmcnt(0)
    s_waitcnt vmcnt(6)
    s_barrier
    v_mfma_f32_16x16x32_bf16 v[12:15], v[52:55], v[68:71], v[12:15]
    ds_read_b128 v[60:63], v127 offset:5120
    ds_read_b128 v[64:67], v127 offset:19456
    v_mfma_f32_16x16x32_bf16 v[16:19], v[56:59], v[68:71], v[16:19]
    ds_read_b64_tr_b16 v[88:89], v152 offset:40960
    ds_read_b64_tr_b16 v[90:91], v152 offset:43008
    v_mfma_f32_16x16x32_bf16 v[20:23], v[52:55], v[72:75], v[20:23]
    ds_read_b64_tr_b16 v[92:93], v153 offset:40960
    ds_read_b64_tr_b16 v[94:95], v153 offset:43008
    v_mfma_f32_16x16x32_bf16 v[24:27], v[56:59], v[72:75], v[24:27]
    s_add_u32 m0, s47, 20480
    s_nop 0
    buffer_load_dwordx4 v124, s[12:15], s43 offen lds
    v_add_u32 v124, 86016, v124
    v_mfma_f32_16x16x32_bf16 v[28:31], v[52:55], v[76:79], v[28:31]
    ds_read_b64_tr_b16 v[96:97], v154 offset:40960
    ds_read_b64_tr_b16 v[98:99], v154 offset:43008
    v_mfma_f32_16x16x32_bf16 v[32:35], v[56:59], v[76:79], v[32:35]
    ds_read_b64_tr_b16 v[100:101], v155 offset:40960
    ds_read_b64_tr_b16 v[102:103], v155 offset:43008
    v_mfma_f32_16x16x32_bf16 v[36:39], v[52:55], v[80:83], v[36:39]
    ds_read_b64_tr_b16 v[104:105], v156 offset:40960
    ds_read_b64_tr_b16 v[106:107], v156 offset:43008
    v_mfma_f32_16x16x32_bf16 v[40:43], v[56:59], v[80:83], v[40:43]
    s_add_u32 m0, s47, 28672
    s_nop 0
    buffer_load_dwordx4 v125, s[16:19], s44 offen lds
    v_add_u32 v125, 114688, v125
    v_mfma_f32_16x16x32_bf16 v[44:47], v[84:87], v[52:55], v[44:47]
    v_mfma_f32_16x16x32_bf16 v[48:51], v[84:87], v[56:59], v[48:51]
    s_waitcnt lgkmcnt(0)
    s_waitcnt vmcnt(6)
    s_barrier
    v_mfma_f32_16x16x32_bf16 v[12:15], v[60:63], v[88:91], v[12:15]
    ds_read_b128 v[52:55], v126 offset:6144
    ds_read_b128 v[56:59], v126 offset:20480
    v_mfma_f32_16x16x32_bf16 v[16:19], v[64:67], v[88:91], v[16:19]
    ds_read_b64_tr_b16 v[68:69], v157 offset:0
    ds_read_b64_tr_b16 v[70:71], v157 offset:2048
    v_mfma_f32_16x16x32_bf16 v[20:23], v[60:63], v[92:95], v[20:23]
    ds_read_b64_tr_b16 v[72:73], v158 offset:0
    ds_read_b64_tr_b16 v[74:75], v158 offset:2048
    v_mfma_f32_16x16x32_bf16 v[24:27], v[64:67], v[92:95], v[24:27]
    s_add_u32 m0, s47, 40960
    s_nop 0
    buffer_load_dwordx4 v124, s[12:15], s43 offen lds
    v_add_u32 v124, 86016, v124
    v_mfma_f32_16x16x32_bf16 v[28:31], v[60:63], v[96:99], v[28:31]
    ds_read_b64_tr_b16 v[76:77], v159 offset:0
    ds_read_b64_tr_b16 v[78:79], v159 offset:2048
    v_mfma_f32_16x16x32_bf16 v[32:35], v[64:67], v[96:99], v[32:35]
    ds_read_b64_tr_b16 v[80:81], v160 offset:0
    ds_read_b64_tr_b16 v[82:83], v160 offset:2048
    v_mfma_f32_16x16x32_bf16 v[36:39], v[60:63], v[100:103], v[36:39]
    ds_read_b64_tr_b16 v[84:85], v161 offset:0
    ds_read_b64_tr_b16 v[86:87], v161 offset:2048
    v_mfma_f32_16x16x32_bf16 v[40:43], v[64:67], v[100:103], v[40:43]
    s_add_u32 m0, s47, 49152
    s_nop 0
    buffer_load_dwordx4 v125, s[16:19], s44 offen lds
    v_add_u32 v125, 114688, v125
    v_mfma_f32_16x16x32_bf16 v[44:47], v[104:107], v[60:63], v[44:47]
    v_mfma_f32_16x16x32_bf16 v[48:51], v[104:107], v[64:67], v[48:51]
    s_waitcnt lgkmcnt(0)
    s_waitcnt vmcnt(6)
    s_barrier
    v_mfma_f32_16x16x32_bf16 v[12:15], v[52:55], v[68:71], v[12:15]
    ds_read_b128 v[60:63], v127 offset:7168
    ds_read_b128 v[64:67], v127 offset:21504
    v_mfma_f32_16x16x32_bf16 v[16:19], v[56:59], v[68:71], v[16:19]
    ds_read_b64_tr_b16 v[88:89], v157 offset:20480
    ds_read_b64_tr_b16 v[90:91], v157 offset:22528
    v_mfma_f32_16x16x32_bf16 v[20:23], v[52:55], v[72:75], v[20:23]
    ds_read_b64_tr_b16 v[92:93], v158 offset:20480
    ds_read_b64_tr_b16 v[94:95], v158 offset:22528
    v_mfma_f32_16x16x32_bf16 v[24:27], v[56:59], v[72:75], v[24:27]
    s_add_u32 m0, s47, 61440
    s_nop 0
    buffer_load_dwordx4 v124, s[12:15], s43 offen lds
    v_add_u32 v124, 86016, v124
    v_mfma_f32_16x16x32_bf16 v[28:31], v[52:55], v[76:79], v[28:31]
    ds_read_b64_tr_b16 v[96:97], v159 offset:20480
    ds_read_b64_tr_b16 v[98:99], v159 offset:22528
    v_mfma_f32_16x16x32_bf16 v[32:35], v[56:59], v[76:79], v[32:35]
    ds_read_b64_tr_b16 v[100:101], v160 offset:20480
    ds_read_b64_tr_b16 v[102:103], v160 offset:22528
    v_mfma_f32_16x16x32_bf16 v[36:39], v[52:55], v[80:83], v[36:39]
    ds_read_b64_tr_b16 v[104:105], v161 offset:20480
    ds_read_b64_tr_b16 v[106:107], v161 offset:22528
    v_mfma_f32_16x16x32_bf16 v[40:43], v[56:59], v[80:83], v[40:43]
    s_add_u32 m0, s47, 69632
    s_nop 0
    buffer_load_dwordx4 v125, s[16:19], s44 offen lds
    v_add_u32 v125, 114688, v125
    v_mfma_f32_16x16x32_bf16 v[44:47], v[84:87], v[52:55], v[44:47]
    v_mfma_f32_16x16x32_bf16 v[48:51], v[84:87], v[56:59], v[48:51]
    s_waitcnt lgkmcnt(0)
    s_waitcnt vmcnt(6)
    s_barrier
    v_mfma_f32_16x16x32_bf16 v[12:15], v[60:63], v[88:91], v[12:15]
    ds_read_b128 v[52:55], v126 offset:8192
    ds_read_b128 v[56:59], v126 offset:22528
    v_mfma_f32_16x16x32_bf16 v[16:19], v[64:67], v[88:91], v[16:19]
    ds_read_b64_tr_b16 v[68:69], v152 offset:0
    ds_read_b64_tr_b16 v[70:71], v152 offset:2048
    v_mfma_f32_16x16x32_bf16 v[20:23], v[60:63], v[92:95], v[20:23]
    ds_read_b64_tr_b16 v[72:73], v153 offset:0
    ds_read_b64_tr_b16 v[74:75], v153 offset:2048
    v_mfma_f32_16x16x32_bf16 v[24:27], v[64:67], v[92:95], v[24:27]
    s_add_u32 m0, s47, 81920
    s_nop 0
    buffer_load_dwordx4 v124, s[12:15], s43 offen lds
    v_add_u32 v124, 86016, v124
    v_mfma_f32_16x16x32_bf16 v[28:31], v[60:63], v[96:99], v[28:31]
    ds_read_b64_tr_b16 v[76:77], v154 offset:0
    ds_read_b64_tr_b16 v[78:79], v154 offset:2048
    v_mfma_f32_16x16x32_bf16 v[32:35], v[64:67], v[96:99], v[32:35]
    ds_read_b64_tr_b16 v[80:81], v155 offset:0
    ds_read_b64_tr_b16 v[82:83], v155 offset:2048
    v_mfma_f32_16x16x32_bf16 v[36:39], v[60:63], v[100:103], v[36:39]
    ds_read_b64_tr_b16 v[84:85], v156 offset:0
    ds_read_b64_tr_b16 v[86:87], v156 offset:2048
    v_mfma_f32_16x16x32_bf16 v[40:43], v[64:67], v[100:103], v[40:43]
    s_add_u32 m0, s47, 90112
    s_nop 0
    buffer_load_dwordx4 v125, s[16:19], s44 offen lds
    v_add_u32 v125, 114688, v125
    v_mfma_f32_16x16x32_bf16 v[44:47], v[104:107], v[60:63], v[44:47]
    v_mfma_f32_16x16x32_bf16 v[48:51], v[104:107], v[64:67], v[48:51]
    s_waitcnt lgkmcnt(0)
    s_waitcnt vmcnt(6)
    s_barrier
    v_mfma_f32_16x16x32_bf16 v[12:15], v[52:55], v[68:71], v[12:15]
    ds_read_b128 v[60:63], v127 offset:9216
    ds_read_b128 v[64:67], v127 offset:23552
    v_mfma_f32_16x16x32_bf16 v[16:19], v[56:59], v[68:71], v[16:19]
    ds_read_b64_tr_b16 v[88:89], v152 offset:20480
    ds_read_b64_tr_b16 v[90:91], v152 offset:22528
    v_mfma_f32_16x16x32_bf16 v[20:23], v[52:55], v[72:75], v[20:23]
    ds_read_b64_tr_b16 v[92:93], v153 offset:20480
    ds_read_b64_tr_b16 v[94:95], v153 offset:22528
    v_mfma_f32_16x16x32_bf16 v[24:27], v[56:59], v[72:75], v[24:27]
    s_add_u32 m0, s47, 0
    s_nop 0
    buffer_load_dwordx4 v124, s[12:15], s43 offen lds
    v_add_u32 v124, 86016, v124
    v_mfma_f32_16x16x32_bf16 v[28:31], v[52:55], v[76:79], v[28:31]
    ds_read_b64_tr_b16 v[96:97], v154 offset:20480
    ds_read_b64_tr_b16 v[98:99], v154 offset:22528
    v_mfma_f32_16x16x32_bf16 v[32:35], v[56:59], v[76:79], v[32:35]
    ds_read_b64_tr_b16 v[100:101], v155 offset:20480
    ds_read_b64_tr_b16 v[102:103], v155 offset:22528
    v_mfma_f32_16x16x32_bf16 v[36:39], v[52:55], v[80:83], v[36:39]
    ds_read_b64_tr_b16 v[104:105], v156 offset:20480
    ds_read_b64_tr_b16 v[106:107], v156 offset:22528
    v_mfma_f32_16x16x32_bf16 v[40:43], v[56:59], v[80:83], v[40:43]
    s_add_u32 m0, s47, 8192
    s_nop 0
    buffer_load_dwordx4 v125, s[16:19], s44 offen lds
    v_add_u32 v125, 114688, v125
    v_mfma_f32_16x16x32_bf16 v[44:47], v[84:87], v[52:55], v[44:47]
    v_mfma_f32_16x16x32_bf16 v[48:51], v[84:87], v[56:59], v[48:51]
    s_waitcnt lgkmcnt(0)
    s_waitcnt vmcnt(6)
    s_barrier
    v_mfma_f32_16x16x32_bf16 v[12:15], v[60:63], v[88:91], v[12:15]
    ds_read_b128 v[52:55], v126 offset:10240
    ds_read_b128 v[56:59], v126 offset:24576
    v_mfma_f32_16x16x32_bf16 v[16:19], v[64:67], v[88:91], v[16:19]
    ds_read_b64_tr_b16 v[68:69], v152 offset:40960
    ds_read_b64_tr_b16 v[70:71], v152 offset:43008
    v_mfma_f32_16x16x32_bf16 v[20:23], v[60:63], v[92:95], v[20:23]
    ds_read_b64_tr_b16 v[72:73], v153 offset:40960
    ds_read_b64_tr_b16 v[74:75], v153 offset:43008
    v_mfma_f32_16x16x32_bf16 v[24:27], v[64:67], v[92:95], v[24:27]
    ds_read_b64_tr_b16 v[76:77], v154 offset:40960
    ds_read_b64_tr_b16 v[78:79], v154 offset:43008
    v_mfma_f32_16x16x32_bf16 v[28:31], v[60:63], v[96:99], v[28:31]
    ds_read_b64_tr_b16 v[80:81], v155 offset:40960
    ds_read_b64_tr_b16 v[82:83], v155 offset:43008
    v_mfma_f32_16x16x32_bf16 v[32:35], v[64:67], v[96:99], v[32:35]
    ds_read_b64_tr_b16 v[84:85], v156 offset:40960
    ds_read_b64_tr_b16 v[86:87], v156 offset:43008
    v_mfma_f32_16x16x32_bf16 v[36:39], v[60:63], v[100:103], v[36:39]
    v_mfma_f32_16x16x32_bf16 v[40:43], v[64:67], v[100:103], v[40:43]
    v_mfma_f32_16x16x32_bf16 v[44:47], v[104:107], v[60:63], v[44:47]
    v_mfma_f32_16x16x32_bf16 v[48:51], v[104:107], v[64:67], v[48:51]
    s_waitcnt lgkmcnt(0)
    s_waitcnt vmcnt(4)
    s_barrier
    v_mfma_f32_16x16x32_bf16 v[12:15], v[52:55], v[68:71], v[12:15]
    ds_read_b128 v[60:63], v127 offset:11264
    ds_read_b128 v[64:67], v127 offset:25600
    v_mfma_f32_16x16x32_bf16 v[16:19], v[56:59], v[68:71], v[16:19]
    ds_read_b64_tr_b16 v[88:89], v157 offset:0
    ds_read_b64_tr_b16 v[90:91], v157 offset:2048
    v_mfma_f32_16x16x32_bf16 v[20:23], v[52:55], v[72:75], v[20:23]
    ds_read_b64_tr_b16 v[92:93], v158 offset:0
    ds_read_b64_tr_b16 v[94:95], v158 offset:2048
    v_mfma_f32_16x16x32_bf16 v[24:27], v[56:59], v[72:75], v[24:27]
    ds_read_b64_tr_b16 v[96:97], v159 offset:0
    ds_read_b64_tr_b16 v[98:99], v159 offset:2048
    v_mfma_f32_16x16x32_bf16 v[28:31], v[52:55], v[76:79], v[28:31]
    ds_read_b64_tr_b16 v[100:101], v160 offset:0
    ds_read_b64_tr_b16 v[102:103], v160 offset:2048
    v_mfma_f32_16x16x32_bf16 v[32:35], v[56:59], v[76:79], v[32:35]
    ds_read_b64_tr_b16 v[104:105], v161 offset:0
    ds_read_b64_tr_b16 v[106:107], v161 offset:2048
    v_mfma_f32_16x16x32_bf16 v[36:39], v[52:55], v[80:83], v[36:39]
    v_mfma_f32_16x16x32_bf16 v[40:43], v[56:59], v[80:83], v[40:43]
    v_mfma_f32_16x16x32_bf16 v[44:47], v[84:87], v[52:55], v[44:47]
    v_mfma_f32_16x16x32_bf16 v[48:51], v[84:87], v[56:59], v[48:51]
    s_waitcnt lgkmcnt(0)
    s_waitcnt vmcnt(2)
    s_barrier
    v_mfma_f32_16x16x32_bf16 v[12:15], v[60:63], v[88:91], v[12:15]
    ds_read_b128 v[52:55], v126 offset:12288
    ds_read_b128 v[56:59], v126 offset:26624
    v_mfma_f32_16x16x32_bf16 v[16:19], v[64:67], v[88:91], v[16:19]
    ds_read_b64_tr_b16 v[68:69], v157 offset:20480
    ds_read_b64_tr_b16 v[70:71], v157 offset:22528
    v_mfma_f32_16x16x32_bf16 v[20:23], v[60:63], v[92:95], v[20:23]
    ds_read_b64_tr_b16 v[72:73], v158 offset:20480
    ds_read_b64_tr_b16 v[74:75], v158 offset:22528
    v_mfma_f32_16x16x32_bf16 v[24:27], v[64:67], v[92:95], v[24:27]
    ds_read_b64_tr_b16 v[76:77], v159 offset:20480
    ds_read_b64_tr_b16 v[78:79], v159 offset:22528
    v_mfma_f32_16x16x32_bf16 v[28:31], v[60:63], v[96:99], v[28:31]
    ds_read_b64_tr_b16 v[80:81], v160 offset:20480
    ds_read_b64_tr_b16 v[82:83], v160 offset:22528
    v_mfma_f32_16x16x32_bf16 v[32:35], v[64:67], v[96:99], v[32:35]
    ds_read_b64_tr_b16 v[84:85], v161 offset:20480
    ds_read_b64_tr_b16 v[86:87], v161 offset:22528
    v_mfma_f32_16x16x32_bf16 v[36:39], v[60:63], v[100:103], v[36:39]
    v_mfma_f32_16x16x32_bf16 v[40:43], v[64:67], v[100:103], v[40:43]
    v_mfma_f32_16x16x32_bf16 v[44:47], v[104:107], v[60:63], v[44:47]
    v_mfma_f32_16x16x32_bf16 v[48:51], v[104:107], v[64:67], v[48:51]
    s_waitcnt lgkmcnt(0)
    s_waitcnt vmcnt(0)
    s_barrier
    v_mfma_f32_16x16x32_bf16 v[12:15], v[52:55], v[68:71], v[12:15]
    ds_read_b128 v[60:63], v127 offset:13312
    ds_read_b128 v[64:67], v127 offset:27648
    v_mfma_f32_16x16x32_bf16 v[16:19], v[56:59], v[68:71], v[16:19]
    ds_read_b64_tr_b16 v[88:89], v152 offset:0
    ds_read_b64_tr_b16 v[90:91], v152 offset:2048
    v_mfma_f32_16x16x32_bf16 v[20:23], v[52:55], v[72:75], v[20:23]
    ds_read_b64_tr_b16 v[92:93], v153 offset:0
    ds_read_b64_tr_b16 v[94:95], v153 offset:2048
    v_mfma_f32_16x16x32_bf16 v[24:27], v[56:59], v[72:75], v[24:27]
    ds_read_b64_tr_b16 v[96:97], v154 offset:0
    ds_read_b64_tr_b16 v[98:99], v154 offset:2048
    v_mfma_f32_16x16x32_bf16 v[28:31], v[52:55], v[76:79], v[28:31]
    ds_read_b64_tr_b16 v[100:101], v155 offset:0
    ds_read_b64_tr_b16 v[102:103], v155 offset:2048
    v_mfma_f32_16x16x32_bf16 v[32:35], v[56:59], v[76:79], v[32:35]
    ds_read_b64_tr_b16 v[104:105], v156 offset:0
    ds_read_b64_tr_b16 v[106:107], v156 offset:2048
    v_mfma_f32_16x16x32_bf16 v[36:39], v[52:55], v[80:83], v[36:39]
    v_mfma_f32_16x16x32_bf16 v[40:43], v[56:59], v[80:83], v[40:43]
    v_mfma_f32_16x16x32_bf16 v[44:47], v[84:87], v[52:55], v[44:47]
    v_mfma_f32_16x16x32_bf16 v[48:51], v[84:87], v[56:59], v[48:51]
    s_waitcnt lgkmcnt(0)
    s_barrier
    v_mfma_f32_16x16x32_bf16 v[12:15], v[60:63], v[88:91], v[12:15]
    v_mfma_f32_16x16x32_bf16 v[16:19], v[64:67], v[88:91], v[16:19]
    v_mfma_f32_16x16x32_bf16 v[20:23], v[60:63], v[92:95], v[20:23]
    v_mfma_f32_16x16x32_bf16 v[24:27], v[64:67], v[92:95], v[24:27]
    v_mfma_f32_16x16x32_bf16 v[28:31], v[60:63], v[96:99], v[28:31]
    v_mfma_f32_16x16x32_bf16 v[32:35], v[64:67], v[96:99], v[32:35]
    v_mfma_f32_16x16x32_bf16 v[36:39], v[60:63], v[100:103], v[36:39]
    v_mfma_f32_16x16x32_bf16 v[40:43], v[64:67], v[100:103], v[40:43]
    v_mfma_f32_16x16x32_bf16 v[44:47], v[104:107], v[60:63], v[44:47]
    v_mfma_f32_16x16x32_bf16 v[48:51], v[104:107], v[64:67], v[48:51]
    s_branch p1_B_epi
p1_B_epi:
    s_lshl_b32 s57, s29, 1
    s_add_u32 s57, s57, s36
    s_cmp_lg_u32 s28, 5
    s_cbranch_scc1 p1_no_stats
    s_and_b32 s31, s29, 3
    s_lshl_b32 s31, s31, 6
    s_lshr_b32 s32, s29, 2
    s_lshl_b32 s32, s32, 2
    s_add_u32 s31, s31, s32
    v_mov_b32 v109, 0
    s_mov_b32 s56, 0
p1_poll:
    s_waitcnt vmcnt(0)
    v_readfirstlane_b32 s32, v108
    s_add_u32 s56, s56, 1
    s_cmp_ge_u32 s56, 0x100000
    s_cbranch_scc1 p1_poll_done
    s_nop 0
    s_cmp_ge_u32 s32, 7
    s_cbranch_scc1 p1_poll_done
    buffer_load_dword v108, v109, s[24:27], s31 offen sc1
    s_branch p1_poll
p1_poll_done:
    v_lshlrev_b32 v162, 3, v1
    s_lshl_b32 s31, s29, 12
    s_add_u32 s31, s31, 0x1240000
    buffer_load_dwordx2 v[76:77], v162, s[20:23], s31 offen offset:0 sc1
    buffer_load_dwordx2 v[78:79], v162, s[20:23], s31 offen offset:512 sc1
    buffer_load_dwordx2 v[80:81], v162, s[20:23], s31 offen offset:1024 sc1
    buffer_load_dwordx2 v[82:83], v162, s[20:23], s31 offen offset:1536 sc1
    buffer_load_dwordx2 v[84:85], v162, s[20:23], s31 offen offset:2048 sc1
    buffer_load_dwordx2 v[86:87], v162, s[20:23], s31 offen offset:2560 sc1
    buffer_load_dwordx2 v[88:89], v162, s[20:23], s31 offen offset:3072 sc1
p1_no_stats:
    s_cmp_eq_u32 s35, 3
    s_cbranch_scc1 p1_epi_z4
    s_cmp_eq_u32 s35, 2
    s_cbranch_scc1 p1_epi_v
    s_cmp_eq_u32 s35, 0
    s_cbranch_scc0 p1_qk_k
    s_lshl_b32 s49, s57, 11
    s_add_u32 s49, s49, 0x0
    s_mov_b32 s96, 0
    s_mov_b32 s97, 0
    v_mov_b32 v108, 0x3e8b97f6
    v_mov_b32 v109, 0x3e8b97f6
    v_pk_mul_f32 v[12:13], v[12:13], v[108:109]
    v_pk_mul_f32 v[14:15], v[14:15], v[108:109]
    v_pk_mul_f32 v[16:17], v[16:17], v[108:109]
    v_pk_mul_f32 v[18:19], v[18:19], v[108:109]
    v_pk_mul_f32 v[20:21], v[20:21], v[108:109]
    v_pk_mul_f32 v[22:23], v[22:23], v[108:109]
    v_pk_mul_f32 v[24:25], v[24:25], v[108:109]
    v_pk_mul_f32 v[26:27], v[26:27], v[108:109]
    v_pk_mul_f32 v[28:29], v[28:29], v[108:109]
    v_pk_mul_f32 v[30:31], v[30:31], v[108:109]
    v_pk_mul_f32 v[32:33], v[32:33], v[108:109]
    v_pk_mul_f32 v[34:35], v[34:35], v[108:109]
    v_pk_mul_f32 v[36:37], v[36:37], v[108:109]
    v_pk_mul_f32 v[38:39], v[38:39], v[108:109]
    v_pk_mul_f32 v[40:41], v[40:41], v[108:109]
    v_pk_mul_f32 v[42:43], v[42:43], v[108:109]
    s_branch p1_qk_go
p1_qk_k:
    s_lshl_b32 s49, s57, 12
    s_add_u32 s49, s49, 0x200000
    s_mov_b32 s96, 0x3f803f80
    s_mov_b32 s97, 0x3f80
p1_qk_go:
    v_cvt_pk_bf16_f32 v164, v12, v13
    v_cvt_pk_bf16_f32 v165, v14, v15
    v_mov_b32 v166, s96
    v_mov_b32 v167, s97
    v_cvt_pk_bf16_f32 v168, v16, v17
    v_cvt_pk_bf16_f32 v169, v18, v19
    v_mov_b32 v170, s96
    v_mov_b32 v171, s97
    v_cvt_pk_bf16_f32 v172, v20, v21
    v_cvt_pk_bf16_f32 v173, v22, v23
    v_mov_b32 v174, s96
    v_mov_b32 v175, s97
    v_cvt_pk_bf16_f32 v176, v24, v25
    v_cvt_pk_bf16_f32 v177, v26, v27
    v_mov_b32 v178, s96
    v_mov_b32 v179, s97
    v_cvt_pk_bf16_f32 v180, v28, v29
    v_cvt_pk_bf16_f32 v181, v30, v31
    v_mov_b32 v182, s96
    v_mov_b32 v183, s97
    v_cvt_pk_bf16_f32 v184, v32, v33
    v_cvt_pk_bf16_f32 v185, v34, v35
    v_mov_b32 v186, s96
    v_mov_b32 v187, s97
    v_cvt_pk_bf16_f32 v188, v36, v37
    v_cvt_pk_bf16_f32 v189, v38, v39
    v_mov_b32 v190, s96
    v_mov_b32 v191, s97
    v_cvt_pk_bf16_f32 v192, v40, v41
    v_cvt_pk_bf16_f32 v193, v42, v43
    v_mov_b32 v194, s96
    v_mov_b32 v195, s97
    s_cmp_lg_u32 s28, 5
    s_cbranch_scc1 p1_fs
    s_waitcnt vmcnt(0)
    v_pk_add_f32 v[76:77], v[76:77], v[78:79]
    v_pk_add_f32 v[80:81], v[80:81], v[82:83]
    v_pk_add_f32 v[84:85], v[84:85], v[86:87]
    v_pk_add_f32 v[76:77], v[76:77], v[80:81]
    v_pk_add_f32 v[84:85], v[84:85], v[88:89]
    v_pk_add_f32 v[76:77], v[76:77], v[84:85]
    v_mul_f32 v78, 0x3a924925, v76
    v_mul_f32 v79, 0x3a924925, v77
    v_fma_f32 v79, -v78, v78, v79
    v_max_f32 v79, 0, v79
    v_add_f32 v79, 0x3727c5ac, v79
    v_rsq_f32 v79, v79
    v_lshlrev_b32 v80, 3, v1
    v_add_u32 v80, 161792, v80
    ds_write_b64 v80, v[78:79]
p1_fs:
    v_cmp_eq_u32 vcc, 0, v236
    s_nop 3
    s_and_saveexec_b64 s[98:99], vcc
    s_cbranch_execz p1_qm1
    buffer_store_dwordx2 v[164:165], v232, s[20:23], s49 offen offset:0 sc1
    buffer_store_dwordx2 v[168:169], v232, s[20:23], s49 offen offset:128 sc1
p1_qm1:
    s_mov_b64 exec, s[98:99]
    v_cmp_eq_u32 vcc, 1, v236
    s_nop 3
    s_and_saveexec_b64 s[98:99], vcc
    s_cbranch_execz p1_qm2
    buffer_store_dwordx4 v[164:167], v232, s[20:23], s49 offen offset:0 sc1
    buffer_store_dwordx4 v[168:171], v232, s[20:23], s49 offen offset:128 sc1
p1_qm2:
    s_mov_b64 exec, s[98:99]
    v_cmp_eq_u32 vcc, 0, v237
    s_nop 3
    s_and_saveexec_b64 s[98:99], vcc
    s_cbranch_execz p1_qm3
    buffer_store_dwordx2 v[172:173], v233, s[20:23], s49 offen offset:0 sc1
    buffer_store_dwordx2 v[176:177], v233, s[20:23], s49 offen offset:128 sc1
p1_qm3:
    s_mov_b64 exec, s[98:99]
    v_cmp_eq_u32 vcc, 1, v237
    s_nop 3
    s_and_saveexec_b64 s[98:99], vcc
    s_cbranch_execz p1_qm4
    buffer_store_dwordx4 v[172:175], v233, s[20:23], s49 offen offset:0 sc1
    buffer_store_dwordx4 v[176:179], v233, s[20:23], s49 offen offset:128 sc1
p1_qm4:
    s_mov_b64 exec, s[98:99]
    v_cmp_eq_u32 vcc, 0, v238
    s_nop 3
    s_and_saveexec_b64 s[98:99], vcc
    s_cbranch_execz p1_qm5
    buffer_store_dwordx2 v[180:181], v234, s[20:23], s49 offen offset:0 sc1
    buffer_store_dwordx2 v[184:185], v234, s[20:23], s49 offen offset:128 sc1
p1_qm5:
    s_mov_b64 exec, s[98:99]
    v_cmp_eq_u32 vcc, 1, v238
    s_nop 3
    s_and_saveexec_b64 s[98:99], vcc
    s_cbranch_execz p1_qm6
    buffer_store_dwordx4 v[180:183], v234, s[20:23], s49 offen offset:0 sc1
    buffer_store_dwordx4 v[184:187], v234, s[20:23], s49 offen offset:128 sc1
p1_qm6:
    s_mov_b64 exec, s[98:99]
    v_cmp_eq_u32 vcc, 0, v239
    s_nop 3
    s_and_saveexec_b64 s[98:99], vcc
    s_cbranch_execz p1_qm7
    buffer_store_dwordx2 v[188:189], v235, s[20:23], s49 offen offset:0 sc1
    buffer_store_dwordx2 v[192:193], v235, s[20:23], s49 offen offset:128 sc1
p1_qm7:
    s_mov_b64 exec, s[98:99]
    v_cmp_eq_u32 vcc, 1, v239
    s_nop 3
    s_and_saveexec_b64 s[98:99], vcc
    s_cbranch_execz p1_qm8
    buffer_store_dwordx4 v[188:191], v235, s[20:23], s49 offen offset:0 sc1
    buffer_store_dwordx4 v[192:195], v235, s[20:23], s49 offen offset:128 sc1
p1_qm8:
    s_mov_b64 exec, s[98:99]
    s_branch p1_epi_fifth
p1_epi_v:
    s_lshl_b32 s49, s57, 12
    s_add_u32 s49, s49, 0x200800
    v_cvt_pk_bf16_f32 v108, v12, v13
    v_cvt_pk_bf16_f32 v109, v14, v15
    v_cvt_pk_bf16_f32 v110, v16, v17
    v_cvt_pk_bf16_f32 v111, v18, v19
    v_cvt_pk_bf16_f32 v112, v20, v21
    v_cvt_pk_bf16_f32 v113, v22, v23
    v_cvt_pk_bf16_f32 v114, v24, v25
    v_cvt_pk_bf16_f32 v115, v26, v27
    v_cvt_pk_bf16_f32 v116, v28, v29
    v_cvt_pk_bf16_f32 v117, v30, v31
    v_cvt_pk_bf16_f32 v118, v32, v33
    v_cvt_pk_bf16_f32 v119, v34, v35
    v_cvt_pk_bf16_f32 v120, v36, v37
    v_cvt_pk_bf16_f32 v121, v38, v39
    v_cvt_pk_bf16_f32 v122, v40, v41
    v_cvt_pk_bf16_f32 v123, v42, v43
    buffer_store_dwordx4 v[108:111], v232, s[20:23], s49 offen sc1
    buffer_store_dwordx4 v[112:115], v233, s[20:23], s49 offen sc1
    buffer_store_dwordx4 v[116:119], v234, s[20:23], s49 offen sc1
    buffer_store_dwordx4 v[120:123], v235, s[20:23], s49 offen sc1
    v_cmp_eq_u32 vcc, 24, v236
    v_mov_b32 v5, 0x3f803f80
    s_nop 0
    v_cndmask_b32 v52, 0, v5, vcc
    v_mov_b32 v53, v52
    v_mov_b32 v54, v52
    v_mov_b32 v55, v52
    v_cmp_le_u32 vcc, 24, v236
    s_nop 3
    s_and_saveexec_b64 s[98:99], vcc
    s_cbranch_execz p1_vpad0
    buffer_store_dwordx4 v[52:55], v232, s[20:23], s49 offen offset:64 sc1
p1_vpad0:
    s_mov_b64 exec, s[98:99]
    v_cmp_eq_u32 vcc, 24, v237
    v_mov_b32 v5, 0x3f803f80
    s_nop 0
    v_cndmask_b32 v56, 0, v5, vcc
    v_mov_b32 v57, v56
    v_mov_b32 v58, v56
    v_mov_b32 v59, v56
    v_cmp_le_u32 vcc, 24, v237
    s_nop 3
    s_and_saveexec_b64 s[98:99], vcc
    s_cbranch_execz p1_vpad1
    buffer_store_dwordx4 v[56:59], v233, s[20:23], s49 offen offset:64 sc1
p1_vpad1:
    s_mov_b64 exec, s[98:99]
    v_cmp_eq_u32 vcc, 24, v238
    v_mov_b32 v5, 0x3f803f80
    s_nop 0
    v_cndmask_b32 v52, 0, v5, vcc
    v_mov_b32 v53, v52
    v_mov_b32 v54, v52
    v_mov_b32 v55, v52
    v_cmp_le_u32 vcc, 24, v238
    s_nop 3
    s_and_saveexec_b64 s[98:99], vcc
    s_cbranch_execz p1_vpad2
    buffer_store_dwordx4 v[52:55], v234, s[20:23], s49 offen offset:64 sc1
p1_vpad2:
    s_mov_b64 exec, s[98:99]
    v_cmp_eq_u32 vcc, 24, v239
    v_mov_b32 v5, 0x3f803f80
    s_nop 0
    v_cndmask_b32 v56, 0, v5, vcc
    v_mov_b32 v57, v56
    v_mov_b32 v58, v56
    v_mov_b32 v59, v56
    v_cmp_le_u32 vcc, 24, v239
    s_nop 3
    s_and_saveexec_b64 s[98:99], vcc
    s_cbranch_execz p1_vpad3
    buffer_store_dwordx4 v[56:59], v235, s[20:23], s49 offen offset:64 sc1
p1_vpad3:
    s_mov_b64 exec, s[98:99]
    s_branch p1_epi_fifth
p1_epi_z4:
    v_lshlrev_b32 v162, 4, v1
    s_lshl_b32 s58, s30, 3
    s_add_u32 s58, s58, 4
    v_pk_mul_f32 v[108:109], v[12:13], v[12:13]
    v_pk_mul_f32 v[110:111], v[14:15], v[14:15]
    v_pk_mul_f32 v[112:113], v[16:17], v[16:17]
    v_pk_mul_f32 v[114:115], v[18:19], v[18:19]
    v_pk_fma_f32 v[108:109], v[108:109], s[6:7], v[148:149]
    v_pk_fma_f32 v[110:111], v[110:111], s[6:7], v[148:149]
    v_pk_fma_f32 v[112:113], v[112:113], s[6:7], v[148:149]
    v_pk_fma_f32 v[114:115], v[114:115], s[6:7], v[148:149]
    v_pk_mul_f32 v[108:109], v[108:109], v[12:13]
    v_pk_mul_f32 v[110:111], v[110:111], v[14:15]
    v_pk_mul_f32 v[112:113], v[112:113], v[16:17]
    v_pk_mul_f32 v[114:115], v[114:115], v[18:19]
    v_exp_f32 v108, v108
    v_exp_f32 v109, v109
    v_exp_f32 v110, v110
    v_exp_f32 v111, v111
    v_exp_f32 v112, v112
    v_exp_f32 v113, v113
    v_exp_f32 v114, v114
    v_exp_f32 v115, v115
    v_pk_add_f32 v[108:109], v[108:109], v[150:151]
    v_pk_add_f32 v[110:111], v[110:111], v[150:151]
    v_pk_add_f32 v[112:113], v[112:113], v[150:151]
    v_pk_add_f32 v[114:115], v[114:115], v[150:151]
    v_rcp_f32 v108, v108
    v_rcp_f32 v109, v109
    v_rcp_f32 v110, v110
    v_rcp_f32 v111, v111
    v_rcp_f32 v112, v112
    v_rcp_f32 v113, v113
    v_rcp_f32 v114, v114
    v_rcp_f32 v115, v115
    v_pk_mul_f32 v[12:13], v[12:13], v[108:109]
    v_pk_mul_f32 v[14:15], v[14:15], v[110:111]
    v_pk_mul_f32 v[16:17], v[16:17], v[112:113]
    v_pk_mul_f32 v[18:19], v[18:19], v[114:115]
    v_cvt_pk_bf16_f32 v116, v12, v13
    v_cvt_pk_bf16_f32 v117, v14, v15
    v_cvt_pk_bf16_f32 v118, v16, v17
    v_cvt_pk_bf16_f32 v119, v18, v19
    s_mul_i32 s31, s57, 56
    s_add_u32 s31, s31, s58
    s_lshl_b32 s31, s31, 10
    s_add_u32 s31, s31, 0x980000
    buffer_store_dwordx4 v[116:119], v162, s[20:23], s31 offen sc1
    s_add_u32 s58, s58, 1
    v_pk_mul_f32 v[108:109], v[20:21], v[20:21]
    v_pk_mul_f32 v[110:111], v[22:23], v[22:23]
    v_pk_mul_f32 v[112:113], v[24:25], v[24:25]
    v_pk_mul_f32 v[114:115], v[26:27], v[26:27]
    v_pk_fma_f32 v[108:109], v[108:109], s[6:7], v[148:149]
    v_pk_fma_f32 v[110:111], v[110:111], s[6:7], v[148:149]
    v_pk_fma_f32 v[112:113], v[112:113], s[6:7], v[148:149]
    v_pk_fma_f32 v[114:115], v[114:115], s[6:7], v[148:149]
    v_pk_mul_f32 v[108:109], v[108:109], v[20:21]
    v_pk_mul_f32 v[110:111], v[110:111], v[22:23]
    v_pk_mul_f32 v[112:113], v[112:113], v[24:25]
    v_pk_mul_f32 v[114:115], v[114:115], v[26:27]
    v_exp_f32 v108, v108
    v_exp_f32 v109, v109
    v_exp_f32 v110, v110
    v_exp_f32 v111, v111
    v_exp_f32 v112, v112
    v_exp_f32 v113, v113
    v_exp_f32 v114, v114
    v_exp_f32 v115, v115
    v_pk_add_f32 v[108:109], v[108:109], v[150:151]
    v_pk_add_f32 v[110:111], v[110:111], v[150:151]
    v_pk_add_f32 v[112:113], v[112:113], v[150:151]
    v_pk_add_f32 v[114:115], v[114:115], v[150:151]
    v_rcp_f32 v108, v108
    v_rcp_f32 v109, v109
    v_rcp_f32 v110, v110
    v_rcp_f32 v111, v111
    v_rcp_f32 v112, v112
    v_rcp_f32 v113, v113
    v_rcp_f32 v114, v114
    v_rcp_f32 v115, v115
    v_pk_mul_f32 v[20:21], v[20:21], v[108:109]
    v_pk_mul_f32 v[22:23], v[22:23], v[110:111]
    v_pk_mul_f32 v[24:25], v[24:25], v[112:113]
    v_pk_mul_f32 v[26:27], v[26:27], v[114:115]
    v_cvt_pk_bf16_f32 v116, v20, v21
    v_cvt_pk_bf16_f32 v117, v22, v23
    v_cvt_pk_bf16_f32 v118, v24, v25
    v_cvt_pk_bf16_f32 v119, v26, v27
    s_mul_i32 s31, s57, 56
    s_add_u32 s31, s31, s58
    s_lshl_b32 s31, s31, 10
    s_add_u32 s31, s31, 0x980000
    buffer_store_dwordx4 v[116:119], v162, s[20:23], s31 offen sc1
    s_add_u32 s58, s58, 1
    v_pk_mul_f32 v[108:109], v[28:29], v[28:29]
    v_pk_mul_f32 v[110:111], v[30:31], v[30:31]
    v_pk_mul_f32 v[112:113], v[32:33], v[32:33]
    v_pk_mul_f32 v[114:115], v[34:35], v[34:35]
    v_pk_fma_f32 v[108:109], v[108:109], s[6:7], v[148:149]
    v_pk_fma_f32 v[110:111], v[110:111], s[6:7], v[148:149]
    v_pk_fma_f32 v[112:113], v[112:113], s[6:7], v[148:149]
    v_pk_fma_f32 v[114:115], v[114:115], s[6:7], v[148:149]
    v_pk_mul_f32 v[108:109], v[108:109], v[28:29]
    v_pk_mul_f32 v[110:111], v[110:111], v[30:31]
    v_pk_mul_f32 v[112:113], v[112:113], v[32:33]
    v_pk_mul_f32 v[114:115], v[114:115], v[34:35]
    v_exp_f32 v108, v108
    v_exp_f32 v109, v109
    v_exp_f32 v110, v110
    v_exp_f32 v111, v111
    v_exp_f32 v112, v112
    v_exp_f32 v113, v113
    v_exp_f32 v114, v114
    v_exp_f32 v115, v115
    v_pk_add_f32 v[108:109], v[108:109], v[150:151]
    v_pk_add_f32 v[110:111], v[110:111], v[150:151]
    v_pk_add_f32 v[112:113], v[112:113], v[150:151]
    v_pk_add_f32 v[114:115], v[114:115], v[150:151]
    v_rcp_f32 v108, v108
    v_rcp_f32 v109, v109
    v_rcp_f32 v110, v110
    v_rcp_f32 v111, v111
    v_rcp_f32 v112, v112
    v_rcp_f32 v113, v113
    v_rcp_f32 v114, v114
    v_rcp_f32 v115, v115
    v_pk_mul_f32 v[28:29], v[28:29], v[108:109]
    v_pk_mul_f32 v[30:31], v[30:31], v[110:111]
    v_pk_mul_f32 v[32:33], v[32:33], v[112:113]
    v_pk_mul_f32 v[34:35], v[34:35], v[114:115]
    v_cvt_pk_bf16_f32 v116, v28, v29
    v_cvt_pk_bf16_f32 v117, v30, v31
    v_cvt_pk_bf16_f32 v118, v32, v33
    v_cvt_pk_bf16_f32 v119, v34, v35
    s_mul_i32 s31, s57, 56
    s_add_u32 s31, s31, s58
    s_lshl_b32 s31, s31, 10
    s_add_u32 s31, s31, 0x980000
    buffer_store_dwordx4 v[116:119], v162, s[20:23], s31 offen sc1
    s_add_u32 s58, s58, 1
    v_pk_mul_f32 v[108:109], v[36:37], v[36:37]
    v_pk_mul_f32 v[110:111], v[38:39], v[38:39]
    v_pk_mul_f32 v[112:113], v[40:41], v[40:41]
    v_pk_mul_f32 v[114:115], v[42:43], v[42:43]
    v_pk_fma_f32 v[108:109], v[108:109], s[6:7], v[148:149]
    v_pk_fma_f32 v[110:111], v[110:111], s[6:7], v[148:149]
    v_pk_fma_f32 v[112:113], v[112:113], s[6:7], v[148:149]
    v_pk_fma_f32 v[114:115], v[114:115], s[6:7], v[148:149]
    v_pk_mul_f32 v[108:109], v[108:109], v[36:37]
    v_pk_mul_f32 v[110:111], v[110:111], v[38:39]
    v_pk_mul_f32 v[112:113], v[112:113], v[40:41]
    v_pk_mul_f32 v[114:115], v[114:115], v[42:43]
    v_exp_f32 v108, v108
    v_exp_f32 v109, v109
    v_exp_f32 v110, v110
    v_exp_f32 v111, v111
    v_exp_f32 v112, v112
    v_exp_f32 v113, v113
    v_exp_f32 v114, v114
    v_exp_f32 v115, v115
    v_pk_add_f32 v[108:109], v[108:109], v[150:151]
    v_pk_add_f32 v[110:111], v[110:111], v[150:151]
    v_pk_add_f32 v[112:113], v[112:113], v[150:151]
    v_pk_add_f32 v[114:115], v[114:115], v[150:151]
    v_rcp_f32 v108, v108
    v_rcp_f32 v109, v109
    v_rcp_f32 v110, v110
    v_rcp_f32 v111, v111
    v_rcp_f32 v112, v112
    v_rcp_f32 v113, v113
    v_rcp_f32 v114, v114
    v_rcp_f32 v115, v115
    v_pk_mul_f32 v[36:37], v[36:37], v[108:109]
    v_pk_mul_f32 v[38:39], v[38:39], v[110:111]
    v_pk_mul_f32 v[40:41], v[40:41], v[112:113]
    v_pk_mul_f32 v[42:43], v[42:43], v[114:115]
    v_cvt_pk_bf16_f32 v116, v36, v37
    v_cvt_pk_bf16_f32 v117, v38, v39
    v_cvt_pk_bf16_f32 v118, v40, v41
    v_cvt_pk_bf16_f32 v119, v42, v43
    s_mul_i32 s31, s57, 56
    s_add_u32 s31, s31, s58
    s_lshl_b32 s31, s31, 10
    s_add_u32 s31, s31, 0x980000
    buffer_store_dwordx4 v[116:119], v162, s[20:23], s31 offen sc1
    s_add_u32 s58, s58, 1
p1_epi_fifth:
    v_lshlrev_b32 v162, 4, v1
    s_lshl_b32 s58, s30, 3
    s_add_u32 s58, s58, s35
    v_pk_mul_f32 v[108:109], v[44:45], v[44:45]
    v_pk_mul_f32 v[110:111], v[46:47], v[46:47]
    v_pk_mul_f32 v[112:113], v[48:49], v[48:49]
    v_pk_mul_f32 v[114:115], v[50:51], v[50:51]
    v_pk_fma_f32 v[108:109], v[108:109], s[6:7], v[148:149]
    v_pk_fma_f32 v[110:111], v[110:111], s[6:7], v[148:149]
    v_pk_fma_f32 v[112:113], v[112:113], s[6:7], v[148:149]
    v_pk_fma_f32 v[114:115], v[114:115], s[6:7], v[148:149]
    v_pk_mul_f32 v[108:109], v[108:109], v[44:45]
    v_pk_mul_f32 v[110:111], v[110:111], v[46:47]
    v_pk_mul_f32 v[112:113], v[112:113], v[48:49]
    v_pk_mul_f32 v[114:115], v[114:115], v[50:51]
    v_exp_f32 v108, v108
    v_exp_f32 v109, v109
    v_exp_f32 v110, v110
    v_exp_f32 v111, v111
    v_exp_f32 v112, v112
    v_exp_f32 v113, v113
    v_exp_f32 v114, v114
    v_exp_f32 v115, v115
    v_pk_add_f32 v[108:109], v[108:109], v[150:151]
    v_pk_add_f32 v[110:111], v[110:111], v[150:151]
    v_pk_add_f32 v[112:113], v[112:113], v[150:151]
    v_pk_add_f32 v[114:115], v[114:115], v[150:151]
    v_rcp_f32 v108, v108
    v_rcp_f32 v109, v109
    v_rcp_f32 v110, v110
    v_rcp_f32 v111, v111
    v_rcp_f32 v112, v112
    v_rcp_f32 v113, v113
    v_rcp_f32 v114, v114
    v_rcp_f32 v115, v115
    v_pk_mul_f32 v[44:45], v[44:45], v[108:109]
    v_pk_mul_f32 v[46:47], v[46:47], v[110:111]
    v_pk_mul_f32 v[48:49], v[48:49], v[112:113]
    v_pk_mul_f32 v[50:51], v[50:51], v[114:115]
    v_cvt_pk_bf16_f32 v116, v44, v45
    v_cvt_pk_bf16_f32 v117, v46, v47
    v_cvt_pk_bf16_f32 v118, v48, v49
    v_cvt_pk_bf16_f32 v119, v50, v51
    s_mul_i32 s31, s57, 56
    s_add_u32 s31, s31, s58
    s_lshl_b32 s31, s31, 10
    s_add_u32 s31, s31, 0x980000
    buffer_store_dwordx4 v[116:119], v162, s[20:23], s31 offen sc1
    s_waitcnt lgkmcnt(0)
    s_barrier
    v_lshrrev_b32 v3, 4, v1
    v_lshlrev_b32 v3, 6, v3
    s_lshl_b32 s31, s36, 8
    s_add_u32 s31, s31, 161792
    v_add_u32 v3, s31, v3
    ds_read_b128 v[108:111], v3 offset:0
    ds_read_b128 v[112:115], v3 offset:16
    ds_read_b128 v[116:119], v3 offset:32
    ds_read_b128 v[120:123], v3 offset:48
    s_waitcnt lgkmcnt(0)
    v_sub_f32 v132, v132, v108
    v_sub_f32 v133, v133, v110
    v_sub_f32 v134, v134, v112
    v_sub_f32 v135, v135, v114
    v_sub_f32 v136, v136, v116
    v_sub_f32 v137, v137, v118
    v_sub_f32 v138, v138, v120
    v_sub_f32 v139, v139, v122
    v_sub_f32 v140, v140, v108
    v_sub_f32 v141, v141, v110
    v_sub_f32 v142, v142, v112
    v_sub_f32 v143, v143, v114
    v_sub_f32 v144, v144, v116
    v_sub_f32 v145, v145, v118
    v_sub_f32 v146, v146, v120
    v_sub_f32 v147, v147, v122
    v_mul_f32 v132, v132, v109
    v_mul_f32 v133, v133, v111
    v_mul_f32 v134, v134, v113
    v_mul_f32 v135, v135, v115
    v_mul_f32 v136, v136, v117
    v_mul_f32 v137, v137, v119
    v_mul_f32 v138, v138, v121
    v_mul_f32 v139, v139, v123
    v_mul_f32 v140, v140, v109
    v_mul_f32 v141, v141, v111
    v_mul_f32 v142, v142, v113
    v_mul_f32 v143, v143, v115
    v_mul_f32 v144, v144, v117
    v_mul_f32 v145, v145, v119
    v_mul_f32 v146, v146, v121
    v_mul_f32 v147, v147, v123
    v_cvt_pk_bf16_f32 v12, v132, v133
    v_cvt_pk_bf16_f32 v13, v134, v135
    v_cvt_pk_bf16_f32 v14, v136, v137
    v_cvt_pk_bf16_f32 v15, v138, v139
    v_cvt_pk_bf16_f32 v16, v140, v141
    v_cvt_pk_bf16_f32 v17, v142, v143
    v_cvt_pk_bf16_f32 v18, v144, v145
    v_cvt_pk_bf16_f32 v19, v146, v147
    v_lshlrev_b32 v162, 4, v1
    s_lshl_b32 s31, s30, 3
    s_lshl_b32 s32, s35, 1
    s_add_u32 s31, s31, s32
    s_add_u32 s31, s31, 0
    s_mul_i32 s32, s31, 9363
    s_lshr_b32 s32, s32, 16
    s_mul_i32 s33, s32, 7
    s_sub_u32 s31, s31, s33
    s_lshl_b32 s32, s32, 6
    s_add_u32 s32, s32, s57
    s_mul_i32 s32, s32, 7
    s_add_u32 s31, s31, s32
    s_lshl_b32 s31, s31, 10
    s_add_u32 s31, s31, 0x600000
    buffer_store_dwordx4 v[12:15], v162, s[20:23], s31 offen sc1
    s_lshl_b32 s31, s30, 3
    s_lshl_b32 s32, s35, 1
    s_add_u32 s31, s31, s32
    s_add_u32 s31, s31, 1
    s_mul_i32 s32, s31, 9363
    s_lshr_b32 s32, s32, 16
    s_mul_i32 s33, s32, 7
    s_sub_u32 s31, s31, s33
    s_lshl_b32 s32, s32, 6
    s_add_u32 s32, s32, s57
    s_mul_i32 s32, s32, 7
    s_add_u32 s31, s31, s32
    s_lshl_b32 s31, s31, 10
    s_add_u32 s31, s31, 0x600000
    buffer_store_dwordx4 v[16:19], v162, s[20:23], s31 offen sc1
    s_endpgm
p1_pf:
    s_load_dwordx2 s[4:5], s[0:1], 40
    s_load_dwordx2 s[6:7], s[0:1], 16
    s_load_dwordx2 s[28:29], s[0:1], 56
    v_lshlrev_b32 v1, 7, v0
    s_sub_u32 s30, s2, 224
    s_load_dwordx2 s[36:37], s[0:1], 72
    s_waitcnt lgkmcnt(0)
    s_mov_b32 s8, s4
    s_mov_b32 s9, s5
    s_mov_b32 s10, 0x800000
    s_mov_b32 s11, 0x20000
    s_mov_b32 s12, s6
    s_mov_b32 s13, s7
    s_mov_b32 s14, 0x62000
    s_mov_b32 s15, 0x20000
    s_mov_b32 s16, s28
    s_mov_b32 s17, s29
    s_mov_b32 s18, 0xc4000
    s_mov_b32 s19, 0x20000
    s_and_b32 s31, s30, 7
    s_lshr_b32 s32, s31, 1
    s_lshl_b32 s32, s32, 3
    s_lshr_b32 s33, s30, 3
    s_lshl_b32 s33, s33, 1
    s_add_u32 s32, s32, s33
    s_and_b32 s31, s31, 1
    s_add_u32 s32, s32, s31
    s_lshl_b32 s32, s32, 18
    buffer_load_dword v2, v1, s[8:11], s32 offen
    s_add_u32 s32, s32, 65536
    buffer_load_dword v3, v1, s[8:11], s32 offen
    s_add_u32 s32, s32, 65536
    buffer_load_dword v4, v1, s[8:11], s32 offen
    s_add_u32 s32, s32, 65536
    buffer_load_dword v5, v1, s[8:11], s32 offen
    s_add_u32 s32, s32, 65536
    v_cmp_gt_u32 vcc, 98, v0
    s_nop 3
    s_and_saveexec_b64 s[34:35], vcc
    s_cbranch_execz p1_pf1
    s_mul_i32 s32, s30, 12544
    buffer_load_dword v6, v1, s[12:15], s32 offen
p1_pf1:
    s_mov_b64 exec, s[34:35]
    v_cmp_gt_u32 vcc, 196, v0
    s_nop 3
    s_and_saveexec_b64 s[34:35], vcc
    s_cbranch_execz p1_pf2
    s_mul_i32 s32, s30, 25088
    buffer_load_dword v7, v1, s[16:19], s32 offen
p1_pf2:
    s_mov_b64 exec, s[34:35]
    s_waitcnt vmcnt(0)
p1_end:
    s_endpgm
p1_B_F0_k0_x:
    v_lshlrev_b32 v116, 3, v1
    v_add_u32 v117, 159744, v116
    ds_read_b64 v[108:109], v117 offset:0
    ds_read_b64 v[110:111], v117 offset:512
    ds_read_b64 v[112:113], v117 offset:1024
    ds_read_b64 v[114:115], v117 offset:1536
    s_waitcnt lgkmcnt(0)
    v_pk_add_f32 v[108:109], v[108:109], v[110:111]
    v_pk_add_f32 v[112:113], v[112:113], v[114:115]
    v_pk_add_f32 v[108:109], v[108:109], v[112:113]
    s_lshl_b32 s31, s29, 3
    s_add_u32 s31, s31, s30
    s_lshl_b32 s31, s31, 9
    s_add_u32 s31, s31, 0x1240000
    buffer_store_dwordx2 v[108:109], v116, s[20:23], s31 offen sc1
    buffer_load_dwordx2 v[118:119], v116, s[20:23], s31 offen sc1
    s_branch p1_B_F0_k0_r
p1_B_F0_k4_x:
    s_and_b32 s31, s29, 3
    s_lshl_b32 s31, s31, 6
    s_lshr_b32 s32, s29, 2
    s_lshl_b32 s32, s32, 2
    s_add_u32 s31, s31, s32
    v_mov_b32 v108, 1
    v_mov_b32 v109, 0
    s_mov_b32 exec_lo, 0x1
    s_mov_b32 exec_hi, 0x0
    buffer_atomic_add v108, v109, s[24:27], s31 offen sc1
    s_mov_b64 exec, -1
    s_branch p1_B_F0_k4_r
p1_B_F1_k12_x:
    s_and_b32 s31, s29, 3
    s_lshl_b32 s31, s31, 6
    s_lshr_b32 s32, s29, 2
    s_lshl_b32 s32, s32, 2
    s_add_u32 s31, s31, s32
    v_mov_b32 v109, 0
    buffer_load_dword v108, v109, s[24:27], s31 offen sc1
    s_branch p1_B_F1_k12_r
.globl p2_kernel
.p2align 8
.type p2_kernel,@function
p2_kernel:
    s_cmp_ge_u32 s2, 256
    s_cbranch_scc1 p2_end
    s_load_dwordx2 s[4:5], s[0:1], 40
    s_load_dwordx2 s[6:7], s[0:1], 48
    s_load_dwordx2 s[30:31], s[0:1], 80
    s_getpc_b64 s[98:99]
    v_lshrrev_b32 v255, 6, v0
    v_cmp_eq_u32 vcc, 3, v255
    s_lshr_b32 s96, s2, 3
    s_mul_i32 s97, s96, 32768
    s_lshr_b32 s97, s97, 16
    s_mul_i32 s97, s97, 2
    s_sub_u32 s96, s96, s97
    s_lshl_b32 s96, s96, 6
    v_and_b32 v255, 63, v0
    v_add_u32 v255, s96, v255
    s_mov_b32 s97, 111
    v_cmp_gt_u32 s[96:97], s97, v255
    s_nop 3
    s_and_b64 vcc, vcc, s[96:97]
    v_lshlrev_b32 v255, 7, v255
    s_and_saveexec_b64 s[96:97], vcc
    s_cbranch_execz p2_cpf
    global_load_dword v254, v255, s[98:99]
p2_cpf:
    s_mov_b64 exec, s[96:97]
    v_and_b32 v1, 63, v0
    v_lshrrev_b32 v3, 6, v0
    s_nop 0
    v_readfirstlane_b32 s20, v3
    v_lshlrev_b32 v2, 4, v1
    s_and_b32 s21, s2, 7
    s_lshr_b32 s22, s2, 3
    v_mov_b32 v10, 1
    s_mov_b32 s27, 0
    s_cmp_lg_u32 s20, 0
    s_cbranch_scc1 p2_noinit
    v_mov_b32 v4, 149520
    v_mov_b32 v12, 0
    v_mov_b32 v13, 0
    v_mov_b32 v14, 0
    v_mov_b32 v15, 0
    ds_write_b128 v4, v[12:15]
p2_noinit:
    s_waitcnt lgkmcnt(0)
    s_barrier
    s_mov_b32 s8, s30
    s_mov_b32 s9, s31
    s_mov_b32 s10, 0x1400000
    s_mov_b32 s11, 0x20000
    s_mov_b32 s12, s4
    s_mov_b32 s13, s5
    s_mov_b32 s14, 0x800000
    s_mov_b32 s15, 0x20000
    s_mov_b32 s16, s6
    s_mov_b32 s17, s7
    s_mov_b32 s18, 0x1000
    s_mov_b32 s19, 0x20000
    s_cmp_ge_u32 s20, 4
    s_cbranch_scc1 p2_spatial
    s_setprio 2
    v_mov_b32 v9, 149520
    s_lshr_b32 s23, s22, 4
    s_lshl_b32 s32, s21, 1
    s_add_u32 s32, s32, s23
    s_and_b32 s33, s22, 15
    s_lshl_b32 s23, s32, 6
    s_lshl_b32 s39, s33, 2
    s_add_u32 s24, s23, s39
    s_lshl_b32 s34, s24, 11
    s_add_u32 s34, s34, 0x0
    s_add_u32 s25, s34, 4096
    buffer_load_dwordx4 v[12:15], v2, s[8:11], s34 offen offset:0
    buffer_load_dwordx4 v[16:19], v2, s[8:11], s34 offen offset:1024
    buffer_load_dwordx4 v[20:23], v2, s[8:11], s34 offen offset:2048
    buffer_load_dwordx4 v[24:27], v2, s[8:11], s34 offen offset:3072
    buffer_load_dwordx4 v[28:31], v2, s[8:11], s25 offen offset:0
    buffer_load_dwordx4 v[32:35], v2, s[8:11], s25 offen offset:1024
    buffer_load_dwordx4 v[36:39], v2, s[8:11], s25 offen offset:2048
    buffer_load_dwordx4 v[40:43], v2, s[8:11], s25 offen offset:3072
    s_lshl_b32 s23, s23, 12
    s_add_u32 s23, s23, 0x200000
    buffer_load_dwordx4 v[204:207], v2, s[8:11], s23 offen offset:0
    buffer_load_dwordx4 v[208:211], v2, s[8:11], s23 offen offset:1024
    s_lshl_b32 s24, s20, 16
    s_add_u32 s36, s23, s24
    s_mov_b32 s35, s36
    buffer_load_dwordx4 v[156:159], v2, s[8:11], s35 offen offset:0
    buffer_load_dwordx4 v[160:163], v2, s[8:11], s35 offen offset:1024
    buffer_load_dwordx4 v[164:167], v2, s[8:11], s35 offen offset:2048
    buffer_load_dwordx4 v[168:171], v2, s[8:11], s35 offen offset:3072
    s_add_u32 s35, s35, 4096
    s_setprio 0
    s_mov_b32 s40, 0x7f800000
    s_mov_b32 s41, 0x41000000
    s_mov_b32 s38, 0
    v_mov_b32 v44, 0
    v_mov_b32 v45, 0
    v_mov_b32 v46, 0
    v_mov_b32 v47, 0
    v_mov_b32 v48, 0
    v_mov_b32 v49, 0
    v_mov_b32 v50, 0
    v_mov_b32 v51, 0
    v_mov_b32 v52, 0
    v_mov_b32 v53, 0
    v_mov_b32 v54, 0
    v_mov_b32 v55, 0
    v_mov_b32 v56, 0
    v_mov_b32 v57, 0
    v_mov_b32 v58, 0
    v_mov_b32 v59, 0
    v_mov_b32 v60, 0
    v_mov_b32 v61, 0
    v_mov_b32 v62, 0
    v_mov_b32 v63, 0
    v_mov_b32 v64, 0
    v_mov_b32 v65, 0
    v_mov_b32 v66, 0
    v_mov_b32 v67, 0
    v_mov_b32 v68, 0
    v_mov_b32 v69, 0
    v_mov_b32 v70, 0
    v_mov_b32 v71, 0
    v_mov_b32 v72, 0
    v_mov_b32 v73, 0
    v_mov_b32 v74, 0
    v_mov_b32 v75, 0
    v_mov_b32 v76, 0
    v_mov_b32 v77, 0
    v_mov_b32 v78, 0
    v_mov_b32 v79, 0
    v_mov_b32 v80, 0
    v_mov_b32 v81, 0
    v_mov_b32 v82, 0
    v_mov_b32 v83, 0
    v_mov_b32 v84, 0
    v_mov_b32 v85, 0
    v_mov_b32 v86, 0
    v_mov_b32 v87, 0
    v_mov_b32 v88, 0
    v_mov_b32 v89, 0
    v_mov_b32 v90, 0
    v_mov_b32 v91, 0
    v_mov_b32 v92, 0
    v_mov_b32 v93, 0
    v_mov_b32 v94, 0
    v_mov_b32 v95, 0
    v_mov_b32 v96, 0
    v_mov_b32 v97, 0
    v_mov_b32 v98, 0
    v_mov_b32 v99, 0
    v_mov_b32 v100, 0
    v_mov_b32 v101, 0
    v_mov_b32 v102, 0
    v_mov_b32 v103, 0
    v_mov_b32 v104, 0
    v_mov_b32 v105, 0
    v_mov_b32 v106, 0
    v_mov_b32 v107, 0
    s_waitcnt vmcnt(4)
    s_setprio 2
    v_mfma_f32_32x32x16_bf16 v[108:123], v[204:207], v[12:15], 0
    v_mfma_f32_32x32x16_bf16 v[108:123], v[208:211], v[16:19], v[108:123]
    v_mfma_f32_32x32x16_bf16 v[124:139], v[204:207], v[20:23], 0
    v_mfma_f32_32x32x16_bf16 v[124:139], v[208:211], v[24:27], v[124:139]
    s_nop 9
    v_max3_f32 v220, v108, v109, v110
    s_nop 0
    v_max3_f32 v221, v124, v125, v126
    v_max3_f32 v220, v220, v111, v112
    v_max3_f32 v221, v221, v127, v128
    v_max3_f32 v220, v220, v113, v114
    v_max3_f32 v221, v221, v129, v130
    v_max3_f32 v220, v220, v115, v116
    v_max3_f32 v221, v221, v131, v132
    v_max3_f32 v220, v220, v117, v118
    v_max3_f32 v221, v221, v133, v134
    v_max3_f32 v220, v220, v119, v120
    v_max3_f32 v221, v221, v135, v136
    v_max3_f32 v220, v220, v121, v122
    v_max3_f32 v221, v221, v137, v138
    v_max_f32 v220, v220, v123
    v_max_f32 v221, v221, v139
    v_mfma_f32_32x32x16_bf16 v[108:123], v[204:207], v[28:31], 0
    v_mfma_f32_32x32x16_bf16 v[108:123], v[208:211], v[32:35], v[108:123]
    v_mfma_f32_32x32x16_bf16 v[124:139], v[204:207], v[36:39], 0
    v_mfma_f32_32x32x16_bf16 v[124:139], v[208:211], v[40:43], v[124:139]
    s_nop 9
    v_max3_f32 v222, v108, v109, v110
    s_nop 0
    v_max3_f32 v223, v124, v125, v126
    v_max3_f32 v222, v222, v111, v112
    v_max3_f32 v223, v223, v127, v128
    v_max3_f32 v222, v222, v113, v114
    v_max3_f32 v223, v223, v129, v130
    v_max3_f32 v222, v222, v115, v116
    v_max3_f32 v223, v223, v131, v132
    v_max3_f32 v222, v222, v117, v118
    v_max3_f32 v223, v223, v133, v134
    v_max3_f32 v222, v222, v119, v120
    v_max3_f32 v223, v223, v135, v136
    v_max3_f32 v222, v222, v121, v122
    v_max3_f32 v223, v223, v137, v138
    v_max_f32 v222, v222, v123
    v_max_f32 v223, v223, v139
    v_mov_b32 v3, v220
    s_nop 1
    v_permlane32_swap_b32 v220, v3
    v_max_f32 v220, v220, v3
    v_mov_b32 v3, v221
    s_nop 1
    v_permlane32_swap_b32 v221, v3
    v_max_f32 v221, v221, v3
    v_mov_b32 v3, v222
    s_nop 1
    v_permlane32_swap_b32 v222, v3
    v_max_f32 v222, v222, v3
    v_mov_b32 v3, v223
    s_nop 1
    v_permlane32_swap_b32 v223, v3
    v_max_f32 v223, v223, v3
    v_add_f32 v220, 0x42800000, v220
    v_add_f32 v221, 0x42800000, v221
    v_add_f32 v222, 0x42800000, v222
    v_add_f32 v223, 0x42800000, v223
    buffer_load_dwordx4 v[172:175], v2, s[8:11], s35 offen offset:0
    buffer_load_dwordx4 v[176:179], v2, s[8:11], s35 offen offset:1024
    buffer_load_dwordx4 v[180:183], v2, s[8:11], s35 offen offset:2048
    buffer_load_dwordx4 v[184:187], v2, s[8:11], s35 offen offset:3072
    s_add_u32 s35, s35, 4096
    buffer_load_dwordx4 v[188:191], v2, s[8:11], s35 offen offset:0
    buffer_load_dwordx4 v[192:195], v2, s[8:11], s35 offen offset:1024
    buffer_load_dwordx4 v[196:199], v2, s[8:11], s35 offen offset:2048
    buffer_load_dwordx4 v[200:203], v2, s[8:11], s35 offen offset:3072
    s_add_u32 s35, s35, 4096
    s_mov_b32 exec_lo, 0x0
    s_mov_b32 exec_hi, 0xffffffff
    v_cvt_pk_bf16_f32 v18, -v220, 0
    v_cvt_pk_bf16_f32 v26, -v221, 0
    v_cvt_pk_bf16_f32 v34, -v222, 0
    v_cvt_pk_bf16_f32 v42, -v223, 0
    s_mov_b64 exec, -1
    s_setprio 1
    s_branch p2_A_go
p2_A_redo:
    s_mov_b32 s35, s36
    buffer_load_dwordx4 v[156:159], v2, s[8:11], s35 offen offset:0
    buffer_load_dwordx4 v[160:163], v2, s[8:11], s35 offen offset:1024
    buffer_load_dwordx4 v[164:167], v2, s[8:11], s35 offen offset:2048
    buffer_load_dwordx4 v[168:171], v2, s[8:11], s35 offen offset:3072
    s_add_u32 s35, s35, 4096
    buffer_load_dwordx4 v[172:175], v2, s[8:11], s35 offen offset:0
    buffer_load_dwordx4 v[176:179], v2, s[8:11], s35 offen offset:1024
    buffer_load_dwordx4 v[180:183], v2, s[8:11], s35 offen offset:2048
    buffer_load_dwordx4 v[184:187], v2, s[8:11], s35 offen offset:3072
    s_add_u32 s35, s35, 4096
    buffer_load_dwordx4 v[188:191], v2, s[8:11], s35 offen offset:0
    buffer_load_dwordx4 v[192:195], v2, s[8:11], s35 offen offset:1024
    buffer_load_dwordx4 v[196:199], v2, s[8:11], s35 offen offset:2048
    buffer_load_dwordx4 v[200:203], v2, s[8:11], s35 offen offset:3072
    s_add_u32 s35, s35, 4096
    v_mov_b32 v44, 0
    v_mov_b32 v45, 0
    v_mov_b32 v46, 0
    v_mov_b32 v47, 0
    v_mov_b32 v48, 0
    v_mov_b32 v49, 0
    v_mov_b32 v50, 0
    v_mov_b32 v51, 0
    v_mov_b32 v52, 0
    v_mov_b32 v53, 0
    v_mov_b32 v54, 0
    v_mov_b32 v55, 0
    v_mov_b32 v56, 0
    v_mov_b32 v57, 0
    v_mov_b32 v58, 0
    v_mov_b32 v59, 0
    v_mov_b32 v60, 0
    v_mov_b32 v61, 0
    v_mov_b32 v62, 0
    v_mov_b32 v63, 0
    v_mov_b32 v64, 0
    v_mov_b32 v65, 0
    v_mov_b32 v66, 0
    v_mov_b32 v67, 0
    v_mov_b32 v68, 0
    v_mov_b32 v69, 0
    v_mov_b32 v70, 0
    v_mov_b32 v71, 0
    v_mov_b32 v72, 0
    v_mov_b32 v73, 0
    v_mov_b32 v74, 0
    v_mov_b32 v75, 0
    v_mov_b32 v76, 0
    v_mov_b32 v77, 0
    v_mov_b32 v78, 0
    v_mov_b32 v79, 0
    v_mov_b32 v80, 0
    v_mov_b32 v81, 0
    v_mov_b32 v82, 0
    v_mov_b32 v83, 0
    v_mov_b32 v84, 0
    v_mov_b32 v85, 0
    v_mov_b32 v86, 0
    v_mov_b32 v87, 0
    v_mov_b32 v88, 0
    v_mov_b32 v89, 0
    v_mov_b32 v90, 0
    v_mov_b32 v91, 0
    v_mov_b32 v92, 0
    v_mov_b32 v93, 0
    v_mov_b32 v94, 0
    v_mov_b32 v95, 0
    v_mov_b32 v96, 0
    v_mov_b32 v97, 0
    v_mov_b32 v98, 0
    v_mov_b32 v99, 0
    v_mov_b32 v100, 0
    v_mov_b32 v101, 0
    v_mov_b32 v102, 0
    v_mov_b32 v103, 0
    v_mov_b32 v104, 0
    v_mov_b32 v105, 0
    v_mov_b32 v106, 0
    v_mov_b32 v107, 0
p2_A_go:
    v_mov_b32 v152, 0
    v_mov_b32 v216, 0
    v_mov_b32 v153, 0
    v_mov_b32 v217, 0
    v_mov_b32 v154, 0
    v_mov_b32 v218, 0
    v_mov_b32 v155, 0
    v_mov_b32 v219, 0
    s_mov_b32 s37, 0
    s_waitcnt vmcnt(8)
    v_mfma_f32_32x32x16_bf16 v[108:123], v[156:159], v[12:15], 0
    v_mfma_f32_32x32x16_bf16 v[108:123], v[160:163], v[16:19], v[108:123]
    s_nop 11
p2_A_loop:
    v_mfma_f32_32x32x16_bf16 v[124:139], v[156:159], v[20:23], 0
    v_exp_f32 v108, v108
    v_exp_f32 v109, v109
    v_exp_f32 v110, v110
    v_exp_f32 v111, v111
    v_mfma_f32_32x32x16_bf16 v[92:107], v[216:219], v[152:155], v[92:107]
    buffer_load_dwordx4 v[204:207], v2, s[8:11], s35 offen offset:0
    buffer_load_dwordx4 v[208:211], v2, s[8:11], s35 offen offset:1024
    buffer_load_dwordx4 v[212:215], v2, s[8:11], s35 offen offset:2048
    buffer_load_dwordx4 v[216:219], v2, s[8:11], s35 offen offset:3072
    s_add_u32 s35, s35, 4096
    v_exp_f32 v112, v112
    v_exp_f32 v113, v113
    v_exp_f32 v114, v114
    v_exp_f32 v115, v115
    v_mfma_f32_32x32x16_bf16 v[124:139], v[160:163], v[24:27], v[124:139]
    v_cvt_pk_bf16_f32 v140, v108, v109
    v_cvt_pk_bf16_f32 v141, v110, v111
    v_exp_f32 v116, v116
    v_exp_f32 v117, v117
    v_cvt_pk_bf16_f32 v142, v112, v113
    v_cvt_pk_bf16_f32 v143, v114, v115
    v_exp_f32 v118, v118
    v_exp_f32 v119, v119
    v_mfma_f32_32x32x16_bf16 v[44:59], v[164:167], v[140:143], v[44:59]
    v_exp_f32 v120, v120
    v_exp_f32 v121, v121
    v_exp_f32 v122, v122
    v_exp_f32 v123, v123
    v_cvt_pk_bf16_f32 v144, v116, v117
    v_cvt_pk_bf16_f32 v145, v118, v119
    v_cvt_pk_bf16_f32 v146, v120, v121
    v_cvt_pk_bf16_f32 v147, v122, v123
    v_mfma_f32_32x32x16_bf16 v[108:123], v[156:159], v[28:31], 0
    v_exp_f32 v124, v124
    v_exp_f32 v125, v125
    v_exp_f32 v126, v126
    v_exp_f32 v127, v127
    v_mfma_f32_32x32x16_bf16 v[44:59], v[168:171], v[144:147], v[44:59]
    v_exp_f32 v128, v128
    v_exp_f32 v129, v129
    v_exp_f32 v130, v130
    v_exp_f32 v131, v131
    v_mfma_f32_32x32x16_bf16 v[108:123], v[160:163], v[32:35], v[108:123]
    v_cvt_pk_bf16_f32 v148, v124, v125
    v_cvt_pk_bf16_f32 v149, v126, v127
    v_exp_f32 v132, v132
    v_exp_f32 v133, v133
    v_cvt_pk_bf16_f32 v150, v128, v129
    v_cvt_pk_bf16_f32 v151, v130, v131
    v_exp_f32 v134, v134
    v_exp_f32 v135, v135
    v_mfma_f32_32x32x16_bf16 v[60:75], v[164:167], v[148:151], v[60:75]
    v_exp_f32 v136, v136
    v_exp_f32 v137, v137
    v_exp_f32 v138, v138
    v_exp_f32 v139, v139
    v_cvt_pk_bf16_f32 v152, v132, v133
    v_cvt_pk_bf16_f32 v153, v134, v135
    v_cvt_pk_bf16_f32 v154, v136, v137
    v_cvt_pk_bf16_f32 v155, v138, v139
    v_mfma_f32_32x32x16_bf16 v[124:139], v[156:159], v[36:39], 0
    v_exp_f32 v108, v108
    v_exp_f32 v109, v109
    v_exp_f32 v110, v110
    v_exp_f32 v111, v111
    v_mfma_f32_32x32x16_bf16 v[60:75], v[168:171], v[152:155], v[60:75]
    v_exp_f32 v112, v112
    v_exp_f32 v113, v113
    v_exp_f32 v114, v114
    v_exp_f32 v115, v115
    v_mfma_f32_32x32x16_bf16 v[124:139], v[160:163], v[40:43], v[124:139]
    v_cvt_pk_bf16_f32 v140, v108, v109
    v_cvt_pk_bf16_f32 v141, v110, v111
    v_exp_f32 v116, v116
    v_exp_f32 v117, v117
    v_cvt_pk_bf16_f32 v142, v112, v113
    v_cvt_pk_bf16_f32 v143, v114, v115
    v_exp_f32 v118, v118
    v_exp_f32 v119, v119
    v_mfma_f32_32x32x16_bf16 v[76:91], v[164:167], v[140:143], v[76:91]
    v_exp_f32 v120, v120
    v_exp_f32 v121, v121
    v_exp_f32 v122, v122
    v_exp_f32 v123, v123
    v_cvt_pk_bf16_f32 v144, v116, v117
    v_cvt_pk_bf16_f32 v145, v118, v119
    v_cvt_pk_bf16_f32 v146, v120, v121
    v_cvt_pk_bf16_f32 v147, v122, v123
    s_waitcnt vmcnt(8)
    v_mfma_f32_32x32x16_bf16 v[108:123], v[172:175], v[12:15], 0
    v_exp_f32 v124, v124
    v_exp_f32 v125, v125
    v_exp_f32 v126, v126
    v_exp_f32 v127, v127
    v_mfma_f32_32x32x16_bf16 v[76:91], v[168:171], v[144:147], v[76:91]
    v_exp_f32 v128, v128
    v_exp_f32 v129, v129
    v_exp_f32 v130, v130
    v_exp_f32 v131, v131
    v_mfma_f32_32x32x16_bf16 v[108:123], v[176:179], v[16:19], v[108:123]
    v_cvt_pk_bf16_f32 v148, v124, v125
    v_cvt_pk_bf16_f32 v149, v126, v127
    v_exp_f32 v132, v132
    v_exp_f32 v133, v133
    v_cvt_pk_bf16_f32 v150, v128, v129
    v_cvt_pk_bf16_f32 v151, v130, v131
    v_exp_f32 v134, v134
    v_exp_f32 v135, v135
    v_mfma_f32_32x32x16_bf16 v[92:107], v[164:167], v[148:151], v[92:107]
    v_exp_f32 v136, v136
    v_exp_f32 v137, v137
    v_exp_f32 v138, v138
    v_exp_f32 v139, v139
    v_cvt_pk_bf16_f32 v152, v132, v133
    v_cvt_pk_bf16_f32 v153, v134, v135
    v_cvt_pk_bf16_f32 v154, v136, v137
    v_cvt_pk_bf16_f32 v155, v138, v139
    v_mfma_f32_32x32x16_bf16 v[124:139], v[172:175], v[20:23], 0
    v_exp_f32 v108, v108
    v_exp_f32 v109, v109
    v_exp_f32 v110, v110
    v_exp_f32 v111, v111
    v_mfma_f32_32x32x16_bf16 v[92:107], v[168:171], v[152:155], v[92:107]
    s_cmp_eq_u32 s37, 3
    s_cbranch_scc1 p2_k1
    buffer_load_dwordx4 v[156:159], v2, s[8:11], s35 offen offset:0
    buffer_load_dwordx4 v[160:163], v2, s[8:11], s35 offen offset:1024
    buffer_load_dwordx4 v[164:167], v2, s[8:11], s35 offen offset:2048
    buffer_load_dwordx4 v[168:171], v2, s[8:11], s35 offen offset:3072
    s_add_u32 s35, s35, 4096
p2_k1:
    v_exp_f32 v112, v112
    v_exp_f32 v113, v113
    v_exp_f32 v114, v114
    v_exp_f32 v115, v115
    v_mfma_f32_32x32x16_bf16 v[124:139], v[176:179], v[24:27], v[124:139]
    v_cvt_pk_bf16_f32 v140, v108, v109
    v_cvt_pk_bf16_f32 v141, v110, v111
    v_exp_f32 v116, v116
    v_exp_f32 v117, v117
    v_cvt_pk_bf16_f32 v142, v112, v113
    v_cvt_pk_bf16_f32 v143, v114, v115
    v_exp_f32 v118, v118
    v_exp_f32 v119, v119
    v_mfma_f32_32x32x16_bf16 v[44:59], v[180:183], v[140:143], v[44:59]
    v_exp_f32 v120, v120
    v_exp_f32 v121, v121
    v_exp_f32 v122, v122
    v_exp_f32 v123, v123
    v_cvt_pk_bf16_f32 v144, v116, v117
    v_cvt_pk_bf16_f32 v145, v118, v119
    v_cvt_pk_bf16_f32 v146, v120, v121
    v_cvt_pk_bf16_f32 v147, v122, v123
    v_mfma_f32_32x32x16_bf16 v[108:123], v[172:175], v[28:31], 0
    v_exp_f32 v124, v124
    v_exp_f32 v125, v125
    v_exp_f32 v126, v126
    v_exp_f32 v127, v127
    v_mfma_f32_32x32x16_bf16 v[44:59], v[184:187], v[144:147], v[44:59]
    v_exp_f32 v128, v128
    v_exp_f32 v129, v129
    v_exp_f32 v130, v130
    v_exp_f32 v131, v131
    v_mfma_f32_32x32x16_bf16 v[108:123], v[176:179], v[32:35], v[108:123]
    v_cvt_pk_bf16_f32 v148, v124, v125
    v_cvt_pk_bf16_f32 v149, v126, v127
    v_exp_f32 v132, v132
    v_exp_f32 v133, v133
    v_cvt_pk_bf16_f32 v150, v128, v129
    v_cvt_pk_bf16_f32 v151, v130, v131
    v_exp_f32 v134, v134
    v_exp_f32 v135, v135
    v_mfma_f32_32x32x16_bf16 v[60:75], v[180:183], v[148:151], v[60:75]
    v_exp_f32 v136, v136
    v_exp_f32 v137, v137
    v_exp_f32 v138, v138
    v_exp_f32 v139, v139
    v_cvt_pk_bf16_f32 v152, v132, v133
    v_cvt_pk_bf16_f32 v153, v134, v135
    v_cvt_pk_bf16_f32 v154, v136, v137
    v_cvt_pk_bf16_f32 v155, v138, v139
    v_mfma_f32_32x32x16_bf16 v[124:139], v[172:175], v[36:39], 0
    v_exp_f32 v108, v108
    v_exp_f32 v109, v109
    v_exp_f32 v110, v110
    v_exp_f32 v111, v111
    v_mfma_f32_32x32x16_bf16 v[60:75], v[184:187], v[152:155], v[60:75]
    v_exp_f32 v112, v112
    v_exp_f32 v113, v113
    v_exp_f32 v114, v114
    v_exp_f32 v115, v115
    v_mfma_f32_32x32x16_bf16 v[124:139], v[176:179], v[40:43], v[124:139]
    v_cvt_pk_bf16_f32 v140, v108, v109
    v_cvt_pk_bf16_f32 v141, v110, v111
    v_exp_f32 v116, v116
    v_exp_f32 v117, v117
    v_cvt_pk_bf16_f32 v142, v112, v113
    v_cvt_pk_bf16_f32 v143, v114, v115
    v_exp_f32 v118, v118
    v_exp_f32 v119, v119
    v_mfma_f32_32x32x16_bf16 v[76:91], v[180:183], v[140:143], v[76:91]
    v_exp_f32 v120, v120
    v_exp_f32 v121, v121
    v_exp_f32 v122, v122
    v_exp_f32 v123, v123
    v_cvt_pk_bf16_f32 v144, v116, v117
    v_cvt_pk_bf16_f32 v145, v118, v119
    v_cvt_pk_bf16_f32 v146, v120, v121
    v_cvt_pk_bf16_f32 v147, v122, v123
    s_cmp_eq_u32 s37, 3
    s_cbranch_scc1 p2_w2_l
    s_waitcnt vmcnt(8)
p2_w2_e:
    v_mfma_f32_32x32x16_bf16 v[108:123], v[188:191], v[12:15], 0
    v_exp_f32 v124, v124
    v_exp_f32 v125, v125
    v_exp_f32 v126, v126
    v_exp_f32 v127, v127
    v_mfma_f32_32x32x16_bf16 v[76:91], v[184:187], v[144:147], v[76:91]
    v_exp_f32 v128, v128
    v_exp_f32 v129, v129
    v_exp_f32 v130, v130
    v_exp_f32 v131, v131
    v_mfma_f32_32x32x16_bf16 v[108:123], v[192:195], v[16:19], v[108:123]
    v_cvt_pk_bf16_f32 v148, v124, v125
    v_cvt_pk_bf16_f32 v149, v126, v127
    v_exp_f32 v132, v132
    v_exp_f32 v133, v133
    v_cvt_pk_bf16_f32 v150, v128, v129
    v_cvt_pk_bf16_f32 v151, v130, v131
    v_exp_f32 v134, v134
    v_exp_f32 v135, v135
    v_mfma_f32_32x32x16_bf16 v[92:107], v[180:183], v[148:151], v[92:107]
    v_exp_f32 v136, v136
    v_exp_f32 v137, v137
    v_exp_f32 v138, v138
    v_exp_f32 v139, v139
    v_cvt_pk_bf16_f32 v152, v132, v133
    v_cvt_pk_bf16_f32 v153, v134, v135
    v_cvt_pk_bf16_f32 v154, v136, v137
    v_cvt_pk_bf16_f32 v155, v138, v139
    v_mfma_f32_32x32x16_bf16 v[124:139], v[188:191], v[20:23], 0
    v_exp_f32 v108, v108
    v_exp_f32 v109, v109
    v_exp_f32 v110, v110
    v_exp_f32 v111, v111
    v_mfma_f32_32x32x16_bf16 v[92:107], v[184:187], v[152:155], v[92:107]
    s_cmp_eq_u32 s37, 3
    s_cbranch_scc1 p2_k3
    buffer_load_dwordx4 v[172:175], v2, s[8:11], s35 offen offset:0
    buffer_load_dwordx4 v[176:179], v2, s[8:11], s35 offen offset:1024
    buffer_load_dwordx4 v[180:183], v2, s[8:11], s35 offen offset:2048
    buffer_load_dwordx4 v[184:187], v2, s[8:11], s35 offen offset:3072
    s_add_u32 s35, s35, 4096
p2_k3:
    v_exp_f32 v112, v112
    v_exp_f32 v113, v113
    v_exp_f32 v114, v114
    v_exp_f32 v115, v115
    v_mfma_f32_32x32x16_bf16 v[124:139], v[192:195], v[24:27], v[124:139]
    v_cvt_pk_bf16_f32 v140, v108, v109
    v_cvt_pk_bf16_f32 v141, v110, v111
    v_exp_f32 v116, v116
    v_exp_f32 v117, v117
    v_cvt_pk_bf16_f32 v142, v112, v113
    v_cvt_pk_bf16_f32 v143, v114, v115
    v_exp_f32 v118, v118
    v_exp_f32 v119, v119
    v_mfma_f32_32x32x16_bf16 v[44:59], v[196:199], v[140:143], v[44:59]
    v_exp_f32 v120, v120
    v_exp_f32 v121, v121
    v_exp_f32 v122, v122
    v_exp_f32 v123, v123
    v_cvt_pk_bf16_f32 v144, v116, v117
    v_cvt_pk_bf16_f32 v145, v118, v119
    v_cvt_pk_bf16_f32 v146, v120, v121
    v_cvt_pk_bf16_f32 v147, v122, v123
    v_mfma_f32_32x32x16_bf16 v[108:123], v[188:191], v[28:31], 0
    v_exp_f32 v124, v124
    v_exp_f32 v125, v125
    v_exp_f32 v126, v126
    v_exp_f32 v127, v127
    v_mfma_f32_32x32x16_bf16 v[44:59], v[200:203], v[144:147], v[44:59]
    v_exp_f32 v128, v128
    v_exp_f32 v129, v129
    v_exp_f32 v130, v130
    v_exp_f32 v131, v131
    v_mfma_f32_32x32x16_bf16 v[108:123], v[192:195], v[32:35], v[108:123]
    v_cvt_pk_bf16_f32 v148, v124, v125
    v_cvt_pk_bf16_f32 v149, v126, v127
    v_exp_f32 v132, v132
    v_exp_f32 v133, v133
    v_cvt_pk_bf16_f32 v150, v128, v129
    v_cvt_pk_bf16_f32 v151, v130, v131
    v_exp_f32 v134, v134
    v_exp_f32 v135, v135
    v_mfma_f32_32x32x16_bf16 v[60:75], v[196:199], v[148:151], v[60:75]
    v_exp_f32 v136, v136
    v_exp_f32 v137, v137
    v_exp_f32 v138, v138
    v_exp_f32 v139, v139
    v_cvt_pk_bf16_f32 v152, v132, v133
    v_cvt_pk_bf16_f32 v153, v134, v135
    v_cvt_pk_bf16_f32 v154, v136, v137
    v_cvt_pk_bf16_f32 v155, v138, v139
    v_mfma_f32_32x32x16_bf16 v[124:139], v[188:191], v[36:39], 0
    v_exp_f32 v108, v108
    v_exp_f32 v109, v109
    v_exp_f32 v110, v110
    v_exp_f32 v111, v111
    v_mfma_f32_32x32x16_bf16 v[60:75], v[200:203], v[152:155], v[60:75]
    v_exp_f32 v112, v112
    v_exp_f32 v113, v113
    v_exp_f32 v114, v114
    v_exp_f32 v115, v115
    v_mfma_f32_32x32x16_bf16 v[124:139], v[192:195], v[40:43], v[124:139]
    v_cvt_pk_bf16_f32 v140, v108, v109
    v_cvt_pk_bf16_f32 v141, v110, v111
    v_exp_f32 v116, v116
    v_exp_f32 v117, v117
    v_cvt_pk_bf16_f32 v142, v112, v113
    v_cvt_pk_bf16_f32 v143, v114, v115
    v_exp_f32 v118, v118
    v_exp_f32 v119, v119
    v_mfma_f32_32x32x16_bf16 v[76:91], v[196:199], v[140:143], v[76:91]
    v_exp_f32 v120, v120
    v_exp_f32 v121, v121
    v_exp_f32 v122, v122
    v_exp_f32 v123, v123
    v_cvt_pk_bf16_f32 v144, v116, v117
    v_cvt_pk_bf16_f32 v145, v118, v119
    v_cvt_pk_bf16_f32 v146, v120, v121
    v_cvt_pk_bf16_f32 v147, v122, v123
    s_cmp_eq_u32 s37, 3
    s_cbranch_scc1 p2_w4_l
    s_waitcnt vmcnt(8)
p2_w4_e:
    v_mfma_f32_32x32x16_bf16 v[108:123], v[204:207], v[12:15], 0
    v_exp_f32 v124, v124
    v_exp_f32 v125, v125
    v_exp_f32 v126, v126
    v_exp_f32 v127, v127
    v_mfma_f32_32x32x16_bf16 v[76:91], v[200:203], v[144:147], v[76:91]
    v_exp_f32 v128, v128
    v_exp_f32 v129, v129
    v_exp_f32 v130, v130
    v_exp_f32 v131, v131
    v_mfma_f32_32x32x16_bf16 v[108:123], v[208:211], v[16:19], v[108:123]
    v_cvt_pk_bf16_f32 v148, v124, v125
    v_cvt_pk_bf16_f32 v149, v126, v127
    v_exp_f32 v132, v132
    v_exp_f32 v133, v133
    v_cvt_pk_bf16_f32 v150, v128, v129
    v_cvt_pk_bf16_f32 v151, v130, v131
    v_exp_f32 v134, v134
    v_exp_f32 v135, v135
    v_mfma_f32_32x32x16_bf16 v[92:107], v[196:199], v[148:151], v[92:107]
    v_exp_f32 v136, v136
    v_exp_f32 v137, v137
    v_exp_f32 v138, v138
    v_exp_f32 v139, v139
    v_cvt_pk_bf16_f32 v152, v132, v133
    v_cvt_pk_bf16_f32 v153, v134, v135
    v_cvt_pk_bf16_f32 v154, v136, v137
    v_cvt_pk_bf16_f32 v155, v138, v139
    v_mfma_f32_32x32x16_bf16 v[124:139], v[204:207], v[20:23], 0
    v_exp_f32 v108, v108
    v_exp_f32 v109, v109
    v_exp_f32 v110, v110
    v_exp_f32 v111, v111
    v_mfma_f32_32x32x16_bf16 v[92:107], v[200:203], v[152:155], v[92:107]
    s_cmp_eq_u32 s37, 3
    s_cbranch_scc1 p2_k5
    buffer_load_dwordx4 v[188:191], v2, s[8:11], s35 offen offset:0
    buffer_load_dwordx4 v[192:195], v2, s[8:11], s35 offen offset:1024
    buffer_load_dwordx4 v[196:199], v2, s[8:11], s35 offen offset:2048
    buffer_load_dwordx4 v[200:203], v2, s[8:11], s35 offen offset:3072
    s_add_u32 s35, s35, 4096
p2_k5:
    v_exp_f32 v112, v112
    v_exp_f32 v113, v113
    v_exp_f32 v114, v114
    v_exp_f32 v115, v115
    v_mfma_f32_32x32x16_bf16 v[124:139], v[208:211], v[24:27], v[124:139]
    v_cvt_pk_bf16_f32 v140, v108, v109
    v_cvt_pk_bf16_f32 v141, v110, v111
    v_exp_f32 v116, v116
    v_exp_f32 v117, v117
    v_cvt_pk_bf16_f32 v142, v112, v113
    v_cvt_pk_bf16_f32 v143, v114, v115
    v_exp_f32 v118, v118
    v_exp_f32 v119, v119
    v_mfma_f32_32x32x16_bf16 v[44:59], v[212:215], v[140:143], v[44:59]
    v_exp_f32 v120, v120
    v_exp_f32 v121, v121
    v_exp_f32 v122, v122
    v_exp_f32 v123, v123
    v_cvt_pk_bf16_f32 v144, v116, v117
    v_cvt_pk_bf16_f32 v145, v118, v119
    v_cvt_pk_bf16_f32 v146, v120, v121
    v_cvt_pk_bf16_f32 v147, v122, v123
    v_mfma_f32_32x32x16_bf16 v[108:123], v[204:207], v[28:31], 0
    v_exp_f32 v124, v124
    v_exp_f32 v125, v125
    v_exp_f32 v126, v126
    v_exp_f32 v127, v127
    v_mfma_f32_32x32x16_bf16 v[44:59], v[216:219], v[144:147], v[44:59]
    v_exp_f32 v128, v128
    v_exp_f32 v129, v129
    v_exp_f32 v130, v130
    v_exp_f32 v131, v131
    v_mfma_f32_32x32x16_bf16 v[108:123], v[208:211], v[32:35], v[108:123]
    v_cvt_pk_bf16_f32 v148, v124, v125
    v_cvt_pk_bf16_f32 v149, v126, v127
    v_exp_f32 v132, v132
    v_exp_f32 v133, v133
    v_cvt_pk_bf16_f32 v150, v128, v129
    v_cvt_pk_bf16_f32 v151, v130, v131
    v_exp_f32 v134, v134
    v_exp_f32 v135, v135
    v_mfma_f32_32x32x16_bf16 v[60:75], v[212:215], v[148:151], v[60:75]
    v_exp_f32 v136, v136
    v_exp_f32 v137, v137
    v_exp_f32 v138, v138
    v_exp_f32 v139, v139
    v_cvt_pk_bf16_f32 v152, v132, v133
    v_cvt_pk_bf16_f32 v153, v134, v135
    v_cvt_pk_bf16_f32 v154, v136, v137
    v_cvt_pk_bf16_f32 v155, v138, v139
    v_mfma_f32_32x32x16_bf16 v[124:139], v[204:207], v[36:39], 0
    v_exp_f32 v108, v108
    v_exp_f32 v109, v109
    v_exp_f32 v110, v110
    v_exp_f32 v111, v111
    v_mfma_f32_32x32x16_bf16 v[60:75], v[216:219], v[152:155], v[60:75]
    v_exp_f32 v112, v112
    v_exp_f32 v113, v113
    v_exp_f32 v114, v114
    v_exp_f32 v115, v115
    v_mfma_f32_32x32x16_bf16 v[124:139], v[208:211], v[40:43], v[124:139]
    v_cvt_pk_bf16_f32 v140, v108, v109
    v_cvt_pk_bf16_f32 v141, v110, v111
    v_exp_f32 v116, v116
    v_exp_f32 v117, v117
    v_cvt_pk_bf16_f32 v142, v112, v113
    v_cvt_pk_bf16_f32 v143, v114, v115
    v_exp_f32 v118, v118
    v_exp_f32 v119, v119
    v_mfma_f32_32x32x16_bf16 v[76:91], v[212:215], v[140:143], v[76:91]
    v_exp_f32 v120, v120
    v_exp_f32 v121, v121
    v_exp_f32 v122, v122
    v_exp_f32 v123, v123
    v_cvt_pk_bf16_f32 v144, v116, v117
    v_cvt_pk_bf16_f32 v145, v118, v119
    v_cvt_pk_bf16_f32 v146, v120, v121
    v_cvt_pk_bf16_f32 v147, v122, v123
    s_waitcnt vmcnt(8)
    v_mfma_f32_32x32x16_bf16 v[108:123], v[156:159], v[12:15], 0
    v_exp_f32 v124, v124
    v_exp_f32 v125, v125
    v_exp_f32 v126, v126
    v_exp_f32 v127, v127
    v_mfma_f32_32x32x16_bf16 v[76:91], v[216:219], v[144:147], v[76:91]
    v_exp_f32 v128, v128
    v_exp_f32 v129, v129
    v_exp_f32 v130, v130
    v_exp_f32 v131, v131
    v_mfma_f32_32x32x16_bf16 v[108:123], v[160:163], v[16:19], v[108:123]
    v_cvt_pk_bf16_f32 v148, v124, v125
    v_cvt_pk_bf16_f32 v149, v126, v127
    v_exp_f32 v132, v132
    v_exp_f32 v133, v133
    v_cvt_pk_bf16_f32 v150, v128, v129
    v_cvt_pk_bf16_f32 v151, v130, v131
    v_exp_f32 v134, v134
    v_exp_f32 v135, v135
    v_mfma_f32_32x32x16_bf16 v[92:107], v[212:215], v[148:151], v[92:107]
    v_exp_f32 v136, v136
    v_exp_f32 v137, v137
    v_exp_f32 v138, v138
    v_exp_f32 v139, v139
    v_cvt_pk_bf16_f32 v152, v132, v133
    v_cvt_pk_bf16_f32 v153, v134, v135
    v_cvt_pk_bf16_f32 v154, v136, v137
    v_cvt_pk_bf16_f32 v155, v138, v139
    s_add_u32 s37, s37, 1
    s_cmp_lt_u32 s37, 4
    s_cbranch_scc1 p2_A_loop
    v_mfma_f32_32x32x16_bf16 v[92:107], v[216:219], v[152:155], v[92:107]
    v_mov_b32 v108, 0x41000000
    v_mov_b32 v109, 0x41000000
    v_pk_mul_f32 v[220:221], v[44:45], v[108:109]
    v_pk_mul_f32 v[222:223], v[46:47], v[108:109]
    v_pk_fma_f32 v[220:221], v[48:49], v[108:109], v[220:221]
    v_pk_fma_f32 v[222:223], v[50:51], v[108:109], v[222:223]
    v_pk_fma_f32 v[220:221], v[52:53], v[108:109], v[220:221]
    v_pk_fma_f32 v[222:223], v[54:55], v[108:109], v[222:223]
    v_pk_fma_f32 v[220:221], v[56:57], v[108:109], v[220:221]
    v_pk_fma_f32 v[222:223], v[58:59], v[108:109], v[222:223]
    v_pk_fma_f32 v[220:221], v[60:61], v[108:109], v[220:221]
    v_pk_fma_f32 v[222:223], v[62:63], v[108:109], v[222:223]
    v_pk_fma_f32 v[220:221], v[64:65], v[108:109], v[220:221]
    v_pk_fma_f32 v[222:223], v[66:67], v[108:109], v[222:223]
    v_pk_fma_f32 v[220:221], v[68:69], v[108:109], v[220:221]
    v_pk_fma_f32 v[222:223], v[70:71], v[108:109], v[222:223]
    v_pk_fma_f32 v[220:221], v[72:73], v[108:109], v[220:221]
    v_pk_fma_f32 v[222:223], v[74:75], v[108:109], v[222:223]
    v_pk_fma_f32 v[220:221], v[76:77], v[108:109], v[220:221]
    v_pk_fma_f32 v[222:223], v[78:79], v[108:109], v[222:223]
    v_pk_fma_f32 v[220:221], v[80:81], v[108:109], v[220:221]
    v_pk_fma_f32 v[222:223], v[82:83], v[108:109], v[222:223]
    v_pk_fma_f32 v[220:221], v[84:85], v[108:109], v[220:221]
    v_pk_fma_f32 v[222:223], v[86:87], v[108:109], v[222:223]
    v_pk_fma_f32 v[220:221], v[88:89], v[108:109], v[220:221]
    v_pk_fma_f32 v[222:223], v[90:91], v[108:109], v[222:223]
    v_pk_fma_f32 v[220:221], v[92:93], v[108:109], v[220:221]
    v_pk_fma_f32 v[222:223], v[94:95], v[108:109], v[222:223]
    v_pk_fma_f32 v[220:221], v[96:97], v[108:109], v[220:221]
    v_pk_fma_f32 v[222:223], v[98:99], v[108:109], v[222:223]
    v_pk_fma_f32 v[220:221], v[100:101], v[108:109], v[220:221]
    v_pk_fma_f32 v[222:223], v[102:103], v[108:109], v[222:223]
    v_pk_fma_f32 v[220:221], v[104:105], v[108:109], v[220:221]
    v_pk_fma_f32 v[222:223], v[106:107], v[108:109], v[222:223]
    v_pk_add_f32 v[220:221], v[220:221], v[222:223]
    v_add_f32 v220, v220, v221
    v_and_b32 v220, 0x7fffffff, v220
    v_cmp_ngt_f32 vcc, s40, v220
    s_cmp_lg_u32 s20, 0
    s_cbranch_scc1 p2_nolow
    s_mov_b32 exec_lo, 0x0
    s_mov_b32 exec_hi, 0xffffffff
    v_min3_f32 v4, v56, v72, v88
    v_min_f32 v4, v4, v104
    s_mov_b32 s25, 0x0d800000
    v_cmp_nlt_f32 s[42:43], s25, v4
    s_mov_b64 exec, -1
    s_nop 2
    s_or_b64 vcc, vcc, s[42:43]
p2_nolow:
    s_nop 1
    s_cmp_lg_u64 vcc, 0
    s_cselect_b32 s24, 1, 0
    v_mov_b32 v4, s24
    s_lshl_b32 s25, s20, 2
    s_add_u32 s25, s25, 149504
    v_mov_b32 v5, s25
    ds_write_b32 v5, v4
    s_cmp_eq_u32 s20, 0
    s_cbranch_scc1 p2_dump0
    s_cmp_gt_u32 s20, 0
    s_cselect_b32 s24, 1, 0
    s_sub_u32 s24, s20, s24
    s_lshl_b32 s24, s24, 12
    s_add_u32 s24, s24, 98304
    v_add_u32 v4, s24, v2
    ds_write_b128 v4, v[44:47] offset:0
    ds_write_b128 v4, v[48:51] offset:1024
    ds_write_b128 v4, v[52:55] offset:2048
    ds_write_b128 v4, v[56:59] offset:3072
p2_dump0:
    s_cmp_eq_u32 s20, 1
    s_cbranch_scc1 p2_dump1
    s_cmp_gt_u32 s20, 1
    s_cselect_b32 s24, 1, 0
    s_sub_u32 s24, s20, s24
    s_lshl_b32 s24, s24, 12
    s_add_u32 s24, s24, 110592
    v_add_u32 v4, s24, v2
    ds_write_b128 v4, v[60:63] offset:0
    ds_write_b128 v4, v[64:67] offset:1024
    ds_write_b128 v4, v[68:71] offset:2048
    ds_write_b128 v4, v[72:75] offset:3072
p2_dump1:
    s_cmp_eq_u32 s20, 2
    s_cbranch_scc1 p2_dump2
    s_cmp_gt_u32 s20, 2
    s_cselect_b32 s24, 1, 0
    s_sub_u32 s24, s20, s24
    s_lshl_b32 s24, s24, 12
    s_add_u32 s24, s24, 122880
    v_add_u32 v4, s24, v2
    ds_write_b128 v4, v[76:79] offset:0
    ds_write_b128 v4, v[80:83] offset:1024
    ds_write_b128 v4, v[84:87] offset:2048
    ds_write_b128 v4, v[88:91] offset:3072
p2_dump2:
    s_cmp_eq_u32 s20, 3
    s_cbranch_scc1 p2_dump3
    s_cmp_gt_u32 s20, 3
    s_cselect_b32 s24, 1, 0
    s_sub_u32 s24, s20, s24
    s_lshl_b32 s24, s24, 12
    s_add_u32 s24, s24, 135168
    v_add_u32 v4, s24, v2
    ds_write_b128 v4, v[92:95] offset:0
    ds_write_b128 v4, v[96:99] offset:1024
    ds_write_b128 v4, v[100:103] offset:2048
    ds_write_b128 v4, v[104:107] offset:3072
p2_dump3:
    s_waitcnt lgkmcnt(0)
    s_mov_b32 exec_lo, 0x1
    s_mov_b32 exec_hi, 0x0
    ds_add_u32 v9, v10
    s_mov_b64 exec, -1
    s_add_u32 s27, s27, 4
    s_mov_b32 s28, 0
p2_sy6:
    ds_read_b32 v3, v9
    s_waitcnt lgkmcnt(0)
    v_readfirstlane_b32 s23, v3
    s_add_u32 s28, s28, 1
    s_cmp_ge_u32 s28, 0x200000
    s_cbranch_scc1 p2_sy6_x
    s_nop 0
    s_cmp_lt_u32 s23, s27
    s_cbranch_scc1 p2_sy6
p2_sy6_x:
    s_cmp_lg_u32 s38, 0
    s_cbranch_scc1 p2_A_fin
    v_mov_b32 v4, 149504
    ds_read_b128 v[220:223], v4
    s_waitcnt lgkmcnt(0)
    v_or_b32 v220, v220, v221
    v_or_b32 v222, v222, v223
    v_or_b32 v220, v220, v222
    s_nop 0
    v_readfirstlane_b32 s24, v220
    s_nop 3
    s_cmp_eq_u32 s24, 0
    s_cbranch_scc1 p2_A_fin
    s_mov_b32 s38, 1
    s_mov_b32 exec_lo, 0x0
    s_mov_b32 exec_hi, 0xffffffff
    v_mov_b32 v18, 0
    v_mov_b32 v19, 0
    v_mov_b32 v26, 0
    v_mov_b32 v27, 0
    v_mov_b32 v34, 0
    v_mov_b32 v35, 0
    v_mov_b32 v42, 0
    v_mov_b32 v43, 0
    s_mov_b64 exec, -1
    v_mov_b32 v220, 0xff800000
    v_mov_b32 v221, 0xff800000
    v_mov_b32 v222, 0xff800000
    v_mov_b32 v223, 0xff800000
    s_mov_b32 s35, s36
    s_mov_b32 s37, 0
p2_A_mx:
    buffer_load_dwordx4 v[156:159], v2, s[8:11], s35 offen offset:0
    buffer_load_dwordx4 v[160:163], v2, s[8:11], s35 offen offset:1024
    s_add_u32 s35, s35, 4096
    s_waitcnt vmcnt(0)
    v_mfma_f32_32x32x16_bf16 v[44:59], v[156:159], v[12:15], 0
    v_mfma_f32_32x32x16_bf16 v[44:59], v[160:163], v[16:19], v[44:59]
    v_mfma_f32_32x32x16_bf16 v[60:75], v[156:159], v[20:23], 0
    v_mfma_f32_32x32x16_bf16 v[60:75], v[160:163], v[24:27], v[60:75]
    v_mfma_f32_32x32x16_bf16 v[76:91], v[156:159], v[28:31], 0
    v_mfma_f32_32x32x16_bf16 v[76:91], v[160:163], v[32:35], v[76:91]
    v_mfma_f32_32x32x16_bf16 v[92:107], v[156:159], v[36:39], 0
    v_mfma_f32_32x32x16_bf16 v[92:107], v[160:163], v[40:43], v[92:107]
    s_nop 5
    v_max3_f32 v220, v220, v44, v45
    v_max3_f32 v220, v220, v46, v47
    v_max3_f32 v220, v220, v48, v49
    v_max3_f32 v220, v220, v50, v51
    v_max3_f32 v220, v220, v52, v53
    v_max3_f32 v220, v220, v54, v55
    v_max3_f32 v220, v220, v56, v57
    v_max3_f32 v220, v220, v58, v59
    v_max3_f32 v221, v221, v60, v61
    v_max3_f32 v221, v221, v62, v63
    v_max3_f32 v221, v221, v64, v65
    v_max3_f32 v221, v221, v66, v67
    v_max3_f32 v221, v221, v68, v69
    v_max3_f32 v221, v221, v70, v71
    v_max3_f32 v221, v221, v72, v73
    v_max3_f32 v221, v221, v74, v75
    v_max3_f32 v222, v222, v76, v77
    v_max3_f32 v222, v222, v78, v79
    v_max3_f32 v222, v222, v80, v81
    v_max3_f32 v222, v222, v82, v83
    v_max3_f32 v222, v222, v84, v85
    v_max3_f32 v222, v222, v86, v87
    v_max3_f32 v222, v222, v88, v89
    v_max3_f32 v222, v222, v90, v91
    v_max3_f32 v223, v223, v92, v93
    v_max3_f32 v223, v223, v94, v95
    v_max3_f32 v223, v223, v96, v97
    v_max3_f32 v223, v223, v98, v99
    v_max3_f32 v223, v223, v100, v101
    v_max3_f32 v223, v223, v102, v103
    v_max3_f32 v223, v223, v104, v105
    v_max3_f32 v223, v223, v106, v107
    s_add_u32 s37, s37, 1
    s_cmp_lt_u32 s37, 16
    s_cbranch_scc1 p2_A_mx
    v_and_b32 v7, 31, v1
    v_lshlrev_b32 v7, 2, v7
    v_add_u32 v7, 147456, v7
    s_lshl_b32 s24, s20, 9
    v_add_u32 v8, s24, v7
    v_mov_b32 v3, v220
    s_nop 1
    v_permlane32_swap_b32 v220, v3
    v_max_f32 v220, v220, v3
    ds_write_b32 v8, v220 offset:0
    v_mov_b32 v3, v221
    s_nop 1
    v_permlane32_swap_b32 v221, v3
    v_max_f32 v221, v221, v3
    ds_write_b32 v8, v221 offset:128
    v_mov_b32 v3, v222
    s_nop 1
    v_permlane32_swap_b32 v222, v3
    v_max_f32 v222, v222, v3
    ds_write_b32 v8, v222 offset:256
    v_mov_b32 v3, v223
    s_nop 1
    v_permlane32_swap_b32 v223, v3
    v_max_f32 v223, v223, v3
    ds_write_b32 v8, v223 offset:384
    s_waitcnt lgkmcnt(0)
    s_mov_b32 exec_lo, 0x1
    s_mov_b32 exec_hi, 0x0
    ds_add_u32 v9, v10
    s_mov_b64 exec, -1
    s_add_u32 s27, s27, 4
    s_mov_b32 s28, 0
p2_sy7:
    ds_read_b32 v3, v9
    s_waitcnt lgkmcnt(0)
    v_readfirstlane_b32 s23, v3
    s_add_u32 s28, s28, 1
    s_cmp_ge_u32 s28, 0x200000
    s_cbranch_scc1 p2_sy7_x
    s_nop 0
    s_cmp_lt_u32 s23, s27
    s_cbranch_scc1 p2_sy7
p2_sy7_x:
    ds_read_b32 v108, v7 offset:0
    ds_read_b32 v109, v7 offset:512
    ds_read_b32 v110, v7 offset:1024
    ds_read_b32 v111, v7 offset:1536
    ds_read_b32 v112, v7 offset:128
    ds_read_b32 v113, v7 offset:640
    ds_read_b32 v114, v7 offset:1152
    ds_read_b32 v115, v7 offset:1664
    ds_read_b32 v116, v7 offset:256
    ds_read_b32 v117, v7 offset:768
    ds_read_b32 v118, v7 offset:1280
    ds_read_b32 v119, v7 offset:1792
    ds_read_b32 v120, v7 offset:384
    ds_read_b32 v121, v7 offset:896
    ds_read_b32 v122, v7 offset:1408
    ds_read_b32 v123, v7 offset:1920
    s_waitcnt lgkmcnt(0)
    v_max3_f32 v220, v108, v109, v110
    v_max_f32 v220, v220, v111
    v_sub_f32 v4, 0, v220
    v_cvt_pk_bf16_f32 v5, v4, 0
    v_lshlrev_b32 v5, 16, v5
    v_sub_f32 v4, v4, v5
    v_cvt_pk_bf16_f32 v6, v4, 0
    v_lshlrev_b32 v6, 16, v6
    v_sub_f32 v4, v4, v6
    s_mov_b32 exec_lo, 0x0
    s_mov_b32 exec_hi, 0xffffffff
    v_cvt_pk_bf16_f32 v18, v5, v6
    v_cvt_pk_bf16_f32 v19, v4, 0
    s_mov_b64 exec, -1
    v_max3_f32 v221, v112, v113, v114
    v_max_f32 v221, v221, v115
    v_sub_f32 v4, 0, v221
    v_cvt_pk_bf16_f32 v5, v4, 0
    v_lshlrev_b32 v5, 16, v5
    v_sub_f32 v4, v4, v5
    v_cvt_pk_bf16_f32 v6, v4, 0
    v_lshlrev_b32 v6, 16, v6
    v_sub_f32 v4, v4, v6
    s_mov_b32 exec_lo, 0x0
    s_mov_b32 exec_hi, 0xffffffff
    v_cvt_pk_bf16_f32 v26, v5, v6
    v_cvt_pk_bf16_f32 v27, v4, 0
    s_mov_b64 exec, -1
    v_max3_f32 v222, v116, v117, v118
    v_max_f32 v222, v222, v119
    v_sub_f32 v4, 0, v222
    v_cvt_pk_bf16_f32 v5, v4, 0
    v_lshlrev_b32 v5, 16, v5
    v_sub_f32 v4, v4, v5
    v_cvt_pk_bf16_f32 v6, v4, 0
    v_lshlrev_b32 v6, 16, v6
    v_sub_f32 v4, v4, v6
    s_mov_b32 exec_lo, 0x0
    s_mov_b32 exec_hi, 0xffffffff
    v_cvt_pk_bf16_f32 v34, v5, v6
    v_cvt_pk_bf16_f32 v35, v4, 0
    s_mov_b64 exec, -1
    v_max3_f32 v223, v120, v121, v122
    v_max_f32 v223, v223, v123
    v_sub_f32 v4, 0, v223
    v_cvt_pk_bf16_f32 v5, v4, 0
    v_lshlrev_b32 v5, 16, v5
    v_sub_f32 v4, v4, v5
    v_cvt_pk_bf16_f32 v6, v4, 0
    v_lshlrev_b32 v6, 16, v6
    v_sub_f32 v4, v4, v6
    s_mov_b32 exec_lo, 0x0
    s_mov_b32 exec_hi, 0xffffffff
    v_cvt_pk_bf16_f32 v42, v5, v6
    v_cvt_pk_bf16_f32 v43, v4, 0
    s_mov_b64 exec, -1
    s_branch p2_A_redo
p2_A_fin:
    s_cmp_lg_u32 s20, 0
    s_cbranch_scc1 p2_own0
    v_mov_b32 v156, v44
    v_mov_b32 v157, v45
    v_mov_b32 v158, v46
    v_mov_b32 v159, v47
    v_mov_b32 v160, v48
    v_mov_b32 v161, v49
    v_mov_b32 v162, v50
    v_mov_b32 v163, v51
    v_mov_b32 v164, v52
    v_mov_b32 v165, v53
    v_mov_b32 v166, v54
    v_mov_b32 v167, v55
    v_mov_b32 v168, v56
    v_mov_b32 v169, v57
    v_mov_b32 v170, v58
    v_mov_b32 v171, v59
p2_own0:
    s_cmp_lg_u32 s20, 1
    s_cbranch_scc1 p2_own1
    v_mov_b32 v156, v60
    v_mov_b32 v157, v61
    v_mov_b32 v158, v62
    v_mov_b32 v159, v63
    v_mov_b32 v160, v64
    v_mov_b32 v161, v65
    v_mov_b32 v162, v66
    v_mov_b32 v163, v67
    v_mov_b32 v164, v68
    v_mov_b32 v165, v69
    v_mov_b32 v166, v70
    v_mov_b32 v167, v71
    v_mov_b32 v168, v72
    v_mov_b32 v169, v73
    v_mov_b32 v170, v74
    v_mov_b32 v171, v75
p2_own1:
    s_cmp_lg_u32 s20, 2
    s_cbranch_scc1 p2_own2
    v_mov_b32 v156, v76
    v_mov_b32 v157, v77
    v_mov_b32 v158, v78
    v_mov_b32 v159, v79
    v_mov_b32 v160, v80
    v_mov_b32 v161, v81
    v_mov_b32 v162, v82
    v_mov_b32 v163, v83
    v_mov_b32 v164, v84
    v_mov_b32 v165, v85
    v_mov_b32 v166, v86
    v_mov_b32 v167, v87
    v_mov_b32 v168, v88
    v_mov_b32 v169, v89
    v_mov_b32 v170, v90
    v_mov_b32 v171, v91
p2_own2:
    s_cmp_lg_u32 s20, 3
    s_cbranch_scc1 p2_own3
    v_mov_b32 v156, v92
    v_mov_b32 v157, v93
    v_mov_b32 v158, v94
    v_mov_b32 v159, v95
    v_mov_b32 v160, v96
    v_mov_b32 v161, v97
    v_mov_b32 v162, v98
    v_mov_b32 v163, v99
    v_mov_b32 v164, v100
    v_mov_b32 v165, v101
    v_mov_b32 v166, v102
    v_mov_b32 v167, v103
    v_mov_b32 v168, v104
    v_mov_b32 v169, v105
    v_mov_b32 v170, v106
    v_mov_b32 v171, v107
p2_own3:
    s_mul_i32 s24, s20, 12288
    s_add_u32 s24, s24, 98304
    v_add_u32 v4, s24, v2
    ds_read_b128 v[44:47], v4 offset:0
    ds_read_b128 v[48:51], v4 offset:1024
    ds_read_b128 v[52:55], v4 offset:2048
    ds_read_b128 v[56:59], v4 offset:3072
    ds_read_b128 v[60:63], v4 offset:4096
    ds_read_b128 v[64:67], v4 offset:5120
    ds_read_b128 v[68:71], v4 offset:6144
    ds_read_b128 v[72:75], v4 offset:7168
    ds_read_b128 v[76:79], v4 offset:8192
    ds_read_b128 v[80:83], v4 offset:9216
    ds_read_b128 v[84:87], v4 offset:10240
    ds_read_b128 v[88:91], v4 offset:11264
    s_waitcnt lgkmcnt(8)
    v_pk_add_f32 v[156:157], v[156:157], v[44:45]
    v_pk_add_f32 v[158:159], v[158:159], v[46:47]
    v_pk_add_f32 v[160:161], v[160:161], v[48:49]
    v_pk_add_f32 v[162:163], v[162:163], v[50:51]
    v_pk_add_f32 v[164:165], v[164:165], v[52:53]
    v_pk_add_f32 v[166:167], v[166:167], v[54:55]
    v_pk_add_f32 v[168:169], v[168:169], v[56:57]
    v_pk_add_f32 v[170:171], v[170:171], v[58:59]
    s_waitcnt lgkmcnt(4)
    v_pk_add_f32 v[156:157], v[156:157], v[60:61]
    v_pk_add_f32 v[158:159], v[158:159], v[62:63]
    v_pk_add_f32 v[160:161], v[160:161], v[64:65]
    v_pk_add_f32 v[162:163], v[162:163], v[66:67]
    v_pk_add_f32 v[164:165], v[164:165], v[68:69]
    v_pk_add_f32 v[166:167], v[166:167], v[70:71]
    v_pk_add_f32 v[168:169], v[168:169], v[72:73]
    v_pk_add_f32 v[170:171], v[170:171], v[74:75]
    s_waitcnt lgkmcnt(0)
    v_pk_add_f32 v[156:157], v[156:157], v[76:77]
    v_pk_add_f32 v[158:159], v[158:159], v[78:79]
    v_pk_add_f32 v[160:161], v[160:161], v[80:81]
    v_pk_add_f32 v[162:163], v[162:163], v[82:83]
    v_pk_add_f32 v[164:165], v[164:165], v[84:85]
    v_pk_add_f32 v[166:167], v[166:167], v[86:87]
    v_pk_add_f32 v[168:169], v[168:169], v[88:89]
    v_pk_add_f32 v[170:171], v[170:171], v[90:91]
    v_mov_b32 v4, v168
    v_mov_b32 v5, v168
    s_nop 1
    v_permlane32_swap_b32 v4, v5
    v_rcp_f32 v5, v5
    s_nop 0
    v_mul_f32 v156, v156, v5
    v_mul_f32 v157, v157, v5
    v_mul_f32 v158, v158, v5
    v_mul_f32 v159, v159, v5
    v_mul_f32 v160, v160, v5
    v_mul_f32 v161, v161, v5
    v_mul_f32 v162, v162, v5
    v_mul_f32 v163, v163, v5
    v_mul_f32 v164, v164, v5
    v_mul_f32 v165, v165, v5
    v_mul_f32 v166, v166, v5
    v_mul_f32 v167, v167, v5
    v_mul_f32 v168, v168, v5
    v_mul_f32 v169, v169, v5
    v_mul_f32 v170, v170, v5
    v_mul_f32 v171, v171, v5
    v_cvt_pk_bf16_f32 v108, v156, v157
    v_cvt_pk_bf16_f32 v109, v158, v159
    v_cvt_pk_bf16_f32 v110, v160, v161
    v_cvt_pk_bf16_f32 v111, v162, v163
    v_cvt_pk_bf16_f32 v112, v164, v165
    v_cvt_pk_bf16_f32 v113, v166, v167
    v_cvt_pk_bf16_f32 v114, v168, v169
    v_cvt_pk_bf16_f32 v115, v170, v171
    v_bfe_u32 v4, v1, 3, 1
    v_mul_u32_u24 v4, 43008, v4
    v_bfe_u32 v5, v1, 4, 1
    v_lshlrev_b32 v5, 3, v5
    v_and_b32 v6, 7, v1
    v_add_u32 v5, v5, v6
    v_lshl_add_u32 v4, v5, 4, v4
    v_lshrrev_b32 v5, 5, v1
    s_add_u32 s24, s39, s20
    s_mul_i32 s24, s24, 86016
    s_add_u32 s24, s24, 0xd00000
    s_mul_i32 s25, s32, 7
    s_and_b32 s26, s32, 1
    s_cmp_eq_u32 s26, 1
    s_cbranch_scc1 p2_o_odd
    s_add_u32 s26, s25, 0
    v_add_u32 v6, s26, v5
    v_lshrrev_b32 v7, 1, v6
    v_lshl_add_u32 v7, v7, 8, v4
    v_and_b32 v6, 1, v6
    v_lshl_add_u32 v7, v6, 3, v7
    buffer_store_dwordx2 v[108:109], v7, s[8:11], s24 offen sc1
    s_add_u32 s26, s25, 2
    v_add_u32 v6, s26, v5
    v_lshrrev_b32 v7, 1, v6
    v_lshl_add_u32 v7, v7, 8, v4
    v_and_b32 v6, 1, v6
    v_lshl_add_u32 v7, v6, 3, v7
    buffer_store_dwordx2 v[110:111], v7, s[8:11], s24 offen sc1
    s_add_u32 s26, s25, 4
    v_add_u32 v6, s26, v5
    v_lshrrev_b32 v7, 1, v6
    v_lshl_add_u32 v7, v7, 8, v4
    v_and_b32 v6, 1, v6
    v_lshl_add_u32 v7, v6, 3, v7
    buffer_store_dwordx2 v[112:113], v7, s[8:11], s24 offen sc1
    s_add_u32 s26, s25, 6
    v_add_u32 v6, s26, v5
    v_lshrrev_b32 v7, 1, v6
    v_lshl_add_u32 v7, v7, 8, v4
    v_and_b32 v6, 1, v6
    v_lshl_add_u32 v7, v6, 3, v7
    s_mov_b32 exec_lo, 0xffffffff
    s_mov_b32 exec_hi, 0x0
    buffer_store_dwordx2 v[114:115], v7, s[8:11], s24 offen sc1
    s_mov_b64 exec, -1
    s_branch p2_o_done
p2_o_odd:
    v_mov_b32 v142, v110
    v_mov_b32 v143, v111
    v_mov_b32 v144, v112
    v_mov_b32 v145, v113
    v_mov_b32 v146, v114
    v_mov_b32 v147, v115
    s_mov_b32 exec_lo, 0x0
    s_mov_b32 exec_hi, 0xffffffff
    v_mov_b32 v142, v108
    v_mov_b32 v143, v109
    v_mov_b32 v144, v110
    v_mov_b32 v145, v111
    v_mov_b32 v146, v112
    v_mov_b32 v147, v113
    s_mov_b64 exec, -1
    s_add_u32 s26, s25, 2
    v_sub_u32 v6, s26, v5
    v_lshrrev_b32 v7, 1, v6
    v_lshl_add_u32 v7, v7, 8, v4
    v_and_b32 v6, 1, v6
    v_lshl_add_u32 v7, v6, 3, v7
    buffer_store_dwordx2 v[142:143], v7, s[8:11], s24 offen sc1
    s_add_u32 s26, s25, 4
    v_sub_u32 v6, s26, v5
    v_lshrrev_b32 v7, 1, v6
    v_lshl_add_u32 v7, v7, 8, v4
    v_and_b32 v6, 1, v6
    v_lshl_add_u32 v7, v6, 3, v7
    buffer_store_dwordx2 v[144:145], v7, s[8:11], s24 offen sc1
    s_add_u32 s26, s25, 6
    v_sub_u32 v6, s26, v5
    v_lshrrev_b32 v7, 1, v6
    v_lshl_add_u32 v7, v7, 8, v4
    v_and_b32 v6, 1, v6
    v_lshl_add_u32 v7, v6, 3, v7
    buffer_store_dwordx2 v[146:147], v7, s[8:11], s24 offen sc1
    s_add_u32 s26, s25, 0
    v_add_u32 v6, s26, v5
    v_lshrrev_b32 v7, 1, v6
    v_lshl_add_u32 v7, v7, 8, v4
    v_and_b32 v6, 1, v6
    v_lshl_add_u32 v7, v6, 3, v7
    s_mov_b32 exec_lo, 0xffffffff
    s_mov_b32 exec_hi, 0x0
    buffer_store_dwordx2 v[108:109], v7, s[8:11], s24 offen sc1
    s_mov_b64 exec, -1
p2_o_done:
    s_mov_b64 exec, -1
    s_endpgm
p2_spatial:
    s_setprio 1
    v_mov_b32 v9, 149524
    s_sub_u32 s32, s20, 4
    s_lshr_b32 s23, s21, 1
    s_lshl_b32 s23, s23, 3
    s_lshr_b32 s24, s22, 2
    s_add_u32 s33, s23, s24
    s_and_b32 s23, s21, 1
    s_lshl_b32 s23, s23, 2
    s_and_b32 s24, s22, 3
    s_add_u32 s34, s23, s24
    s_mul_i32 s39, s32, 24576
    s_lshl_b32 s23, s34, 6
    s_lshl_b32 s24, s32, 4
    s_add_u32 s23, s23, s24
    s_mul_i32 s35, s23, 7168
    s_add_u32 s35, s35, 0x600000
    s_add_u32 s36, s35, 4096
    v_lshrrev_b32 v3, 3, v1
    v_lshlrev_b32 v3, 12, v3
    v_and_b32 v4, 7, v1
    v_bfe_u32 v5, v1, 4, 1
    v_xor_b32 v4, v4, v5
    v_xor_b32 v5, 0, v4
    v_lshl_add_u32 v212, v5, 4, v3
    v_xor_b32 v5, 2, v4
    v_lshl_add_u32 v213, v5, 4, v3
    v_add_u32 v213, 32768, v213
    v_xor_b32 v5, 4, v4
    v_lshl_add_u32 v214, v5, 4, v3
    v_add_u32 v214, 65536, v214
    v_xor_b32 v5, 6, v4
    v_lshl_add_u32 v215, v5, 4, v3
    v_add_u32 v215, 98304, v215
    s_lshl_b32 s37, s33, 18
    s_lshl_b32 s23, s32, 10
    s_add_u32 s37, s37, s23
    s_add_u32 s38, s37, 131072
    v_and_b32 v3, 15, v1
    v_lshrrev_b32 v4, 4, v1
    v_lshrrev_b32 v5, 2, v3
    v_and_b32 v6, 3, v3
    v_lshl_add_u32 v6, v5, 3, v6
    v_lshlrev_b32 v6, 7, v6
    v_lshlrev_b32 v5, 1, v5
    v_bfe_u32 v7, v3, 1, 1
    v_or_b32 v5, v5, v7
    v_xor_b32 v5, v5, v4
    v_lshl_add_u32 v6, v5, 4, v6
    v_add_u32 v216, s39, v6
    v_xor_b32 v217, 64, v216
    s_mov_b32 s41, s39
    s_add_u32 m0, s41, 0
    s_nop 0
    buffer_load_dwordx4 v212, s[12:15], s37 offen lds
    s_add_u32 m0, s41, 1024
    s_nop 0
    buffer_load_dwordx4 v213, s[12:15], s37 offen lds
    s_add_u32 m0, s41, 2048
    s_nop 0
    buffer_load_dwordx4 v214, s[12:15], s37 offen lds
    s_add_u32 m0, s41, 3072
    s_nop 0
    buffer_load_dwordx4 v215, s[12:15], s37 offen lds
    s_add_u32 m0, s41, 4096
    s_nop 0
    buffer_load_dwordx4 v212, s[12:15], s38 offen lds
    s_add_u32 m0, s41, 5120
    s_nop 0
    buffer_load_dwordx4 v213, s[12:15], s38 offen lds
    s_add_u32 m0, s41, 6144
    s_nop 0
    buffer_load_dwordx4 v214, s[12:15], s38 offen lds
    s_add_u32 m0, s41, 7168
    s_nop 0
    buffer_load_dwordx4 v215, s[12:15], s38 offen lds
    s_add_u32 s37, s37, 128
    s_add_u32 s38, s38, 128
    s_add_u32 s41, s41, 8192
    buffer_load_dwordx4 v[124:127], v2, s[8:11], s35 offen offset:0
    s_add_u32 m0, s41, 0
    s_nop 0
    buffer_load_dwordx4 v212, s[12:15], s37 offen lds
    s_add_u32 m0, s41, 1024
    s_nop 0
    buffer_load_dwordx4 v213, s[12:15], s37 offen lds
    buffer_load_dwordx4 v[128:131], v2, s[8:11], s35 offen offset:1024
    s_add_u32 m0, s41, 2048
    s_nop 0
    buffer_load_dwordx4 v214, s[12:15], s37 offen lds
    s_add_u32 m0, s41, 3072
    s_nop 0
    buffer_load_dwordx4 v215, s[12:15], s37 offen lds
    buffer_load_dwordx4 v[132:135], v2, s[8:11], s35 offen offset:2048
    s_add_u32 m0, s41, 4096
    s_nop 0
    buffer_load_dwordx4 v212, s[12:15], s38 offen lds
    s_add_u32 m0, s41, 5120
    s_nop 0
    buffer_load_dwordx4 v213, s[12:15], s38 offen lds
    buffer_load_dwordx4 v[136:139], v2, s[8:11], s35 offen offset:3072
    s_add_u32 m0, s41, 6144
    s_nop 0
    buffer_load_dwordx4 v214, s[12:15], s38 offen lds
    s_add_u32 m0, s41, 7168
    s_nop 0
    buffer_load_dwordx4 v215, s[12:15], s38 offen lds
    buffer_load_dwordx4 v[140:143], v2, s[8:11], s36 offen offset:0
    buffer_load_dwordx4 v[144:147], v2, s[8:11], s36 offen offset:1024
    buffer_load_dwordx4 v[148:151], v2, s[8:11], s36 offen offset:2048
    s_add_u32 s37, s37, 128
    s_add_u32 s38, s38, 128
    s_add_u32 s35, s35, 7168
    s_add_u32 s36, s36, 7168
    buffer_load_dwordx4 v[152:155], v2, s[8:11], s35 offen offset:0
    buffer_load_dwordx4 v[156:159], v2, s[8:11], s35 offen offset:1024
    buffer_load_dwordx4 v[160:163], v2, s[8:11], s35 offen offset:2048
    buffer_load_dwordx4 v[164:167], v2, s[8:11], s35 offen offset:3072
    buffer_load_dwordx4 v[168:171], v2, s[8:11], s36 offen offset:0
    buffer_load_dwordx4 v[172:175], v2, s[8:11], s36 offen offset:1024
    buffer_load_dwordx4 v[176:179], v2, s[8:11], s36 offen offset:2048
    s_add_u32 s35, s35, 7168
    s_add_u32 s36, s36, 7168
    s_add_u32 s41, s41, 8192
    s_mov_b32 s40, 0
    s_mov_b32 s42, 0
    v_mov_b32 v218, v216
    v_mov_b32 v219, v217
    s_setprio 0
    s_waitcnt vmcnt(22)
    ds_read_b128 v[180:183], v218 offset:0
    ds_read_b128 v[184:187], v218 offset:512
    ds_read_b128 v[188:191], v218 offset:4096
    ds_read_b128 v[192:195], v218 offset:4608
    s_waitcnt vmcnt(21)
    s_waitcnt lgkmcnt(0)
    ds_read_b128 v[196:199], v219 offset:0
    ds_read_b128 v[200:203], v219 offset:512
    ds_read_b128 v[204:207], v219 offset:4096
    ds_read_b128 v[208:211], v219 offset:4608
    v_mfma_f32_16x16x32_bf16 v[12:15], v[124:127], v[180:183], 0
    v_mfma_f32_16x16x32_bf16 v[40:43], v[124:127], v[184:187], 0
    v_mfma_f32_16x16x32_bf16 v[68:71], v[124:127], v[188:191], 0
    v_mfma_f32_16x16x32_bf16 v[96:99], v[124:127], v[192:195], 0
    buffer_load_dwordx4 v[124:127], v2, s[8:11], s35 offen offset:0
    s_add_u32 m0, s41, 0
    s_nop 0
    buffer_load_dwordx4 v212, s[12:15], s37 offen lds
    s_add_u32 m0, s41, 1024
    s_nop 0
    buffer_load_dwordx4 v213, s[12:15], s37 offen lds
    s_waitcnt vmcnt(21)
    v_mfma_f32_16x16x32_bf16 v[16:19], v[128:131], v[180:183], 0
    v_mfma_f32_16x16x32_bf16 v[44:47], v[128:131], v[184:187], 0
    v_mfma_f32_16x16x32_bf16 v[72:75], v[128:131], v[188:191], 0
    v_mfma_f32_16x16x32_bf16 v[100:103], v[128:131], v[192:195], 0
    buffer_load_dwordx4 v[128:131], v2, s[8:11], s35 offen offset:1024
    s_add_u32 m0, s41, 2048
    s_nop 0
    buffer_load_dwordx4 v214, s[12:15], s37 offen lds
    s_add_u32 m0, s41, 3072
    s_nop 0
    buffer_load_dwordx4 v215, s[12:15], s37 offen lds
    s_waitcnt vmcnt(21)
    v_mfma_f32_16x16x32_bf16 v[20:23], v[132:135], v[180:183], 0
    v_mfma_f32_16x16x32_bf16 v[48:51], v[132:135], v[184:187], 0
    v_mfma_f32_16x16x32_bf16 v[76:79], v[132:135], v[188:191], 0
    v_mfma_f32_16x16x32_bf16 v[104:107], v[132:135], v[192:195], 0
    buffer_load_dwordx4 v[132:135], v2, s[8:11], s35 offen offset:2048
    s_add_u32 m0, s41, 4096
    s_nop 0
    buffer_load_dwordx4 v212, s[12:15], s38 offen lds
    s_add_u32 m0, s41, 5120
    s_nop 0
    buffer_load_dwordx4 v213, s[12:15], s38 offen lds
    s_waitcnt vmcnt(21)
    v_mfma_f32_16x16x32_bf16 v[24:27], v[136:139], v[180:183], 0
    v_mfma_f32_16x16x32_bf16 v[52:55], v[136:139], v[184:187], 0
    v_mfma_f32_16x16x32_bf16 v[80:83], v[136:139], v[188:191], 0
    v_mfma_f32_16x16x32_bf16 v[108:111], v[136:139], v[192:195], 0
    buffer_load_dwordx4 v[136:139], v2, s[8:11], s35 offen offset:3072
    s_add_u32 m0, s41, 6144
    s_nop 0
    buffer_load_dwordx4 v214, s[12:15], s38 offen lds
    s_add_u32 m0, s41, 7168
    s_nop 0
    buffer_load_dwordx4 v215, s[12:15], s38 offen lds
    s_waitcnt vmcnt(21)
    v_mfma_f32_16x16x32_bf16 v[28:31], v[140:143], v[180:183], 0
    v_mfma_f32_16x16x32_bf16 v[56:59], v[140:143], v[184:187], 0
    v_mfma_f32_16x16x32_bf16 v[84:87], v[140:143], v[188:191], 0
    v_mfma_f32_16x16x32_bf16 v[112:115], v[140:143], v[192:195], 0
    buffer_load_dwordx4 v[140:143], v2, s[8:11], s36 offen offset:0
    s_waitcnt vmcnt(21)
    v_mfma_f32_16x16x32_bf16 v[32:35], v[144:147], v[180:183], 0
    v_mfma_f32_16x16x32_bf16 v[60:63], v[144:147], v[184:187], 0
    v_mfma_f32_16x16x32_bf16 v[88:91], v[144:147], v[188:191], 0
    v_mfma_f32_16x16x32_bf16 v[116:119], v[144:147], v[192:195], 0
    buffer_load_dwordx4 v[144:147], v2, s[8:11], s36 offen offset:1024
    s_waitcnt vmcnt(21)
    v_mfma_f32_16x16x32_bf16 v[36:39], v[148:151], v[180:183], 0
    v_mfma_f32_16x16x32_bf16 v[64:67], v[148:151], v[184:187], 0
    v_mfma_f32_16x16x32_bf16 v[92:95], v[148:151], v[188:191], 0
    v_mfma_f32_16x16x32_bf16 v[120:123], v[148:151], v[192:195], 0
    buffer_load_dwordx4 v[148:151], v2, s[8:11], s36 offen offset:2048
    s_add_u32 s35, s35, 7168
    s_add_u32 s36, s36, 7168
    s_add_u32 s37, s37, 128
    s_add_u32 s38, s38, 128
    s_add_u32 s41, s41, 8192
    s_add_u32 s23, s39, 24576
    s_cmp_eq_u32 s41, s23
    s_cselect_b32 s41, s39, s41
    s_waitcnt vmcnt(21)
    s_waitcnt lgkmcnt(0)
    s_add_u32 s40, s40, 8192
    s_cmp_eq_u32 s40, 24576
    s_cselect_b32 s40, 0, s40
    v_add_u32 v218, s40, v216
    ds_read_b128 v[180:183], v218 offset:0
    ds_read_b128 v[184:187], v218 offset:512
    ds_read_b128 v[188:191], v218 offset:4096
    ds_read_b128 v[192:195], v218 offset:4608
    v_add_u32 v219, s40, v217
    v_mfma_f32_16x16x32_bf16 v[12:15], v[152:155], v[196:199], v[12:15]
    v_mfma_f32_16x16x32_bf16 v[40:43], v[152:155], v[200:203], v[40:43]
    v_mfma_f32_16x16x32_bf16 v[68:71], v[152:155], v[204:207], v[68:71]
    v_mfma_f32_16x16x32_bf16 v[96:99], v[152:155], v[208:211], v[96:99]
    buffer_load_dwordx4 v[152:155], v2, s[8:11], s35 offen offset:0
    s_waitcnt vmcnt(21)
    v_mfma_f32_16x16x32_bf16 v[16:19], v[156:159], v[196:199], v[16:19]
    v_mfma_f32_16x16x32_bf16 v[44:47], v[156:159], v[200:203], v[44:47]
    v_mfma_f32_16x16x32_bf16 v[72:75], v[156:159], v[204:207], v[72:75]
    v_mfma_f32_16x16x32_bf16 v[100:103], v[156:159], v[208:211], v[100:103]
    buffer_load_dwordx4 v[156:159], v2, s[8:11], s35 offen offset:1024
    s_waitcnt vmcnt(21)
    v_mfma_f32_16x16x32_bf16 v[20:23], v[160:163], v[196:199], v[20:23]
    v_mfma_f32_16x16x32_bf16 v[48:51], v[160:163], v[200:203], v[48:51]
    v_mfma_f32_16x16x32_bf16 v[76:79], v[160:163], v[204:207], v[76:79]
    v_mfma_f32_16x16x32_bf16 v[104:107], v[160:163], v[208:211], v[104:107]
    buffer_load_dwordx4 v[160:163], v2, s[8:11], s35 offen offset:2048
    s_waitcnt vmcnt(21)
    v_mfma_f32_16x16x32_bf16 v[24:27], v[164:167], v[196:199], v[24:27]
    v_mfma_f32_16x16x32_bf16 v[52:55], v[164:167], v[200:203], v[52:55]
    v_mfma_f32_16x16x32_bf16 v[80:83], v[164:167], v[204:207], v[80:83]
    v_mfma_f32_16x16x32_bf16 v[108:111], v[164:167], v[208:211], v[108:111]
    buffer_load_dwordx4 v[164:167], v2, s[8:11], s35 offen offset:3072
    s_waitcnt vmcnt(21)
    v_mfma_f32_16x16x32_bf16 v[28:31], v[168:171], v[196:199], v[28:31]
    v_mfma_f32_16x16x32_bf16 v[56:59], v[168:171], v[200:203], v[56:59]
    v_mfma_f32_16x16x32_bf16 v[84:87], v[168:171], v[204:207], v[84:87]
    v_mfma_f32_16x16x32_bf16 v[112:115], v[168:171], v[208:211], v[112:115]
    buffer_load_dwordx4 v[168:171], v2, s[8:11], s36 offen offset:0
    s_waitcnt vmcnt(21)
    v_mfma_f32_16x16x32_bf16 v[32:35], v[172:175], v[196:199], v[32:35]
    v_mfma_f32_16x16x32_bf16 v[60:63], v[172:175], v[200:203], v[60:63]
    v_mfma_f32_16x16x32_bf16 v[88:91], v[172:175], v[204:207], v[88:91]
    v_mfma_f32_16x16x32_bf16 v[116:119], v[172:175], v[208:211], v[116:119]
    buffer_load_dwordx4 v[172:175], v2, s[8:11], s36 offen offset:1024
    s_waitcnt vmcnt(21)
    v_mfma_f32_16x16x32_bf16 v[36:39], v[176:179], v[196:199], v[36:39]
    v_mfma_f32_16x16x32_bf16 v[64:67], v[176:179], v[200:203], v[64:67]
    v_mfma_f32_16x16x32_bf16 v[92:95], v[176:179], v[204:207], v[92:95]
    v_mfma_f32_16x16x32_bf16 v[120:123], v[176:179], v[208:211], v[120:123]
    buffer_load_dwordx4 v[176:179], v2, s[8:11], s36 offen offset:2048
    s_add_u32 s35, s35, 7168
    s_add_u32 s36, s36, 7168
    s_mov_b32 s42, 1
p2_S_loop:
    s_waitcnt vmcnt(21)
    s_waitcnt lgkmcnt(0)
    ds_read_b128 v[196:199], v219 offset:0
    ds_read_b128 v[200:203], v219 offset:512
    ds_read_b128 v[204:207], v219 offset:4096
    ds_read_b128 v[208:211], v219 offset:4608
    v_mfma_f32_16x16x32_bf16 v[12:15], v[124:127], v[180:183], v[12:15]
    v_mfma_f32_16x16x32_bf16 v[40:43], v[124:127], v[184:187], v[40:43]
    v_mfma_f32_16x16x32_bf16 v[68:71], v[124:127], v[188:191], v[68:71]
    v_mfma_f32_16x16x32_bf16 v[96:99], v[124:127], v[192:195], v[96:99]
    buffer_load_dwordx4 v[124:127], v2, s[8:11], s35 offen offset:0
    s_add_u32 m0, s41, 0
    s_nop 0
    buffer_load_dwordx4 v212, s[12:15], s37 offen lds
    s_add_u32 m0, s41, 1024
    s_nop 0
    buffer_load_dwordx4 v213, s[12:15], s37 offen lds
    s_waitcnt vmcnt(21)
    v_mfma_f32_16x16x32_bf16 v[16:19], v[128:131], v[180:183], v[16:19]
    v_mfma_f32_16x16x32_bf16 v[44:47], v[128:131], v[184:187], v[44:47]
    v_mfma_f32_16x16x32_bf16 v[72:75], v[128:131], v[188:191], v[72:75]
    v_mfma_f32_16x16x32_bf16 v[100:103], v[128:131], v[192:195], v[100:103]
    buffer_load_dwordx4 v[128:131], v2, s[8:11], s35 offen offset:1024
    s_add_u32 m0, s41, 2048
    s_nop 0
    buffer_load_dwordx4 v214, s[12:15], s37 offen lds
    s_add_u32 m0, s41, 3072
    s_nop 0
    buffer_load_dwordx4 v215, s[12:15], s37 offen lds
    s_waitcnt vmcnt(21)
    v_mfma_f32_16x16x32_bf16 v[20:23], v[132:135], v[180:183], v[20:23]
    v_mfma_f32_16x16x32_bf16 v[48:51], v[132:135], v[184:187], v[48:51]
    v_mfma_f32_16x16x32_bf16 v[76:79], v[132:135], v[188:191], v[76:79]
    v_mfma_f32_16x16x32_bf16 v[104:107], v[132:135], v[192:195], v[104:107]
    buffer_load_dwordx4 v[132:135], v2, s[8:11], s35 offen offset:2048
    s_add_u32 m0, s41, 4096
    s_nop 0
    buffer_load_dwordx4 v212, s[12:15], s38 offen lds
    s_add_u32 m0, s41, 5120
    s_nop 0
    buffer_load_dwordx4 v213, s[12:15], s38 offen lds
    s_waitcnt vmcnt(21)
    v_mfma_f32_16x16x32_bf16 v[24:27], v[136:139], v[180:183], v[24:27]
    v_mfma_f32_16x16x32_bf16 v[52:55], v[136:139], v[184:187], v[52:55]
    v_mfma_f32_16x16x32_bf16 v[80:83], v[136:139], v[188:191], v[80:83]
    v_mfma_f32_16x16x32_bf16 v[108:111], v[136:139], v[192:195], v[108:111]
    buffer_load_dwordx4 v[136:139], v2, s[8:11], s35 offen offset:3072
    s_add_u32 m0, s41, 6144
    s_nop 0
    buffer_load_dwordx4 v214, s[12:15], s38 offen lds
    s_add_u32 m0, s41, 7168
    s_nop 0
    buffer_load_dwordx4 v215, s[12:15], s38 offen lds
    s_waitcnt vmcnt(21)
    v_mfma_f32_16x16x32_bf16 v[28:31], v[140:143], v[180:183], v[28:31]
    v_mfma_f32_16x16x32_bf16 v[56:59], v[140:143], v[184:187], v[56:59]
    v_mfma_f32_16x16x32_bf16 v[84:87], v[140:143], v[188:191], v[84:87]
    v_mfma_f32_16x16x32_bf16 v[112:115], v[140:143], v[192:195], v[112:115]
    buffer_load_dwordx4 v[140:143], v2, s[8:11], s36 offen offset:0
    s_waitcnt vmcnt(21)
    v_mfma_f32_16x16x32_bf16 v[32:35], v[144:147], v[180:183], v[32:35]
    v_mfma_f32_16x16x32_bf16 v[60:63], v[144:147], v[184:187], v[60:63]
    v_mfma_f32_16x16x32_bf16 v[88:91], v[144:147], v[188:191], v[88:91]
    v_mfma_f32_16x16x32_bf16 v[116:119], v[144:147], v[192:195], v[116:119]
    buffer_load_dwordx4 v[144:147], v2, s[8:11], s36 offen offset:1024
    s_waitcnt vmcnt(21)
    v_mfma_f32_16x16x32_bf16 v[36:39], v[148:151], v[180:183], v[36:39]
    v_mfma_f32_16x16x32_bf16 v[64:67], v[148:151], v[184:187], v[64:67]
    v_mfma_f32_16x16x32_bf16 v[92:95], v[148:151], v[188:191], v[92:95]
    v_mfma_f32_16x16x32_bf16 v[120:123], v[148:151], v[192:195], v[120:123]
    buffer_load_dwordx4 v[148:151], v2, s[8:11], s36 offen offset:2048
    s_add_u32 s35, s35, 7168
    s_add_u32 s36, s36, 7168
    s_add_u32 s37, s37, 128
    s_add_u32 s38, s38, 128
    s_add_u32 s41, s41, 8192
    s_add_u32 s23, s39, 24576
    s_cmp_eq_u32 s41, s23
    s_cselect_b32 s41, s39, s41
    s_waitcnt vmcnt(21)
    s_waitcnt lgkmcnt(0)
    s_add_u32 s40, s40, 8192
    s_cmp_eq_u32 s40, 24576
    s_cselect_b32 s40, 0, s40
    v_add_u32 v218, s40, v216
    ds_read_b128 v[180:183], v218 offset:0
    ds_read_b128 v[184:187], v218 offset:512
    ds_read_b128 v[188:191], v218 offset:4096
    ds_read_b128 v[192:195], v218 offset:4608
    v_add_u32 v219, s40, v217
    v_mfma_f32_16x16x32_bf16 v[12:15], v[152:155], v[196:199], v[12:15]
    v_mfma_f32_16x16x32_bf16 v[40:43], v[152:155], v[200:203], v[40:43]
    v_mfma_f32_16x16x32_bf16 v[68:71], v[152:155], v[204:207], v[68:71]
    v_mfma_f32_16x16x32_bf16 v[96:99], v[152:155], v[208:211], v[96:99]
    buffer_load_dwordx4 v[152:155], v2, s[8:11], s35 offen offset:0
    s_waitcnt vmcnt(21)
    v_mfma_f32_16x16x32_bf16 v[16:19], v[156:159], v[196:199], v[16:19]
    v_mfma_f32_16x16x32_bf16 v[44:47], v[156:159], v[200:203], v[44:47]
    v_mfma_f32_16x16x32_bf16 v[72:75], v[156:159], v[204:207], v[72:75]
    v_mfma_f32_16x16x32_bf16 v[100:103], v[156:159], v[208:211], v[100:103]
    buffer_load_dwordx4 v[156:159], v2, s[8:11], s35 offen offset:1024
    s_waitcnt vmcnt(21)
    v_mfma_f32_16x16x32_bf16 v[20:23], v[160:163], v[196:199], v[20:23]
    v_mfma_f32_16x16x32_bf16 v[48:51], v[160:163], v[200:203], v[48:51]
    v_mfma_f32_16x16x32_bf16 v[76:79], v[160:163], v[204:207], v[76:79]
    v_mfma_f32_16x16x32_bf16 v[104:107], v[160:163], v[208:211], v[104:107]
    buffer_load_dwordx4 v[160:163], v2, s[8:11], s35 offen offset:2048
    s_waitcnt vmcnt(21)
    v_mfma_f32_16x16x32_bf16 v[24:27], v[164:167], v[196:199], v[24:27]
    v_mfma_f32_16x16x32_bf16 v[52:55], v[164:167], v[200:203], v[52:55]
    v_mfma_f32_16x16x32_bf16 v[80:83], v[164:167], v[204:207], v[80:83]
    v_mfma_f32_16x16x32_bf16 v[108:111], v[164:167], v[208:211], v[108:111]
    buffer_load_dwordx4 v[164:167], v2, s[8:11], s35 offen offset:3072
    s_waitcnt vmcnt(21)
    v_mfma_f32_16x16x32_bf16 v[28:31], v[168:171], v[196:199], v[28:31]
    v_mfma_f32_16x16x32_bf16 v[56:59], v[168:171], v[200:203], v[56:59]
    v_mfma_f32_16x16x32_bf16 v[84:87], v[168:171], v[204:207], v[84:87]
    v_mfma_f32_16x16x32_bf16 v[112:115], v[168:171], v[208:211], v[112:115]
    buffer_load_dwordx4 v[168:171], v2, s[8:11], s36 offen offset:0
    s_waitcnt vmcnt(21)
    v_mfma_f32_16x16x32_bf16 v[32:35], v[172:175], v[196:199], v[32:35]
    v_mfma_f32_16x16x32_bf16 v[60:63], v[172:175], v[200:203], v[60:63]
    v_mfma_f32_16x16x32_bf16 v[88:91], v[172:175], v[204:207], v[88:91]
    v_mfma_f32_16x16x32_bf16 v[116:119], v[172:175], v[208:211], v[116:119]
    buffer_load_dwordx4 v[172:175], v2, s[8:11], s36 offen offset:1024
    s_waitcnt vmcnt(21)
    v_mfma_f32_16x16x32_bf16 v[36:39], v[176:179], v[196:199], v[36:39]
    v_mfma_f32_16x16x32_bf16 v[64:67], v[176:179], v[200:203], v[64:67]
    v_mfma_f32_16x16x32_bf16 v[92:95], v[176:179], v[204:207], v[92:95]
    v_mfma_f32_16x16x32_bf16 v[120:123], v[176:179], v[208:211], v[120:123]
    buffer_load_dwordx4 v[176:179], v2, s[8:11], s36 offen offset:2048
    s_add_u32 s35, s35, 7168
    s_add_u32 s36, s36, 7168
    s_add_u32 s42, s42, 1
    s_cmp_lt_u32 s42, 6
    s_cbranch_scc1 p2_S_loop
    s_waitcnt vmcnt(21)
    s_waitcnt lgkmcnt(0)
    ds_read_b128 v[196:199], v219 offset:0
    ds_read_b128 v[200:203], v219 offset:512
    ds_read_b128 v[204:207], v219 offset:4096
    ds_read_b128 v[208:211], v219 offset:4608
    v_mfma_f32_16x16x32_bf16 v[12:15], v[124:127], v[180:183], v[12:15]
    v_mfma_f32_16x16x32_bf16 v[40:43], v[124:127], v[184:187], v[40:43]
    v_mfma_f32_16x16x32_bf16 v[68:71], v[124:127], v[188:191], v[68:71]
    v_mfma_f32_16x16x32_bf16 v[96:99], v[124:127], v[192:195], v[96:99]
    buffer_load_dwordx4 v[124:127], v2, s[8:11], s35 offen offset:0
    s_waitcnt vmcnt(19)
    v_mfma_f32_16x16x32_bf16 v[16:19], v[128:131], v[180:183], v[16:19]
    v_mfma_f32_16x16x32_bf16 v[44:47], v[128:131], v[184:187], v[44:47]
    v_mfma_f32_16x16x32_bf16 v[72:75], v[128:131], v[188:191], v[72:75]
    v_mfma_f32_16x16x32_bf16 v[100:103], v[128:131], v[192:195], v[100:103]
    buffer_load_dwordx4 v[128:131], v2, s[8:11], s35 offen offset:1024
    s_waitcnt vmcnt(17)
    v_mfma_f32_16x16x32_bf16 v[20:23], v[132:135], v[180:183], v[20:23]
    v_mfma_f32_16x16x32_bf16 v[48:51], v[132:135], v[184:187], v[48:51]
    v_mfma_f32_16x16x32_bf16 v[76:79], v[132:135], v[188:191], v[76:79]
    v_mfma_f32_16x16x32_bf16 v[104:107], v[132:135], v[192:195], v[104:107]
    buffer_load_dwordx4 v[132:135], v2, s[8:11], s35 offen offset:2048
    s_waitcnt vmcnt(15)
    v_mfma_f32_16x16x32_bf16 v[24:27], v[136:139], v[180:183], v[24:27]
    v_mfma_f32_16x16x32_bf16 v[52:55], v[136:139], v[184:187], v[52:55]
    v_mfma_f32_16x16x32_bf16 v[80:83], v[136:139], v[188:191], v[80:83]
    v_mfma_f32_16x16x32_bf16 v[108:111], v[136:139], v[192:195], v[108:111]
    buffer_load_dwordx4 v[136:139], v2, s[8:11], s35 offen offset:3072
    s_waitcnt vmcnt(13)
    v_mfma_f32_16x16x32_bf16 v[28:31], v[140:143], v[180:183], v[28:31]
    v_mfma_f32_16x16x32_bf16 v[56:59], v[140:143], v[184:187], v[56:59]
    v_mfma_f32_16x16x32_bf16 v[84:87], v[140:143], v[188:191], v[84:87]
    v_mfma_f32_16x16x32_bf16 v[112:115], v[140:143], v[192:195], v[112:115]
    buffer_load_dwordx4 v[140:143], v2, s[8:11], s36 offen offset:0
    s_waitcnt vmcnt(13)
    v_mfma_f32_16x16x32_bf16 v[32:35], v[144:147], v[180:183], v[32:35]
    v_mfma_f32_16x16x32_bf16 v[60:63], v[144:147], v[184:187], v[60:63]
    v_mfma_f32_16x16x32_bf16 v[88:91], v[144:147], v[188:191], v[88:91]
    v_mfma_f32_16x16x32_bf16 v[116:119], v[144:147], v[192:195], v[116:119]
    buffer_load_dwordx4 v[144:147], v2, s[8:11], s36 offen offset:1024
    s_waitcnt vmcnt(13)
    v_mfma_f32_16x16x32_bf16 v[36:39], v[148:151], v[180:183], v[36:39]
    v_mfma_f32_16x16x32_bf16 v[64:67], v[148:151], v[184:187], v[64:67]
    v_mfma_f32_16x16x32_bf16 v[92:95], v[148:151], v[188:191], v[92:95]
    v_mfma_f32_16x16x32_bf16 v[120:123], v[148:151], v[192:195], v[120:123]
    buffer_load_dwordx4 v[148:151], v2, s[8:11], s36 offen offset:2048
    s_add_u32 s35, s35, 7168
    s_add_u32 s36, s36, 7168
    s_waitcnt vmcnt(13)
    s_waitcnt lgkmcnt(0)
    s_add_u32 s40, s40, 8192
    s_cmp_eq_u32 s40, 24576
    s_cselect_b32 s40, 0, s40
    v_add_u32 v218, s40, v216
    ds_read_b128 v[180:183], v218 offset:0
    ds_read_b128 v[184:187], v218 offset:512
    ds_read_b128 v[188:191], v218 offset:4096
    ds_read_b128 v[192:195], v218 offset:4608
    v_add_u32 v219, s40, v217
    v_mfma_f32_16x16x32_bf16 v[12:15], v[152:155], v[196:199], v[12:15]
    v_mfma_f32_16x16x32_bf16 v[40:43], v[152:155], v[200:203], v[40:43]
    v_mfma_f32_16x16x32_bf16 v[68:71], v[152:155], v[204:207], v[68:71]
    v_mfma_f32_16x16x32_bf16 v[96:99], v[152:155], v[208:211], v[96:99]
    buffer_load_dwordx4 v[152:155], v2, s[8:11], s35 offen offset:0
    s_waitcnt vmcnt(13)
    v_mfma_f32_16x16x32_bf16 v[16:19], v[156:159], v[196:199], v[16:19]
    v_mfma_f32_16x16x32_bf16 v[44:47], v[156:159], v[200:203], v[44:47]
    v_mfma_f32_16x16x32_bf16 v[72:75], v[156:159], v[204:207], v[72:75]
    v_mfma_f32_16x16x32_bf16 v[100:103], v[156:159], v[208:211], v[100:103]
    buffer_load_dwordx4 v[156:159], v2, s[8:11], s35 offen offset:1024
    s_waitcnt vmcnt(13)
    v_mfma_f32_16x16x32_bf16 v[20:23], v[160:163], v[196:199], v[20:23]
    v_mfma_f32_16x16x32_bf16 v[48:51], v[160:163], v[200:203], v[48:51]
    v_mfma_f32_16x16x32_bf16 v[76:79], v[160:163], v[204:207], v[76:79]
    v_mfma_f32_16x16x32_bf16 v[104:107], v[160:163], v[208:211], v[104:107]
    buffer_load_dwordx4 v[160:163], v2, s[8:11], s35 offen offset:2048
    s_waitcnt vmcnt(13)
    v_mfma_f32_16x16x32_bf16 v[24:27], v[164:167], v[196:199], v[24:27]
    v_mfma_f32_16x16x32_bf16 v[52:55], v[164:167], v[200:203], v[52:55]
    v_mfma_f32_16x16x32_bf16 v[80:83], v[164:167], v[204:207], v[80:83]
    v_mfma_f32_16x16x32_bf16 v[108:111], v[164:167], v[208:211], v[108:111]
    buffer_load_dwordx4 v[164:167], v2, s[8:11], s35 offen offset:3072
    s_waitcnt vmcnt(13)
    v_mfma_f32_16x16x32_bf16 v[28:31], v[168:171], v[196:199], v[28:31]
    v_mfma_f32_16x16x32_bf16 v[56:59], v[168:171], v[200:203], v[56:59]
    v_mfma_f32_16x16x32_bf16 v[84:87], v[168:171], v[204:207], v[84:87]
    v_mfma_f32_16x16x32_bf16 v[112:115], v[168:171], v[208:211], v[112:115]
    buffer_load_dwordx4 v[168:171], v2, s[8:11], s36 offen offset:0
    s_waitcnt vmcnt(13)
    v_mfma_f32_16x16x32_bf16 v[32:35], v[172:175], v[196:199], v[32:35]
    v_mfma_f32_16x16x32_bf16 v[60:63], v[172:175], v[200:203], v[60:63]
    v_mfma_f32_16x16x32_bf16 v[88:91], v[172:175], v[204:207], v[88:91]
    v_mfma_f32_16x16x32_bf16 v[116:119], v[172:175], v[208:211], v[116:119]
    buffer_load_dwordx4 v[172:175], v2, s[8:11], s36 offen offset:1024
    s_waitcnt vmcnt(13)
    v_mfma_f32_16x16x32_bf16 v[36:39], v[176:179], v[196:199], v[36:39]
    v_mfma_f32_16x16x32_bf16 v[64:67], v[176:179], v[200:203], v[64:67]
    v_mfma_f32_16x16x32_bf16 v[92:95], v[176:179], v[204:207], v[92:95]
    v_mfma_f32_16x16x32_bf16 v[120:123], v[176:179], v[208:211], v[120:123]
    buffer_load_dwordx4 v[176:179], v2, s[8:11], s36 offen offset:2048
    s_add_u32 s35, s35, 7168
    s_add_u32 s36, s36, 7168
    s_lshl_b32 s43, s33, 2
    s_add_u32 s43, s43, s32
    s_lshr_b32 s23, s43, 1
    s_mul_i32 s23, s23, 56
    s_mul_i32 s24, s34, 7
    s_add_u32 s23, s23, s24
    s_lshl_b32 s23, s23, 10
    s_and_b32 s24, s43, 1
    s_lshl_b32 s24, s24, 3
    s_add_u32 s23, s23, s24
    s_add_u32 s23, s23, 0x980000
    s_add_u32 s24, s23, 4096
    buffer_load_dwordx2 v[220:221], v2, s[8:11], s23 offen offset:0
    buffer_load_dwordx2 v[222:223], v2, s[8:11], s23 offen offset:1024
    buffer_load_dwordx2 v[224:225], v2, s[8:11], s23 offen offset:2048
    buffer_load_dwordx2 v[226:227], v2, s[8:11], s23 offen offset:3072
    buffer_load_dwordx2 v[228:229], v2, s[8:11], s24 offen offset:0
    buffer_load_dwordx2 v[230:231], v2, s[8:11], s24 offen offset:1024
    buffer_load_dwordx2 v[232:233], v2, s[8:11], s24 offen offset:2048
    v_and_b32 v5, 15, v1
    v_lshrrev_b32 v6, 2, v5
    v_and_b32 v7, 3, v5
    v_lshl_add_u32 v6, v6, 3, v7
    v_lshlrev_b32 v6, 1, v6
    s_lshl_b32 s23, s33, 6
    s_lshr_b32 s24, s32, 1
    s_lshl_b32 s24, s24, 5
    s_add_u32 s23, s23, s24
    s_and_b32 s24, s32, 1
    s_lshl_b32 s24, s24, 2
    s_add_u32 s23, s23, s24
    s_lshl_b32 s23, s23, 1
    buffer_load_ushort v234, v6, s[16:19], s23 offen
    s_waitcnt vmcnt(21)
    s_waitcnt lgkmcnt(0)
    ds_read_b128 v[196:199], v219 offset:0
    ds_read_b128 v[200:203], v219 offset:512
    ds_read_b128 v[204:207], v219 offset:4096
    ds_read_b128 v[208:211], v219 offset:4608
    v_mfma_f32_16x16x32_bf16 v[12:15], v[124:127], v[180:183], v[12:15]
    v_mfma_f32_16x16x32_bf16 v[40:43], v[124:127], v[184:187], v[40:43]
    v_mfma_f32_16x16x32_bf16 v[68:71], v[124:127], v[188:191], v[68:71]
    v_mfma_f32_16x16x32_bf16 v[96:99], v[124:127], v[192:195], v[96:99]
    s_waitcnt vmcnt(20)
    v_mfma_f32_16x16x32_bf16 v[16:19], v[128:131], v[180:183], v[16:19]
    v_mfma_f32_16x16x32_bf16 v[44:47], v[128:131], v[184:187], v[44:47]
    v_mfma_f32_16x16x32_bf16 v[72:75], v[128:131], v[188:191], v[72:75]
    v_mfma_f32_16x16x32_bf16 v[100:103], v[128:131], v[192:195], v[100:103]
    s_waitcnt vmcnt(19)
    v_mfma_f32_16x16x32_bf16 v[20:23], v[132:135], v[180:183], v[20:23]
    v_mfma_f32_16x16x32_bf16 v[48:51], v[132:135], v[184:187], v[48:51]
    v_mfma_f32_16x16x32_bf16 v[76:79], v[132:135], v[188:191], v[76:79]
    v_mfma_f32_16x16x32_bf16 v[104:107], v[132:135], v[192:195], v[104:107]
    s_waitcnt vmcnt(18)
    v_mfma_f32_16x16x32_bf16 v[24:27], v[136:139], v[180:183], v[24:27]
    v_mfma_f32_16x16x32_bf16 v[52:55], v[136:139], v[184:187], v[52:55]
    v_mfma_f32_16x16x32_bf16 v[80:83], v[136:139], v[188:191], v[80:83]
    v_mfma_f32_16x16x32_bf16 v[108:111], v[136:139], v[192:195], v[108:111]
    s_waitcnt vmcnt(17)
    v_mfma_f32_16x16x32_bf16 v[28:31], v[140:143], v[180:183], v[28:31]
    v_mfma_f32_16x16x32_bf16 v[56:59], v[140:143], v[184:187], v[56:59]
    v_mfma_f32_16x16x32_bf16 v[84:87], v[140:143], v[188:191], v[84:87]
    v_mfma_f32_16x16x32_bf16 v[112:115], v[140:143], v[192:195], v[112:115]
    s_waitcnt vmcnt(16)
    v_mfma_f32_16x16x32_bf16 v[32:35], v[144:147], v[180:183], v[32:35]
    v_mfma_f32_16x16x32_bf16 v[60:63], v[144:147], v[184:187], v[60:63]
    v_mfma_f32_16x16x32_bf16 v[88:91], v[144:147], v[188:191], v[88:91]
    v_mfma_f32_16x16x32_bf16 v[116:119], v[144:147], v[192:195], v[116:119]
    s_waitcnt vmcnt(15)
    v_mfma_f32_16x16x32_bf16 v[36:39], v[148:151], v[180:183], v[36:39]
    v_mfma_f32_16x16x32_bf16 v[64:67], v[148:151], v[184:187], v[64:67]
    v_mfma_f32_16x16x32_bf16 v[92:95], v[148:151], v[188:191], v[92:95]
    v_mfma_f32_16x16x32_bf16 v[120:123], v[148:151], v[192:195], v[120:123]
    s_waitcnt vmcnt(14)
    s_waitcnt lgkmcnt(0)
    v_mfma_f32_16x16x32_bf16 v[12:15], v[152:155], v[196:199], v[12:15]
    v_mfma_f32_16x16x32_bf16 v[40:43], v[152:155], v[200:203], v[40:43]
    v_mfma_f32_16x16x32_bf16 v[68:71], v[152:155], v[204:207], v[68:71]
    v_mfma_f32_16x16x32_bf16 v[96:99], v[152:155], v[208:211], v[96:99]
    s_waitcnt vmcnt(13)
    v_mfma_f32_16x16x32_bf16 v[16:19], v[156:159], v[196:199], v[16:19]
    v_mfma_f32_16x16x32_bf16 v[44:47], v[156:159], v[200:203], v[44:47]
    v_mfma_f32_16x16x32_bf16 v[72:75], v[156:159], v[204:207], v[72:75]
    v_mfma_f32_16x16x32_bf16 v[100:103], v[156:159], v[208:211], v[100:103]
    s_waitcnt vmcnt(12)
    v_mfma_f32_16x16x32_bf16 v[20:23], v[160:163], v[196:199], v[20:23]
    v_mfma_f32_16x16x32_bf16 v[48:51], v[160:163], v[200:203], v[48:51]
    v_mfma_f32_16x16x32_bf16 v[76:79], v[160:163], v[204:207], v[76:79]
    v_mfma_f32_16x16x32_bf16 v[104:107], v[160:163], v[208:211], v[104:107]
    s_waitcnt vmcnt(11)
    v_mfma_f32_16x16x32_bf16 v[24:27], v[164:167], v[196:199], v[24:27]
    v_mfma_f32_16x16x32_bf16 v[52:55], v[164:167], v[200:203], v[52:55]
    v_mfma_f32_16x16x32_bf16 v[80:83], v[164:167], v[204:207], v[80:83]
    v_mfma_f32_16x16x32_bf16 v[108:111], v[164:167], v[208:211], v[108:111]
    s_waitcnt vmcnt(10)
    v_mfma_f32_16x16x32_bf16 v[28:31], v[168:171], v[196:199], v[28:31]
    v_mfma_f32_16x16x32_bf16 v[56:59], v[168:171], v[200:203], v[56:59]
    v_mfma_f32_16x16x32_bf16 v[84:87], v[168:171], v[204:207], v[84:87]
    v_mfma_f32_16x16x32_bf16 v[112:115], v[168:171], v[208:211], v[112:115]
    s_waitcnt vmcnt(9)
    v_mfma_f32_16x16x32_bf16 v[32:35], v[172:175], v[196:199], v[32:35]
    v_mfma_f32_16x16x32_bf16 v[60:63], v[172:175], v[200:203], v[60:63]
    v_mfma_f32_16x16x32_bf16 v[88:91], v[172:175], v[204:207], v[88:91]
    v_mfma_f32_16x16x32_bf16 v[116:119], v[172:175], v[208:211], v[116:119]
    s_waitcnt vmcnt(8)
    v_mfma_f32_16x16x32_bf16 v[36:39], v[176:179], v[196:199], v[36:39]
    v_mfma_f32_16x16x32_bf16 v[64:67], v[176:179], v[200:203], v[64:67]
    v_mfma_f32_16x16x32_bf16 v[92:95], v[176:179], v[204:207], v[92:95]
    v_mfma_f32_16x16x32_bf16 v[120:123], v[176:179], v[208:211], v[120:123]
    s_cmp_eq_u32 s32, 0
    s_cbranch_scc1 p2_sd0_own
    s_cmp_lt_u32 s32, 0
    s_cselect_b32 s24, 0, 0
    s_mul_i32 s24, s24, 7168
    s_add_u32 s24, s24, s39
    v_add_u32 v4, s24, v2
    ds_write_b128 v4, v[12:15] offset:0
    ds_write_b128 v4, v[16:19] offset:1024
    ds_write_b128 v4, v[20:23] offset:2048
    ds_write_b128 v4, v[24:27] offset:3072
    ds_write_b128 v4, v[28:31] offset:4096
    ds_write_b128 v4, v[32:35] offset:5120
    ds_write_b128 v4, v[36:39] offset:6144
    s_branch p2_sd0_e
p2_sd0_own:
    v_mov_b32 v124, v12
    v_mov_b32 v125, v13
    v_mov_b32 v126, v14
    v_mov_b32 v127, v15
    v_mov_b32 v128, v16
    v_mov_b32 v129, v17
    v_mov_b32 v130, v18
    v_mov_b32 v131, v19
    v_mov_b32 v132, v20
    v_mov_b32 v133, v21
    v_mov_b32 v134, v22
    v_mov_b32 v135, v23
    v_mov_b32 v136, v24
    v_mov_b32 v137, v25
    v_mov_b32 v138, v26
    v_mov_b32 v139, v27
    v_mov_b32 v140, v28
    v_mov_b32 v141, v29
    v_mov_b32 v142, v30
    v_mov_b32 v143, v31
    v_mov_b32 v144, v32
    v_mov_b32 v145, v33
    v_mov_b32 v146, v34
    v_mov_b32 v147, v35
    v_mov_b32 v148, v36
    v_mov_b32 v149, v37
    v_mov_b32 v150, v38
    v_mov_b32 v151, v39
p2_sd0_e:
    s_cmp_eq_u32 s32, 1
    s_cbranch_scc1 p2_sd1_own
    s_cmp_lt_u32 s32, 1
    s_cselect_b32 s24, 0, 1
    s_mul_i32 s24, s24, 7168
    s_add_u32 s24, s24, s39
    v_add_u32 v4, s24, v2
    ds_write_b128 v4, v[40:43] offset:0
    ds_write_b128 v4, v[44:47] offset:1024
    ds_write_b128 v4, v[48:51] offset:2048
    ds_write_b128 v4, v[52:55] offset:3072
    ds_write_b128 v4, v[56:59] offset:4096
    ds_write_b128 v4, v[60:63] offset:5120
    ds_write_b128 v4, v[64:67] offset:6144
    s_branch p2_sd1_e
p2_sd1_own:
    v_mov_b32 v124, v40
    v_mov_b32 v125, v41
    v_mov_b32 v126, v42
    v_mov_b32 v127, v43
    v_mov_b32 v128, v44
    v_mov_b32 v129, v45
    v_mov_b32 v130, v46
    v_mov_b32 v131, v47
    v_mov_b32 v132, v48
    v_mov_b32 v133, v49
    v_mov_b32 v134, v50
    v_mov_b32 v135, v51
    v_mov_b32 v136, v52
    v_mov_b32 v137, v53
    v_mov_b32 v138, v54
    v_mov_b32 v139, v55
    v_mov_b32 v140, v56
    v_mov_b32 v141, v57
    v_mov_b32 v142, v58
    v_mov_b32 v143, v59
    v_mov_b32 v144, v60
    v_mov_b32 v145, v61
    v_mov_b32 v146, v62
    v_mov_b32 v147, v63
    v_mov_b32 v148, v64
    v_mov_b32 v149, v65
    v_mov_b32 v150, v66
    v_mov_b32 v151, v67
p2_sd1_e:
    s_cmp_eq_u32 s32, 2
    s_cbranch_scc1 p2_sd2_own
    s_cmp_lt_u32 s32, 2
    s_cselect_b32 s24, 1, 2
    s_mul_i32 s24, s24, 7168
    s_add_u32 s24, s24, s39
    v_add_u32 v4, s24, v2
    ds_write_b128 v4, v[68:71] offset:0
    ds_write_b128 v4, v[72:75] offset:1024
    ds_write_b128 v4, v[76:79] offset:2048
    ds_write_b128 v4, v[80:83] offset:3072
    ds_write_b128 v4, v[84:87] offset:4096
    ds_write_b128 v4, v[88:91] offset:5120
    ds_write_b128 v4, v[92:95] offset:6144
    s_branch p2_sd2_e
p2_sd2_own:
    v_mov_b32 v124, v68
    v_mov_b32 v125, v69
    v_mov_b32 v126, v70
    v_mov_b32 v127, v71
    v_mov_b32 v128, v72
    v_mov_b32 v129, v73
    v_mov_b32 v130, v74
    v_mov_b32 v131, v75
    v_mov_b32 v132, v76
    v_mov_b32 v133, v77
    v_mov_b32 v134, v78
    v_mov_b32 v135, v79
    v_mov_b32 v136, v80
    v_mov_b32 v137, v81
    v_mov_b32 v138, v82
    v_mov_b32 v139, v83
    v_mov_b32 v140, v84
    v_mov_b32 v141, v85
    v_mov_b32 v142, v86
    v_mov_b32 v143, v87
    v_mov_b32 v144, v88
    v_mov_b32 v145, v89
    v_mov_b32 v146, v90
    v_mov_b32 v147, v91
    v_mov_b32 v148, v92
    v_mov_b32 v149, v93
    v_mov_b32 v150, v94
    v_mov_b32 v151, v95
p2_sd2_e:
    s_cmp_eq_u32 s32, 3
    s_cbranch_scc1 p2_sd3_own
    s_cmp_lt_u32 s32, 3
    s_cselect_b32 s24, 2, 3
    s_mul_i32 s24, s24, 7168
    s_add_u32 s24, s24, s39
    v_add_u32 v4, s24, v2
    ds_write_b128 v4, v[96:99] offset:0
    ds_write_b128 v4, v[100:103] offset:1024
    ds_write_b128 v4, v[104:107] offset:2048
    ds_write_b128 v4, v[108:111] offset:3072
    ds_write_b128 v4, v[112:115] offset:4096
    ds_write_b128 v4, v[116:119] offset:5120
    ds_write_b128 v4, v[120:123] offset:6144
    s_branch p2_sd3_e
p2_sd3_own:
    v_mov_b32 v124, v96
    v_mov_b32 v125, v97
    v_mov_b32 v126, v98
    v_mov_b32 v127, v99
    v_mov_b32 v128, v100
    v_mov_b32 v129, v101
    v_mov_b32 v130, v102
    v_mov_b32 v131, v103
    v_mov_b32 v132, v104
    v_mov_b32 v133, v105
    v_mov_b32 v134, v106
    v_mov_b32 v135, v107
    v_mov_b32 v136, v108
    v_mov_b32 v137, v109
    v_mov_b32 v138, v110
    v_mov_b32 v139, v111
    v_mov_b32 v140, v112
    v_mov_b32 v141, v113
    v_mov_b32 v142, v114
    v_mov_b32 v143, v115
    v_mov_b32 v144, v116
    v_mov_b32 v145, v117
    v_mov_b32 v146, v118
    v_mov_b32 v147, v119
    v_mov_b32 v148, v120
    v_mov_b32 v149, v121
    v_mov_b32 v150, v122
    v_mov_b32 v151, v123
p2_sd3_e:
    s_waitcnt lgkmcnt(0)
    s_mov_b32 exec_lo, 0x1
    s_mov_b32 exec_hi, 0x0
    ds_add_u32 v9, v10
    s_mov_b64 exec, -1
    s_add_u32 s27, s27, 4
    s_mov_b32 s28, 0
p2_sy8:
    ds_read_b32 v3, v9
    s_waitcnt lgkmcnt(0)
    v_readfirstlane_b32 s23, v3
    s_add_u32 s28, s28, 1
    s_cmp_ge_u32 s28, 0x200000
    s_cbranch_scc1 p2_sy8_x
    s_nop 0
    s_cmp_lt_u32 s23, s27
    s_cbranch_scc1 p2_sy8
p2_sy8_x:
    s_cmp_ge_u32 0, s32
    s_cselect_b32 s24, 1, 0
    s_cmp_gt_u32 s32, s24
    s_cselect_b32 s25, 1, 0
    s_sub_u32 s25, s32, s25
    s_mul_i32 s25, s25, 7168
    s_mul_i32 s24, s24, 24576
    s_add_u32 s24, s24, s25
    v_add_u32 v4, s24, v2
    s_cmp_ge_u32 1, s32
    s_cselect_b32 s24, 2, 1
    s_cmp_gt_u32 s32, s24
    s_cselect_b32 s25, 1, 0
    s_sub_u32 s25, s32, s25
    s_mul_i32 s25, s25, 7168
    s_mul_i32 s24, s24, 24576
    s_add_u32 s24, s24, s25
    v_add_u32 v5, s24, v2
    s_cmp_ge_u32 2, s32
    s_cselect_b32 s24, 3, 2
    s_cmp_gt_u32 s32, s24
    s_cselect_b32 s25, 1, 0
    s_sub_u32 s25, s32, s25
    s_mul_i32 s25, s25, 7168
    s_mul_i32 s24, s24, 24576
    s_add_u32 s24, s24, s25
    v_add_u32 v6, s24, v2
    ds_read_b128 v[12:15], v4 offset:0
    ds_read_b128 v[16:19], v4 offset:1024
    ds_read_b128 v[20:23], v4 offset:2048
    ds_read_b128 v[24:27], v4 offset:3072
    ds_read_b128 v[28:31], v4 offset:4096
    ds_read_b128 v[32:35], v4 offset:5120
    ds_read_b128 v[36:39], v4 offset:6144
    ds_read_b128 v[40:43], v5 offset:0
    ds_read_b128 v[44:47], v5 offset:1024
    ds_read_b128 v[48:51], v5 offset:2048
    ds_read_b128 v[52:55], v5 offset:3072
    ds_read_b128 v[56:59], v5 offset:4096
    ds_read_b128 v[60:63], v5 offset:5120
    ds_read_b128 v[64:67], v5 offset:6144
    ds_read_b128 v[68:71], v6 offset:0
    ds_read_b128 v[72:75], v6 offset:1024
    ds_read_b128 v[76:79], v6 offset:2048
    ds_read_b128 v[80:83], v6 offset:3072
    ds_read_b128 v[84:87], v6 offset:4096
    ds_read_b128 v[88:91], v6 offset:5120
    ds_read_b128 v[92:95], v6 offset:6144
    s_waitcnt vmcnt(0)
    v_lshlrev_b32 v96, 16, v220
    v_and_b32 v97, 0xffff0000, v220
    v_lshlrev_b32 v98, 16, v221
    v_and_b32 v99, 0xffff0000, v221
    v_lshlrev_b32 v100, 16, v222
    v_and_b32 v101, 0xffff0000, v222
    v_lshlrev_b32 v102, 16, v223
    v_and_b32 v103, 0xffff0000, v223
    v_lshlrev_b32 v104, 16, v224
    v_and_b32 v105, 0xffff0000, v224
    v_lshlrev_b32 v106, 16, v225
    v_and_b32 v107, 0xffff0000, v225
    v_lshlrev_b32 v108, 16, v226
    v_and_b32 v109, 0xffff0000, v226
    v_lshlrev_b32 v110, 16, v227
    v_and_b32 v111, 0xffff0000, v227
    v_lshlrev_b32 v112, 16, v228
    v_and_b32 v113, 0xffff0000, v228
    v_lshlrev_b32 v114, 16, v229
    v_and_b32 v115, 0xffff0000, v229
    v_lshlrev_b32 v116, 16, v230
    v_and_b32 v117, 0xffff0000, v230
    v_lshlrev_b32 v118, 16, v231
    v_and_b32 v119, 0xffff0000, v231
    v_lshlrev_b32 v120, 16, v232
    v_and_b32 v121, 0xffff0000, v232
    v_lshlrev_b32 v122, 16, v233
    v_and_b32 v123, 0xffff0000, v233
    v_lshlrev_b32 v180, 16, v234
    v_mov_b32 v181, v180
    v_pk_add_f32 v[124:125], v[124:125], v[180:181]
    v_pk_add_f32 v[126:127], v[126:127], v[180:181]
    v_pk_add_f32 v[128:129], v[128:129], v[180:181]
    v_pk_add_f32 v[130:131], v[130:131], v[180:181]
    v_pk_add_f32 v[132:133], v[132:133], v[180:181]
    v_pk_add_f32 v[134:135], v[134:135], v[180:181]
    v_pk_add_f32 v[136:137], v[136:137], v[180:181]
    v_pk_add_f32 v[138:139], v[138:139], v[180:181]
    v_pk_add_f32 v[140:141], v[140:141], v[180:181]
    v_pk_add_f32 v[142:143], v[142:143], v[180:181]
    v_pk_add_f32 v[144:145], v[144:145], v[180:181]
    v_pk_add_f32 v[146:147], v[146:147], v[180:181]
    v_pk_add_f32 v[148:149], v[148:149], v[180:181]
    v_pk_add_f32 v[150:151], v[150:151], v[180:181]
    s_waitcnt lgkmcnt(14)
    v_pk_add_f32 v[124:125], v[124:125], v[12:13]
    v_pk_add_f32 v[126:127], v[126:127], v[14:15]
    v_pk_add_f32 v[128:129], v[128:129], v[16:17]
    v_pk_add_f32 v[130:131], v[130:131], v[18:19]
    v_pk_add_f32 v[132:133], v[132:133], v[20:21]
    v_pk_add_f32 v[134:135], v[134:135], v[22:23]
    v_pk_add_f32 v[136:137], v[136:137], v[24:25]
    v_pk_add_f32 v[138:139], v[138:139], v[26:27]
    v_pk_add_f32 v[140:141], v[140:141], v[28:29]
    v_pk_add_f32 v[142:143], v[142:143], v[30:31]
    v_pk_add_f32 v[144:145], v[144:145], v[32:33]
    v_pk_add_f32 v[146:147], v[146:147], v[34:35]
    v_pk_add_f32 v[148:149], v[148:149], v[36:37]
    v_pk_add_f32 v[150:151], v[150:151], v[38:39]
    s_waitcnt lgkmcnt(7)
    v_pk_add_f32 v[124:125], v[124:125], v[40:41]
    v_pk_add_f32 v[126:127], v[126:127], v[42:43]
    v_pk_add_f32 v[128:129], v[128:129], v[44:45]
    v_pk_add_f32 v[130:131], v[130:131], v[46:47]
    v_pk_add_f32 v[132:133], v[132:133], v[48:49]
    v_pk_add_f32 v[134:135], v[134:135], v[50:51]
    v_pk_add_f32 v[136:137], v[136:137], v[52:53]
    v_pk_add_f32 v[138:139], v[138:139], v[54:55]
    v_pk_add_f32 v[140:141], v[140:141], v[56:57]
    v_pk_add_f32 v[142:143], v[142:143], v[58:59]
    v_pk_add_f32 v[144:145], v[144:145], v[60:61]
    v_pk_add_f32 v[146:147], v[146:147], v[62:63]
    v_pk_add_f32 v[148:149], v[148:149], v[64:65]
    v_pk_add_f32 v[150:151], v[150:151], v[66:67]
    s_waitcnt lgkmcnt(0)
    v_pk_add_f32 v[124:125], v[124:125], v[68:69]
    v_pk_add_f32 v[126:127], v[126:127], v[70:71]
    v_pk_add_f32 v[128:129], v[128:129], v[72:73]
    v_pk_add_f32 v[130:131], v[130:131], v[74:75]
    v_pk_add_f32 v[132:133], v[132:133], v[76:77]
    v_pk_add_f32 v[134:135], v[134:135], v[78:79]
    v_pk_add_f32 v[136:137], v[136:137], v[80:81]
    v_pk_add_f32 v[138:139], v[138:139], v[82:83]
    v_pk_add_f32 v[140:141], v[140:141], v[84:85]
    v_pk_add_f32 v[142:143], v[142:143], v[86:87]
    v_pk_add_f32 v[144:145], v[144:145], v[88:89]
    v_pk_add_f32 v[146:147], v[146:147], v[90:91]
    v_pk_add_f32 v[148:149], v[148:149], v[92:93]
    v_pk_add_f32 v[150:151], v[150:151], v[94:95]
    v_pk_mul_f32 v[124:125], v[124:125], v[96:97]
    v_pk_mul_f32 v[126:127], v[126:127], v[98:99]
    v_pk_mul_f32 v[128:129], v[128:129], v[100:101]
    v_pk_mul_f32 v[130:131], v[130:131], v[102:103]
    v_pk_mul_f32 v[132:133], v[132:133], v[104:105]
    v_pk_mul_f32 v[134:135], v[134:135], v[106:107]
    v_pk_mul_f32 v[136:137], v[136:137], v[108:109]
    v_pk_mul_f32 v[138:139], v[138:139], v[110:111]
    v_pk_mul_f32 v[140:141], v[140:141], v[112:113]
    v_pk_mul_f32 v[142:143], v[142:143], v[114:115]
    v_pk_mul_f32 v[144:145], v[144:145], v[116:117]
    v_pk_mul_f32 v[146:147], v[146:147], v[118:119]
    v_pk_mul_f32 v[148:149], v[148:149], v[120:121]
    v_pk_mul_f32 v[150:151], v[150:151], v[122:123]
    v_cvt_pk_bf16_f32 v220, v124, v125
    v_cvt_pk_bf16_f32 v221, v126, v127
    v_cvt_pk_bf16_f32 v222, v128, v129
    v_cvt_pk_bf16_f32 v223, v130, v131
    v_cvt_pk_bf16_f32 v224, v132, v133
    v_cvt_pk_bf16_f32 v225, v134, v135
    v_cvt_pk_bf16_f32 v226, v136, v137
    v_cvt_pk_bf16_f32 v227, v138, v139
    v_cvt_pk_bf16_f32 v228, v140, v141
    v_cvt_pk_bf16_f32 v229, v142, v143
    v_cvt_pk_bf16_f32 v230, v144, v145
    v_cvt_pk_bf16_f32 v231, v146, v147
    v_cvt_pk_bf16_f32 v232, v148, v149
    v_cvt_pk_bf16_f32 v233, v150, v151
    v_and_b32 v4, 15, v1
    v_lshlrev_b32 v4, 4, v4
    v_bfe_u32 v5, v1, 5, 1
    v_lshl_add_u32 v4, v5, 8, v4
    v_bfe_u32 v5, v1, 4, 1
    s_mul_i32 s23, s43, 43008
    s_mul_i32 s24, s34, 3584
    s_add_u32 s23, s23, s24
    s_add_u32 s23, s23, 0xd03800
    v_lshl_add_u32 v6, v5, 9, v4
    v_permlane16_swap_b32 v220, v222
    v_permlane16_swap_b32 v221, v223
    v_permlane16_swap_b32 v224, v226
    v_permlane16_swap_b32 v225, v227
    v_permlane16_swap_b32 v228, v230
    v_permlane16_swap_b32 v229, v231
    buffer_store_dwordx4 v[220:223], v6, s[8:11], s23 offen offset:0 sc1
    buffer_store_dwordx4 v[224:227], v6, s[8:11], s23 offen offset:1024 sc1
    buffer_store_dwordx4 v[228:231], v6, s[8:11], s23 offen offset:2048 sc1
    v_lshl_add_u32 v4, v5, 3, v4
    buffer_store_dwordx2 v[232:233], v4, s[8:11], s23 offen offset:3072 sc1
p2_end:
    s_endpgm
p2_w2_l:
    s_waitcnt vmcnt(4)
    s_branch p2_w2_e
p2_w4_l:
    s_waitcnt vmcnt(0)
    s_branch p2_w4_e
.globl p3_kernel
.p2align 8
.type p3_kernel,@function
p3_kernel:
    s_cmp_ge_u32 s2, 224
    s_cbranch_scc1 p3_end
    s_load_dwordx2 s[56:57], s[0:1], 80
    s_load_dwordx2 s[6:7], s[0:1], 16
    s_load_dwordx2 s[52:53], s[0:1], 56
    s_load_dwordx2 s[4:5], s[0:1], 0
    s_load_dwordx2 s[54:55], s[0:1], 64
    v_and_b32 v1, 63, v0
    v_lshrrev_b32 v2, 6, v0
    s_nop 0
    v_readfirstlane_b32 s28, v2
    s_and_b32 s31, s2, 7
    s_lshr_b32 s32, s2, 3
    s_mul_i32 s33, s32, 37
    s_lshr_b32 s33, s33, 8
    s_mul_i32 s34, s33, 7
    s_sub_u32 s30, s32, s34
    s_lshl_b32 s31, s31, 2
    s_add_u32 s29, s31, s33
    s_lshr_b32 s40, s28, 2
    s_and_b32 s41, s28, 3
    v_lshlrev_b32 v8, 4, v1
    s_lshl_b32 s31, s29, 2
    s_add_u32 s31, s31, s41
    s_mul_i32 s31, s31, 42
    s_add_u32 s31, s31, s40
    s_lshl_b32 s31, s31, 10
    s_add_u32 s37, s31, 0xd00000
    s_lshl_b32 s35, s28, 10
    v_lshrrev_b32 v2, 3, v1
    v_and_b32 v3, 7, v1
    v_lshrrev_b32 v4, 2, v2
    v_and_b32 v5, 3, v2
    v_lshl_add_u32 v4, v4, 3, v5
    v_mul_u32_u24 v4, 896, v4
    v_bfe_u32 v5, v2, 1, 2
    v_lshrrev_b32 v6, 1, v3
    v_xor_b32 v6, v6, v5
    v_and_b32 v3, 1, v3
    v_lshl_add_u32 v6, v6, 1, v3
    v_lshl_add_u32 v9, v6, 4, v4
    s_and_b32 s31, s41, 1
    s_lshl_b32 s31, s31, 4
    s_lshr_b32 s32, s41, 1
    s_lshl_b32 s32, s32, 2
    s_add_u32 s31, s31, s32
    s_lshl_b32 s32, s40, 5
    s_add_u32 s31, s31, s32
    s_mul_i32 s31, s31, 896
    s_lshl_b32 s32, s30, 7
    s_add_u32 s38, s31, s32
    v_and_b32 v2, 15, v1
    v_lshrrev_b32 v3, 4, v1
    v_lshrrev_b32 v4, 2, v2
    v_and_b32 v5, 3, v2
    v_lshl_add_u32 v4, v4, 3, v5
    v_mul_u32_u24 v4, 896, v4
    v_lshl_add_u32 v10, v3, 3, v4
    s_lshl_b32 s31, s29, 6
    s_lshr_b32 s32, s41, 1
    s_lshl_b32 s32, s32, 5
    s_add_u32 s31, s31, s32
    s_and_b32 s32, s41, 1
    s_lshl_b32 s32, s32, 2
    s_add_u32 s31, s31, s32
    s_mul_i32 s36, s31, 896
    s_lshl_b32 s31, s30, 7
    s_add_u32 s36, s36, s31
    s_lshl_b32 s31, s40, 6
    s_add_u32 s36, s36, s31
    v_lshlrev_b32 v16, 4, v1
    s_lshl_b32 s31, s41, 10
    v_add_u32 v16, s31, v16
    v_lshrrev_b32 v4, 2, v2
    v_lshl_add_u32 v4, v3, 2, v4
    v_bfe_u32 v5, v4, 1, 2
    v_lshlrev_b32 v4, 7, v4
    v_and_b32 v2, 3, v2
    v_lshl_add_u32 v4, v2, 3, v4
    v_add_u32 v4, 8192, v4
    s_lshl_b32 s31, s40, 1
    s_add_u32 s32, s31, 0
    v_xor_b32 v6, s32, v5
    v_lshl_add_u32 v18, v6, 5, v4
    s_add_u32 s32, s31, 1
    v_xor_b32 v6, s32, v5
    v_lshl_add_u32 v19, v6, 5, v4
    v_add_u32 v17, 65536, v16
    v_add_u32 v20, 65536, v18
    v_add_u32 v21, 65536, v19
    s_waitcnt lgkmcnt(0)
    s_mov_b32 s20, s56
    s_mov_b32 s21, s57
    s_mov_b32 s22, 0x1400000
    s_mov_b32 s23, 0x20000
    s_mov_b32 s12, s6
    s_mov_b32 s13, s7
    s_mov_b32 s14, 0x62000
    s_mov_b32 s15, 0x20000
    s_mov_b32 s16, s52
    s_mov_b32 s17, s53
    s_mov_b32 s18, 0xc4000
    s_mov_b32 s19, 0x20000
    v_mov_b32 v22, v9
    s_add_u32 m0, s35, 0
    s_nop 0
    buffer_load_dwordx4 v8, s[20:23], s37 offen lds
    v_add_u32 v8, 2048, v8
    s_add_u32 m0, s35, 8192
    s_nop 0
    buffer_load_dwordx4 v9, s[12:15], s38 offen lds
    v_add_u32 v9, 57344, v9
    s_add_u32 m0, s35, 16384
    s_nop 0
    buffer_load_dwordx4 v8, s[20:23], s37 offen lds
    v_add_u32 v8, 2048, v8
    s_add_u32 m0, s35, 24576
    s_nop 0
    buffer_load_dwordx4 v9, s[12:15], s38 offen lds
    v_add_u32 v9, 57344, v9
    s_add_u32 m0, s35, 32768
    s_nop 0
    buffer_load_dwordx4 v8, s[20:23], s37 offen lds
    v_add_u32 v8, 2048, v8
    s_add_u32 m0, s35, 40960
    s_nop 0
    buffer_load_dwordx4 v9, s[12:15], s38 offen lds
    v_add_u32 v9, 57344, v9
    s_add_u32 m0, s35, 49152
    s_nop 0
    buffer_load_dwordx4 v8, s[20:23], s37 offen lds
    v_add_u32 v8, 2048, v8
    s_add_u32 m0, s35, 57344
    s_nop 0
    buffer_load_dwordx4 v9, s[12:15], s38 offen lds
    v_add_u32 v9, 57344, v9
    s_add_u32 m0, s35, 65536
    s_nop 0
    buffer_load_dwordx4 v8, s[20:23], s37 offen lds
    v_add_u32 v8, 2048, v8
    s_add_u32 m0, s35, 73728
    s_nop 0
    buffer_load_dwordx4 v9, s[12:15], s38 offen lds
    v_add_u32 v9, 57344, v9
    s_getpc_b64 s[98:99]
    v_lshrrev_b32 v255, 6, v0
    v_cmp_eq_u32 vcc, 7, v255
    s_lshr_b32 s96, s2, 3
    s_mul_i32 s97, s96, 65536
    s_lshr_b32 s97, s97, 16
    s_mul_i32 s97, s97, 1
    s_sub_u32 s96, s96, s97
    s_lshl_b32 s96, s96, 6
    v_and_b32 v255, 63, v0
    v_add_u32 v255, s96, v255
    v_cmp_gt_u32 s[96:97], 36, v255
    s_nop 3
    s_and_b64 vcc, vcc, s[96:97]
    v_lshlrev_b32 v255, 7, v255
    s_and_saveexec_b64 s[96:97], vcc
    s_cbranch_execz p3_cpf
    global_load_dword v254, v255, s[98:99]
p3_cpf:
    s_mov_b64 exec, s[96:97]
    s_mov_b32 s8, s4
    s_mov_b32 s9, s5
    s_mov_b32 s10, 0x1c0000
    s_mov_b32 s11, 0x20000
    s_mov_b32 s24, s54
    s_mov_b32 s25, s55
    s_mov_b32 s26, 0x1c0000
    s_mov_b32 s27, 0x20000
    v_lshrrev_b32 v6, 3, v0
    v_mul_u32_u24 v10, 896, v6
    v_and_b32 v7, 7, v0
    v_lshl_add_u32 v10, v7, 4, v10
    s_mul_i32 s36, s29, 57344
    s_lshl_b32 s31, s30, 7
    s_add_u32 s36, s36, s31
    v_mul_u32_u24 v23, 272, v6
    v_lshl_add_u32 v23, v7, 5, v23
    buffer_load_dwordx4 v[12:15], v10, s[8:11], s36 offen
    s_waitcnt vmcnt(8)
    s_barrier
    ds_read_b128 v[32:35], v16 offset:0
    ds_read_b64_tr_b16 v[48:49], v18 offset:0
    ds_read_b64_tr_b16 v[50:51], v18 offset:2048
    ds_read_b64_tr_b16 v[52:53], v19 offset:0
    ds_read_b64_tr_b16 v[54:55], v19 offset:2048
    ds_read_b128 v[36:39], v16 offset:4096
    ds_read_b64_tr_b16 v[56:57], v18 offset:4096
    ds_read_b64_tr_b16 v[58:59], v18 offset:6144
    ds_read_b64_tr_b16 v[60:61], v19 offset:4096
    ds_read_b64_tr_b16 v[62:63], v19 offset:6144
    s_waitcnt lgkmcnt(0)
    s_waitcnt vmcnt(6)
    s_barrier
    v_mfma_f32_16x16x32_bf16 v[24:27], v[48:51], v[32:35], 0
    ds_read_b128 v[40:43], v16 offset:16384
    ds_read_b64_tr_b16 v[64:65], v18 offset:16384
    ds_read_b64_tr_b16 v[66:67], v18 offset:18432
    v_mfma_f32_16x16x32_bf16 v[28:31], v[52:55], v[32:35], 0
    ds_read_b64_tr_b16 v[68:69], v19 offset:16384
    ds_read_b64_tr_b16 v[70:71], v19 offset:18432
    ds_read_b128 v[44:47], v16 offset:20480
    s_add_u32 m0, s35, 81920
    s_nop 0
    buffer_load_dwordx4 v8, s[20:23], s37 offen lds
    v_add_u32 v8, 2048, v8
    v_mfma_f32_16x16x32_bf16 v[24:27], v[56:59], v[36:39], v[24:27]
    ds_read_b64_tr_b16 v[72:73], v18 offset:20480
    ds_read_b64_tr_b16 v[74:75], v18 offset:22528
    ds_read_b64_tr_b16 v[76:77], v19 offset:20480
    s_add_u32 m0, s35, 90112
    s_nop 0
    buffer_load_dwordx4 v9, s[12:15], s38 offen lds
    v_add_u32 v9, 57344, v9
    v_mfma_f32_16x16x32_bf16 v[28:31], v[60:63], v[36:39], v[28:31]
    ds_read_b64_tr_b16 v[78:79], v19 offset:22528
    s_waitcnt lgkmcnt(0)
    s_waitcnt vmcnt(6)
    s_barrier
    v_mfma_f32_16x16x32_bf16 v[24:27], v[64:67], v[40:43], v[24:27]
    ds_read_b128 v[32:35], v16 offset:32768
    ds_read_b64_tr_b16 v[48:49], v18 offset:32768
    ds_read_b64_tr_b16 v[50:51], v18 offset:34816
    v_mfma_f32_16x16x32_bf16 v[28:31], v[68:71], v[40:43], v[28:31]
    ds_read_b64_tr_b16 v[52:53], v19 offset:32768
    ds_read_b64_tr_b16 v[54:55], v19 offset:34816
    ds_read_b128 v[36:39], v16 offset:36864
    s_add_u32 m0, s35, 0
    s_nop 0
    buffer_load_dwordx4 v8, s[20:23], s37 offen lds
    v_add_u32 v8, 2048, v8
    v_mfma_f32_16x16x32_bf16 v[24:27], v[72:75], v[44:47], v[24:27]
    ds_read_b64_tr_b16 v[56:57], v18 offset:36864
    ds_read_b64_tr_b16 v[58:59], v18 offset:38912
    ds_read_b64_tr_b16 v[60:61], v19 offset:36864
    s_add_u32 m0, s35, 8192
    s_nop 0
    buffer_load_dwordx4 v9, s[12:15], s38 offen lds
    v_add_u32 v9, 57344, v9
    v_mfma_f32_16x16x32_bf16 v[28:31], v[76:79], v[44:47], v[28:31]
    ds_read_b64_tr_b16 v[62:63], v19 offset:38912
    s_waitcnt lgkmcnt(0)
    s_waitcnt vmcnt(6)
    s_barrier
    v_mfma_f32_16x16x32_bf16 v[24:27], v[48:51], v[32:35], v[24:27]
    ds_read_b128 v[40:43], v16 offset:49152
    ds_read_b64_tr_b16 v[64:65], v18 offset:49152
    ds_read_b64_tr_b16 v[66:67], v18 offset:51200
    v_mfma_f32_16x16x32_bf16 v[28:31], v[52:55], v[32:35], v[28:31]
    ds_read_b64_tr_b16 v[68:69], v19 offset:49152
    ds_read_b64_tr_b16 v[70:71], v19 offset:51200
    ds_read_b128 v[44:47], v16 offset:53248
    s_add_u32 m0, s35, 16384
    s_nop 0
    buffer_load_dwordx4 v8, s[20:23], s37 offen lds
    v_add_u32 v8, 2048, v8
    v_mfma_f32_16x16x32_bf16 v[24:27], v[56:59], v[36:39], v[24:27]
    ds_read_b64_tr_b16 v[72:73], v18 offset:53248
    ds_read_b64_tr_b16 v[74:75], v18 offset:55296
    ds_read_b64_tr_b16 v[76:77], v19 offset:53248
    s_add_u32 m0, s35, 24576
    s_nop 0
    buffer_load_dwordx4 v22, s[16:19], s38 offen lds
    v_add_u32 v22, 57344, v22
    v_mfma_f32_16x16x32_bf16 v[28:31], v[60:63], v[36:39], v[28:31]
    ds_read_b64_tr_b16 v[78:79], v19 offset:55296
    s_waitcnt lgkmcnt(0)
    s_waitcnt vmcnt(6)
    s_barrier
    v_mfma_f32_16x16x32_bf16 v[24:27], v[64:67], v[40:43], v[24:27]
    ds_read_b128 v[32:35], v17 offset:0
    ds_read_b64_tr_b16 v[48:49], v20 offset:0
    ds_read_b64_tr_b16 v[50:51], v20 offset:2048
    v_mfma_f32_16x16x32_bf16 v[28:31], v[68:71], v[40:43], v[28:31]
    ds_read_b64_tr_b16 v[52:53], v21 offset:0
    ds_read_b64_tr_b16 v[54:55], v21 offset:2048
    ds_read_b128 v[36:39], v17 offset:4096
    s_add_u32 m0, s35, 32768
    s_nop 0
    buffer_load_dwordx4 v8, s[20:23], s37 offen lds
    v_add_u32 v8, 2048, v8
    v_mfma_f32_16x16x32_bf16 v[24:27], v[72:75], v[44:47], v[24:27]
    ds_read_b64_tr_b16 v[56:57], v20 offset:4096
    ds_read_b64_tr_b16 v[58:59], v20 offset:6144
    ds_read_b64_tr_b16 v[60:61], v21 offset:4096
    s_add_u32 m0, s35, 40960
    s_nop 0
    buffer_load_dwordx4 v22, s[16:19], s38 offen lds
    v_add_u32 v22, 57344, v22
    v_mfma_f32_16x16x32_bf16 v[28:31], v[76:79], v[44:47], v[28:31]
    ds_read_b64_tr_b16 v[62:63], v21 offset:6144
    s_waitcnt lgkmcnt(0)
    s_waitcnt vmcnt(6)
    s_barrier
    v_mfma_f32_16x16x32_bf16 v[24:27], v[48:51], v[32:35], v[24:27]
    ds_read_b128 v[40:43], v17 offset:16384
    ds_read_b64_tr_b16 v[64:65], v20 offset:16384
    ds_read_b64_tr_b16 v[66:67], v20 offset:18432
    v_mfma_f32_16x16x32_bf16 v[28:31], v[52:55], v[32:35], v[28:31]
    ds_read_b64_tr_b16 v[68:69], v21 offset:16384
    ds_read_b64_tr_b16 v[70:71], v21 offset:18432
    ds_read_b128 v[44:47], v17 offset:20480
    s_add_u32 m0, s35, 49152
    s_nop 0
    buffer_load_dwordx4 v8, s[20:23], s37 offen lds
    v_add_u32 v8, 2048, v8
    v_mfma_f32_16x16x32_bf16 v[24:27], v[56:59], v[36:39], v[24:27]
    ds_read_b64_tr_b16 v[72:73], v20 offset:20480
    ds_read_b64_tr_b16 v[74:75], v20 offset:22528
    ds_read_b64_tr_b16 v[76:77], v21 offset:20480
    s_add_u32 m0, s35, 57344
    s_nop 0
    buffer_load_dwordx4 v22, s[16:19], s38 offen lds
    v_add_u32 v22, 57344, v22
    v_mfma_f32_16x16x32_bf16 v[28:31], v[60:63], v[36:39], v[28:31]
    ds_read_b64_tr_b16 v[78:79], v21 offset:22528
    s_waitcnt lgkmcnt(0)
    s_waitcnt vmcnt(6)
    s_barrier
    v_mfma_f32_16x16x32_bf16 v[24:27], v[64:67], v[40:43], v[24:27]
    ds_read_b128 v[32:35], v16 offset:0
    ds_read_b64_tr_b16 v[48:49], v18 offset:0
    ds_read_b64_tr_b16 v[50:51], v18 offset:2048
    v_mfma_f32_16x16x32_bf16 v[28:31], v[68:71], v[40:43], v[28:31]
    ds_read_b64_tr_b16 v[52:53], v19 offset:0
    ds_read_b64_tr_b16 v[54:55], v19 offset:2048
    ds_read_b128 v[36:39], v16 offset:4096
    s_add_u32 m0, s35, 65536
    s_nop 0
    buffer_load_dwordx4 v8, s[20:23], s37 offen lds
    v_add_u32 v8, 2048, v8
    v_mfma_f32_16x16x32_bf16 v[24:27], v[72:75], v[44:47], v[24:27]
    ds_read_b64_tr_b16 v[56:57], v18 offset:4096
    ds_read_b64_tr_b16 v[58:59], v18 offset:6144
    ds_read_b64_tr_b16 v[60:61], v19 offset:4096
    s_add_u32 m0, s35, 73728
    s_nop 0
    buffer_load_dwordx4 v22, s[16:19], s38 offen lds
    v_add_u32 v22, 57344, v22
    v_mfma_f32_16x16x32_bf16 v[28:31], v[76:79], v[44:47], v[28:31]
    ds_read_b64_tr_b16 v[62:63], v19 offset:6144
    s_waitcnt lgkmcnt(0)
    s_waitcnt vmcnt(6)
    s_barrier
    v_mfma_f32_16x16x32_bf16 v[24:27], v[48:51], v[32:35], v[24:27]
    ds_read_b128 v[40:43], v16 offset:16384
    ds_read_b64_tr_b16 v[64:65], v18 offset:16384
    ds_read_b64_tr_b16 v[66:67], v18 offset:18432
    v_mfma_f32_16x16x32_bf16 v[28:31], v[52:55], v[32:35], v[28:31]
    ds_read_b64_tr_b16 v[68:69], v19 offset:16384
    ds_read_b64_tr_b16 v[70:71], v19 offset:18432
    ds_read_b128 v[44:47], v16 offset:20480
    s_add_u32 m0, s35, 81920
    s_nop 0
    buffer_load_dwordx4 v8, s[20:23], s37 offen lds
    v_add_u32 v8, 2048, v8
    v_mfma_f32_16x16x32_bf16 v[24:27], v[56:59], v[36:39], v[24:27]
    ds_read_b64_tr_b16 v[72:73], v18 offset:20480
    ds_read_b64_tr_b16 v[74:75], v18 offset:22528
    ds_read_b64_tr_b16 v[76:77], v19 offset:20480
    s_add_u32 m0, s35, 90112
    s_nop 0
    buffer_load_dwordx4 v22, s[16:19], s38 offen lds
    v_add_u32 v22, 57344, v22
    v_mfma_f32_16x16x32_bf16 v[28:31], v[60:63], v[36:39], v[28:31]
    ds_read_b64_tr_b16 v[78:79], v19 offset:22528
    s_waitcnt lgkmcnt(0)
    s_waitcnt vmcnt(6)
    s_barrier
    v_mfma_f32_16x16x32_bf16 v[24:27], v[64:67], v[40:43], v[24:27]
    ds_read_b128 v[32:35], v16 offset:32768
    ds_read_b64_tr_b16 v[48:49], v18 offset:32768
    ds_read_b64_tr_b16 v[50:51], v18 offset:34816
    v_mfma_f32_16x16x32_bf16 v[28:31], v[68:71], v[40:43], v[28:31]
    ds_read_b64_tr_b16 v[52:53], v19 offset:32768
    ds_read_b64_tr_b16 v[54:55], v19 offset:34816
    ds_read_b128 v[36:39], v16 offset:36864
    s_add_u32 m0, s35, 0
    s_nop 0
    buffer_load_dwordx4 v8, s[20:23], s37 offen lds
    v_add_u32 v8, 2048, v8
    v_mfma_f32_16x16x32_bf16 v[24:27], v[72:75], v[44:47], v[24:27]
    ds_read_b64_tr_b16 v[56:57], v18 offset:36864
    ds_read_b64_tr_b16 v[58:59], v18 offset:38912
    ds_read_b64_tr_b16 v[60:61], v19 offset:36864
    s_add_u32 m0, s35, 8192
    s_nop 0
    buffer_load_dwordx4 v22, s[16:19], s38 offen lds
    v_add_u32 v22, 57344, v22
    v_mfma_f32_16x16x32_bf16 v[28:31], v[76:79], v[44:47], v[28:31]
    ds_read_b64_tr_b16 v[62:63], v19 offset:38912
    s_waitcnt lgkmcnt(0)
    s_waitcnt vmcnt(6)
    s_barrier
    v_mfma_f32_16x16x32_bf16 v[24:27], v[48:51], v[32:35], v[24:27]
    ds_read_b128 v[40:43], v16 offset:49152
    ds_read_b64_tr_b16 v[64:65], v18 offset:49152
    ds_read_b64_tr_b16 v[66:67], v18 offset:51200
    v_mfma_f32_16x16x32_bf16 v[28:31], v[52:55], v[32:35], v[28:31]
    ds_read_b64_tr_b16 v[68:69], v19 offset:49152
    ds_read_b64_tr_b16 v[70:71], v19 offset:51200
    ds_read_b128 v[44:47], v16 offset:53248
    s_add_u32 m0, s35, 16384
    s_nop 0
    buffer_load_dwordx4 v8, s[20:23], s37 offen lds
    v_add_u32 v8, 2048, v8
    v_mfma_f32_16x16x32_bf16 v[24:27], v[56:59], v[36:39], v[24:27]
    ds_read_b64_tr_b16 v[72:73], v18 offset:53248
    ds_read_b64_tr_b16 v[74:75], v18 offset:55296
    ds_read_b64_tr_b16 v[76:77], v19 offset:53248
    s_add_u32 m0, s35, 24576
    s_nop 0
    buffer_load_dwordx4 v22, s[16:19], s38 offen lds
    v_add_u32 v22, 57344, v22
    v_mfma_f32_16x16x32_bf16 v[28:31], v[60:63], v[36:39], v[28:31]
    ds_read_b64_tr_b16 v[78:79], v19 offset:55296
    s_waitcnt lgkmcnt(0)
    s_waitcnt vmcnt(6)
    s_barrier
    v_mfma_f32_16x16x32_bf16 v[24:27], v[64:67], v[40:43], v[24:27]
    ds_read_b128 v[32:35], v17 offset:0
    ds_read_b64_tr_b16 v[48:49], v20 offset:0
    ds_read_b64_tr_b16 v[50:51], v20 offset:2048
    v_mfma_f32_16x16x32_bf16 v[28:31], v[68:71], v[40:43], v[28:31]
    ds_read_b64_tr_b16 v[52:53], v21 offset:0
    ds_read_b64_tr_b16 v[54:55], v21 offset:2048
    ds_read_b128 v[36:39], v17 offset:4096
    s_add_u32 m0, s35, 32768
    s_nop 0
    buffer_load_dwordx4 v8, s[20:23], s37 offen lds
    v_add_u32 v8, 2048, v8
    v_mfma_f32_16x16x32_bf16 v[24:27], v[72:75], v[44:47], v[24:27]
    ds_read_b64_tr_b16 v[56:57], v20 offset:4096
    ds_read_b64_tr_b16 v[58:59], v20 offset:6144
    ds_read_b64_tr_b16 v[60:61], v21 offset:4096
    s_add_u32 m0, s35, 40960
    s_nop 0
    buffer_load_dwordx4 v22, s[16:19], s38 offen lds
    v_add_u32 v22, 57344, v22
    v_mfma_f32_16x16x32_bf16 v[28:31], v[76:79], v[44:47], v[28:31]
    ds_read_b64_tr_b16 v[62:63], v21 offset:6144
    s_waitcnt lgkmcnt(0)
    s_waitcnt vmcnt(6)
    s_barrier
    v_mfma_f32_16x16x32_bf16 v[24:27], v[48:51], v[32:35], v[24:27]
    ds_read_b128 v[40:43], v17 offset:16384
    ds_read_b64_tr_b16 v[64:65], v20 offset:16384
    ds_read_b64_tr_b16 v[66:67], v20 offset:18432
    v_mfma_f32_16x16x32_bf16 v[28:31], v[52:55], v[32:35], v[28:31]
    ds_read_b64_tr_b16 v[68:69], v21 offset:16384
    ds_read_b64_tr_b16 v[70:71], v21 offset:18432
    ds_read_b128 v[44:47], v17 offset:20480
    s_add_u32 m0, s35, 49152
    s_nop 0
    buffer_load_dwordx4 v8, s[20:23], s37 offen lds
    v_add_u32 v8, 2048, v8
    v_mfma_f32_16x16x32_bf16 v[24:27], v[56:59], v[36:39], v[24:27]
    ds_read_b64_tr_b16 v[72:73], v20 offset:20480
    ds_read_b64_tr_b16 v[74:75], v20 offset:22528
    ds_read_b64_tr_b16 v[76:77], v21 offset:20480
    s_add_u32 m0, s35, 57344
    s_nop 0
    buffer_load_dwordx4 v22, s[16:19], s38 offen lds
    v_add_u32 v22, 57344, v22
    v_mfma_f32_16x16x32_bf16 v[28:31], v[60:63], v[36:39], v[28:31]
    ds_read_b64_tr_b16 v[78:79], v21 offset:22528
    s_waitcnt lgkmcnt(0)
    s_waitcnt vmcnt(6)
    s_barrier
    v_mfma_f32_16x16x32_bf16 v[24:27], v[64:67], v[40:43], v[24:27]
    ds_read_b128 v[32:35], v16 offset:0
    ds_read_b64_tr_b16 v[48:49], v18 offset:0
    ds_read_b64_tr_b16 v[50:51], v18 offset:2048
    v_mfma_f32_16x16x32_bf16 v[28:31], v[68:71], v[40:43], v[28:31]
    ds_read_b64_tr_b16 v[52:53], v19 offset:0
    ds_read_b64_tr_b16 v[54:55], v19 offset:2048
    ds_read_b128 v[36:39], v16 offset:4096
    s_add_u32 m0, s35, 65536
    s_nop 0
    buffer_load_dwordx4 v8, s[20:23], s37 offen lds
    v_add_u32 v8, 2048, v8
    v_mfma_f32_16x16x32_bf16 v[24:27], v[72:75], v[44:47], v[24:27]
    ds_read_b64_tr_b16 v[56:57], v18 offset:4096
    ds_read_b64_tr_b16 v[58:59], v18 offset:6144
    ds_read_b64_tr_b16 v[60:61], v19 offset:4096
    s_add_u32 m0, s35, 73728
    s_nop 0
    buffer_load_dwordx4 v22, s[16:19], s38 offen lds
    v_add_u32 v22, 57344, v22
    v_mfma_f32_16x16x32_bf16 v[28:31], v[76:79], v[44:47], v[28:31]
    ds_read_b64_tr_b16 v[62:63], v19 offset:6144
    s_waitcnt lgkmcnt(0)
    s_waitcnt vmcnt(6)
    s_barrier
    v_mfma_f32_16x16x32_bf16 v[24:27], v[48:51], v[32:35], v[24:27]
    ds_read_b128 v[40:43], v16 offset:16384
    ds_read_b64_tr_b16 v[64:65], v18 offset:16384
    ds_read_b64_tr_b16 v[66:67], v18 offset:18432
    v_mfma_f32_16x16x32_bf16 v[28:31], v[52:55], v[32:35], v[28:31]
    ds_read_b64_tr_b16 v[68:69], v19 offset:16384
    ds_read_b64_tr_b16 v[70:71], v19 offset:18432
    ds_read_b128 v[44:47], v16 offset:20480
    s_add_u32 m0, s35, 81920
    s_nop 0
    buffer_load_dwordx4 v8, s[20:23], s37 offen lds
    v_add_u32 v8, 2048, v8
    v_mfma_f32_16x16x32_bf16 v[24:27], v[56:59], v[36:39], v[24:27]
    ds_read_b64_tr_b16 v[72:73], v18 offset:20480
    ds_read_b64_tr_b16 v[74:75], v18 offset:22528
    ds_read_b64_tr_b16 v[76:77], v19 offset:20480
    s_add_u32 m0, s35, 90112
    s_nop 0
    buffer_load_dwordx4 v22, s[16:19], s38 offen lds
    v_add_u32 v22, 57344, v22
    v_mfma_f32_16x16x32_bf16 v[28:31], v[60:63], v[36:39], v[28:31]
    ds_read_b64_tr_b16 v[78:79], v19 offset:22528
    s_waitcnt lgkmcnt(0)
    s_waitcnt vmcnt(6)
    s_barrier
    v_mfma_f32_16x16x32_bf16 v[24:27], v[64:67], v[40:43], v[24:27]
    ds_read_b128 v[32:35], v16 offset:32768
    ds_read_b64_tr_b16 v[48:49], v18 offset:32768
    ds_read_b64_tr_b16 v[50:51], v18 offset:34816
    v_mfma_f32_16x16x32_bf16 v[28:31], v[68:71], v[40:43], v[28:31]
    ds_read_b64_tr_b16 v[52:53], v19 offset:32768
    ds_read_b64_tr_b16 v[54:55], v19 offset:34816
    ds_read_b128 v[36:39], v16 offset:36864
    s_add_u32 m0, s35, 0
    s_nop 0
    buffer_load_dwordx4 v8, s[20:23], s37 offen lds
    v_add_u32 v8, 2048, v8
    v_mfma_f32_16x16x32_bf16 v[24:27], v[72:75], v[44:47], v[24:27]
    ds_read_b64_tr_b16 v[56:57], v18 offset:36864
    ds_read_b64_tr_b16 v[58:59], v18 offset:38912
    ds_read_b64_tr_b16 v[60:61], v19 offset:36864
    s_add_u32 m0, s35, 8192
    s_nop 0
    buffer_load_dwordx4 v22, s[16:19], s38 offen lds
    v_add_u32 v22, 57344, v22
    v_mfma_f32_16x16x32_bf16 v[28:31], v[76:79], v[44:47], v[28:31]
    ds_read_b64_tr_b16 v[62:63], v19 offset:38912
    s_waitcnt lgkmcnt(0)
    s_waitcnt vmcnt(6)
    s_barrier
    v_mfma_f32_16x16x32_bf16 v[24:27], v[48:51], v[32:35], v[24:27]
    ds_read_b128 v[40:43], v16 offset:49152
    ds_read_b64_tr_b16 v[64:65], v18 offset:49152
    ds_read_b64_tr_b16 v[66:67], v18 offset:51200
    v_mfma_f32_16x16x32_bf16 v[28:31], v[52:55], v[32:35], v[28:31]
    ds_read_b64_tr_b16 v[68:69], v19 offset:49152
    ds_read_b64_tr_b16 v[70:71], v19 offset:51200
    ds_read_b128 v[44:47], v16 offset:53248
    s_add_u32 m0, s35, 16384
    s_nop 0
    buffer_load_dwordx4 v8, s[20:23], s37 offen lds
    v_add_u32 v8, 2048, v8
    v_mfma_f32_16x16x32_bf16 v[24:27], v[56:59], v[36:39], v[24:27]
    ds_read_b64_tr_b16 v[72:73], v18 offset:53248
    ds_read_b64_tr_b16 v[74:75], v18 offset:55296
    ds_read_b64_tr_b16 v[76:77], v19 offset:53248
    s_add_u32 m0, s35, 24576
    s_nop 0
    buffer_load_dwordx4 v22, s[16:19], s38 offen lds
    v_add_u32 v22, 57344, v22
    v_mfma_f32_16x16x32_bf16 v[28:31], v[60:63], v[36:39], v[28:31]
    ds_read_b64_tr_b16 v[78:79], v19 offset:55296
    s_waitcnt lgkmcnt(0)
    s_waitcnt vmcnt(6)
    s_barrier
    v_mfma_f32_16x16x32_bf16 v[24:27], v[64:67], v[40:43], v[24:27]
    ds_read_b128 v[32:35], v17 offset:0
    ds_read_b64_tr_b16 v[48:49], v20 offset:0
    ds_read_b64_tr_b16 v[50:51], v20 offset:2048
    v_mfma_f32_16x16x32_bf16 v[28:31], v[68:71], v[40:43], v[28:31]
    ds_read_b64_tr_b16 v[52:53], v21 offset:0
    ds_read_b64_tr_b16 v[54:55], v21 offset:2048
    ds_read_b128 v[36:39], v17 offset:4096
    s_add_u32 m0, s35, 32768
    s_nop 0
    buffer_load_dwordx4 v8, s[20:23], s37 offen lds
    v_add_u32 v8, 2048, v8
    v_mfma_f32_16x16x32_bf16 v[24:27], v[72:75], v[44:47], v[24:27]
    ds_read_b64_tr_b16 v[56:57], v20 offset:4096
    ds_read_b64_tr_b16 v[58:59], v20 offset:6144
    ds_read_b64_tr_b16 v[60:61], v21 offset:4096
    s_add_u32 m0, s35, 40960
    s_nop 0
    buffer_load_dwordx4 v22, s[16:19], s38 offen lds
    v_add_u32 v22, 57344, v22
    v_mfma_f32_16x16x32_bf16 v[28:31], v[76:79], v[44:47], v[28:31]
    ds_read_b64_tr_b16 v[62:63], v21 offset:6144
    s_waitcnt lgkmcnt(0)
    s_waitcnt vmcnt(6)
    s_barrier
    v_mfma_f32_16x16x32_bf16 v[24:27], v[48:51], v[32:35], v[24:27]
    ds_read_b128 v[40:43], v17 offset:16384
    ds_read_b64_tr_b16 v[64:65], v20 offset:16384
    ds_read_b64_tr_b16 v[66:67], v20 offset:18432
    v_mfma_f32_16x16x32_bf16 v[28:31], v[52:55], v[32:35], v[28:31]
    ds_read_b64_tr_b16 v[68:69], v21 offset:16384
    ds_read_b64_tr_b16 v[70:71], v21 offset:18432
    ds_read_b128 v[44:47], v17 offset:20480
    v_mfma_f32_16x16x32_bf16 v[24:27], v[56:59], v[36:39], v[24:27]
    ds_read_b64_tr_b16 v[72:73], v20 offset:20480
    ds_read_b64_tr_b16 v[74:75], v20 offset:22528
    ds_read_b64_tr_b16 v[76:77], v21 offset:20480
    v_mfma_f32_16x16x32_bf16 v[28:31], v[60:63], v[36:39], v[28:31]
    ds_read_b64_tr_b16 v[78:79], v21 offset:22528
    s_waitcnt lgkmcnt(0)
    s_waitcnt vmcnt(4)
    s_barrier
    v_mfma_f32_16x16x32_bf16 v[24:27], v[64:67], v[40:43], v[24:27]
    ds_read_b128 v[32:35], v16 offset:0
    ds_read_b64_tr_b16 v[48:49], v18 offset:0
    ds_read_b64_tr_b16 v[50:51], v18 offset:2048
    v_mfma_f32_16x16x32_bf16 v[28:31], v[68:71], v[40:43], v[28:31]
    ds_read_b64_tr_b16 v[52:53], v19 offset:0
    ds_read_b64_tr_b16 v[54:55], v19 offset:2048
    ds_read_b128 v[36:39], v16 offset:4096
    v_mfma_f32_16x16x32_bf16 v[24:27], v[72:75], v[44:47], v[24:27]
    ds_read_b64_tr_b16 v[56:57], v18 offset:4096
    ds_read_b64_tr_b16 v[58:59], v18 offset:6144
    ds_read_b64_tr_b16 v[60:61], v19 offset:4096
    v_mfma_f32_16x16x32_bf16 v[28:31], v[76:79], v[44:47], v[28:31]
    ds_read_b64_tr_b16 v[62:63], v19 offset:6144
    s_waitcnt lgkmcnt(0)
    s_waitcnt vmcnt(2)
    s_barrier
    v_mfma_f32_16x16x32_bf16 v[24:27], v[48:51], v[32:35], v[24:27]
    ds_read_b128 v[40:43], v16 offset:16384
    ds_read_b64_tr_b16 v[64:65], v18 offset:16384
    ds_read_b64_tr_b16 v[66:67], v18 offset:18432
    v_mfma_f32_16x16x32_bf16 v[28:31], v[52:55], v[32:35], v[28:31]
    ds_read_b64_tr_b16 v[68:69], v19 offset:16384
    ds_read_b64_tr_b16 v[70:71], v19 offset:18432
    ds_read_b128 v[44:47], v16 offset:20480
    v_mfma_f32_16x16x32_bf16 v[24:27], v[56:59], v[36:39], v[24:27]
    ds_read_b64_tr_b16 v[72:73], v18 offset:20480
    ds_read_b64_tr_b16 v[74:75], v18 offset:22528
    ds_read_b64_tr_b16 v[76:77], v19 offset:20480
    v_mfma_f32_16x16x32_bf16 v[28:31], v[60:63], v[36:39], v[28:31]
    ds_read_b64_tr_b16 v[78:79], v19 offset:22528
    s_waitcnt lgkmcnt(0)
    s_waitcnt vmcnt(0)
    s_barrier
    v_mfma_f32_16x16x32_bf16 v[24:27], v[64:67], v[40:43], v[24:27]
    ds_read_b128 v[32:35], v16 offset:32768
    ds_read_b64_tr_b16 v[48:49], v18 offset:32768
    ds_read_b64_tr_b16 v[50:51], v18 offset:34816
    v_mfma_f32_16x16x32_bf16 v[28:31], v[68:71], v[40:43], v[28:31]
    ds_read_b64_tr_b16 v[52:53], v19 offset:32768
    ds_read_b64_tr_b16 v[54:55], v19 offset:34816
    ds_read_b128 v[36:39], v16 offset:36864
    v_mfma_f32_16x16x32_bf16 v[24:27], v[72:75], v[44:47], v[24:27]
    ds_read_b64_tr_b16 v[56:57], v18 offset:36864
    ds_read_b64_tr_b16 v[58:59], v18 offset:38912
    ds_read_b64_tr_b16 v[60:61], v19 offset:36864
    v_mfma_f32_16x16x32_bf16 v[28:31], v[76:79], v[44:47], v[28:31]
    ds_read_b64_tr_b16 v[62:63], v19 offset:38912
    s_waitcnt lgkmcnt(0)
    v_mfma_f32_16x16x32_bf16 v[24:27], v[48:51], v[32:35], v[24:27]
    v_mfma_f32_16x16x32_bf16 v[28:31], v[52:55], v[32:35], v[28:31]
    v_mfma_f32_16x16x32_bf16 v[24:27], v[56:59], v[36:39], v[24:27]
    v_mfma_f32_16x16x32_bf16 v[28:31], v[60:63], v[36:39], v[28:31]
    s_barrier
    v_and_b32 v2, 15, v1
    v_lshrrev_b32 v3, 2, v2
    v_and_b32 v2, 3, v2
    v_lshl_add_u32 v2, v3, 3, v2
    s_lshr_b32 s31, s41, 1
    s_lshl_b32 s31, s31, 5
    s_and_b32 s32, s41, 1
    s_lshl_b32 s32, s32, 2
    s_add_u32 s31, s31, s32
    v_add_u32 v2, s31, v2
    v_mul_u32_u24 v2, 272, v2
    v_lshrrev_b32 v3, 4, v1
    v_lshl_add_u32 v2, v3, 4, v2
    s_lshl_b32 s31, s40, 7
    v_add_u32 v2, s31, v2
    ds_write_b128 v2, v[24:27] offset:0
    ds_write_b128 v2, v[28:31] offset:64
    s_waitcnt vmcnt(0) lgkmcnt(0)
    s_barrier
    ds_read_b128 v[48:51], v23 offset:0
    ds_read_b128 v[52:55], v23 offset:16
    v_lshlrev_b32 v32, 16, v12
    v_and_b32 v33, 0xffff0000, v12
    v_lshlrev_b32 v34, 16, v13
    v_and_b32 v35, 0xffff0000, v13
    v_lshlrev_b32 v36, 16, v14
    v_and_b32 v37, 0xffff0000, v14
    v_lshlrev_b32 v38, 16, v15
    v_and_b32 v39, 0xffff0000, v15
    s_waitcnt lgkmcnt(0)
    v_pk_add_f32 v[48:49], v[48:49], v[32:33]
    v_pk_add_f32 v[50:51], v[50:51], v[34:35]
    v_pk_add_f32 v[52:53], v[52:53], v[36:37]
    v_pk_add_f32 v[54:55], v[54:55], v[38:39]
    v_cvt_pk_bf16_f32 v40, v48, v49
    v_cvt_pk_bf16_f32 v41, v50, v51
    v_cvt_pk_bf16_f32 v42, v52, v53
    v_cvt_pk_bf16_f32 v43, v54, v55
    buffer_store_dwordx4 v[40:43], v10, s[24:27], s36 offen
p3_end:
    s_endpgm
text_end:
    s_endpgm
.section .rodata,"a"
.p2align 6
.amdhsa_kernel p1_kernel
  .amdhsa_next_free_vgpr 256
  .amdhsa_next_free_sgpr 100
  .amdhsa_accum_offset 256
  .amdhsa_group_segment_fixed_size 0
  .amdhsa_kernarg_size 88
  .amdhsa_user_sgpr_count 2
  .amdhsa_user_sgpr_kernarg_segment_ptr 1
  .amdhsa_system_sgpr_workgroup_id_x 1
.end_amdhsa_kernel
.p2align 6
.amdhsa_kernel p2_kernel
  .amdhsa_next_free_vgpr 256
  .amdhsa_next_free_sgpr 100
  .amdhsa_accum_offset 256
  .amdhsa_group_segment_fixed_size 0
  .amdhsa_kernarg_size 88
  .amdhsa_user_sgpr_count 2
  .amdhsa_user_sgpr_kernarg_segment_ptr 1
  .amdhsa_system_sgpr_workgroup_id_x 1
.end_amdhsa_kernel
.p2align 6
.amdhsa_kernel p3_kernel
  .amdhsa_next_free_vgpr 256
  .amdhsa_next_free_sgpr 100
  .amdhsa_accum_offset 256
  .amdhsa_group_segment_fixed_size 0
  .amdhsa_kernarg_size 88
  .amdhsa_user_sgpr_count 2
  .amdhsa_user_sgpr_kernarg_segment_ptr 1
  .amdhsa_system_sgpr_workgroup_id_x 1
.end_amdhsa_kernel
```
